```python
import torch

def _softmax(x, axis=-1):
    return torch.softmax(x, dim=axis)
def _gelu(x):
    return torch.nn.functional.gelu(x, approximate="tanh")
def _silu(x):
    return torch.nn.functional.silu(x)
def _sigmoid(x):
    return torch.sigmoid(x)
def _layernorm(x, axis=-1, eps=1e-5):
    m = x.mean(dim=axis, keepdim=True)
    v = x.var(dim=axis, keepdim=True, unbiased=False)
    return (x - m) / torch.sqrt(v + eps)
def _scatter_add(tgt, idx, src, axis=0):
    return tgt.clone().index_add_(axis, idx, src)
def _segment_sum(src, seg, n):
    out = torch.zeros((n,) + src.shape[1:], dtype=src.dtype)
    return out.index_add_(0, seg, src)
def _pad(x, pw):
    flat = tuple(v for pair in reversed(pw) for v in pair)
    return torch.nn.functional.pad(x, flat)

kernel_name = 'gated_mix__linear_kernel_hedgehog__mixer_s_mlp__prompt'

def setup_inputs():

    _w = (lambda a: (lambda t: t.to(torch.bfloat16) if t.is_floating_point() else t)(torch.as_tensor(a)))
    def _A_setup():
        B, S, D, H = 1, 2048, 448, 16
        Dh = D // H
        return {
            "x": _w((lambda *s: torch.randn(*s, dtype=torch.bfloat16) * 0.05)(B, S, D)),
            "wqkv": _w((lambda *s: torch.randn(*s, dtype=torch.bfloat16) * 1.6)(D, 3 * D)),
            "w_phi": _w((lambda *s: torch.randn(*s, dtype=torch.bfloat16) * 1.6)(H, Dh, Dh) * (Dh ** -0.5)),
            "wo": _w((lambda *s: torch.randn(*s, dtype=torch.bfloat16) * 0.1)(D, D)),
        }
    _A_in = _A_setup()

    def _B_setup():
        B, S, D, F = 1, 2048, 448, 1792
        return {
            "x":  _w((lambda *s: torch.randn(*s, dtype=torch.bfloat16) * 0.05)(B, S, D)),
            "w1": _w((lambda *s: torch.randn(*s, dtype=torch.bfloat16) * 0.4)(D, D) * (D ** -0.5)),
            "w2": _w((lambda *s: torch.randn(*s, dtype=torch.bfloat16) * 0.4)(D, D) * (D ** -0.5)),
            "w3": _w((lambda *s: torch.randn(*s, dtype=torch.bfloat16) * 0.4)(D, F) * (D ** -0.5)),
            "w4": _w((lambda *s: torch.randn(*s, dtype=torch.bfloat16) * 0.4)(F, D) * (F ** -0.5)),
        }
    _B_in = _B_setup()

    return {
        "A_x": _A_in["x"],
        "A_wqkv": _A_in["wqkv"],
        "A_w_phi": _A_in["w_phi"],
        "A_wo": _A_in["wo"],
        "B_x": _B_in["x"],
        "B_w1": _B_in["w1"],
        "B_w2": _B_in["w2"],
        "B_w3": _B_in["w3"],
        "B_w4": _B_in["w4"],
        "gate_w": _w((lambda *s: torch.randn(*s, dtype=torch.bfloat16) * 0.05)(448) * 16.0),
    }

def reference(A_x, A_wqkv, A_w_phi, A_wo, B_x, B_w1, B_w2, B_w3, B_w4, gate_w):
    def _A_ref(x, wqkv, w_phi, wo):
        B, S, D = x.shape
        H = 16; Dh = D // H
        qkv = (lambda x, *d: x.permute(*d))((x @ wqkv).reshape(B, S, 3, H, Dh), 2, 0, 3, 1, 4)
        q, k, v = qkv[0], qkv[1], qkv[2]
        pq = torch.einsum("bhsd,hdf->bhsf", q, w_phi)
        pk = torch.einsum("bhsd,hdf->bhsf", k, w_phi)
        phi_q = torch.concatenate([_softmax(pq, axis=-1), _softmax(-pq, axis=-1)], axis=-1)
        phi_k = torch.concatenate([_softmax(pk, axis=-1), _softmax(-pk, axis=-1)], axis=-1)
        kv = torch.einsum("bhsf,bhsd->bhfd", phi_k, v)
        z  = torch.einsum("bhsf->bhf", phi_k)
        num = torch.einsum("bhqf,bhfd->bhqd", phi_q, kv)
        den = torch.einsum("bhqf,bhf->bhq", phi_q, z)[..., None] + 1e-6
        o = num / den
        return (lambda x, *d: x.permute(*d))(o, 0, 2, 1, 3).reshape(B, S, D) @ wo

    def _B_ref(x, w1, w2, w3, w4):
        B, S, D = x.shape
        h = _gelu(_layernorm(x, axis=-1) @ w1)
        c = D // 4
        g0 = _pad(h[:, :, 0*c:1*c], ((0, 0), (1, 0), (0, 0)))[:, :S, :]
        g1 = _pad(h[:, :, 1*c:2*c], ((0, 0), (0, 1), (0, 0)))[:, 1:, :]
        g2 = _pad(h[:, :, 2*c:3*c], ((0, 0), (2, 0), (0, 0)))[:, :S, :]
        g3 = _pad(h[:, :, 3*c:   ], ((0, 0), (0, 2), (0, 0)))[:, 2:, :]
        hs = torch.concatenate([g0, g1, g2, g3], axis=-1) @ w2
        x1 = x + hs
        h2 = _gelu(_layernorm(x1, axis=-1) @ w3) @ w4
        return x1 + h2

    x = A_x
    g = _sigmoid((x * gate_w).sum(-1, keepdims=True))
    a = _A_ref(x, A_wqkv, A_w_phi, A_wo)
    b = _B_ref(x, B_w1, B_w2, B_w3, B_w4)
    return g * a + (1 - g) * b
```

```asm
; @launch kernel=p1_kernel grid=(256,1,1) block=(256,1,1) lds=163840
.amdgcn_target "amdgcn-amd-amdhsa--gfx950"
.text
.p2align 12
L_code_start:
.globl p1_kernel
.p2align 8
.type p1_kernel,@function
p1_kernel:
    s_cmp_ge_u32 s2, 256
    s_nop 0
    s_cbranch_scc1 L_exit
    s_load_dwordx16 s[16:31], s[0:1], 0
    s_load_dwordx8 s[32:39], s[0:1], 64
    s_load_dwordx2 s[40:41], s[0:1], 96
    s_getpc_b64 s[68:69]
L_pc0:
    s_sub_u32 s68, s68, L_pc0-L_code_start
    s_subb_u32 s69, s69, 0
    s_and_b32 s69, s69, 0xffff
    s_mov_b32 s70, L_code_end-L_code_start
    s_mov_b32 s71, 0x00020000
    s_lshr_b32 s5, s2, 3
    s_lshl_b32 s5, s5, 11
    v_lshl_add_u32 v255, v0, 7, s5
    v_cmp_gt_u32 vcc, 16, v0
    s_nop 1
    v_cndmask_b32 v255, -1, v255, vcc
    buffer_load_dword v254, v255, s[68:71], 0 offen
    v_lshrrev_b32 v4, 6, v0
    v_and_b32 v1, 63, v0
    v_readfirstlane_b32 s72, v4
    s_and_b32 s3, s2, 7
    s_lshr_b32 s4, s2, 3
    s_lshl_b32 s5, s3, 1
    s_and_b32 s6, s4, 1
    s_add_u32 s73, s5, s6
    s_lshr_b32 s74, s4, 1
    s_lshl_b32 s5, s3, 2
    s_and_b32 s7, s4, 3
    s_add_u32 s75, s5, s7
    s_lshr_b32 s76, s4, 2
    v_lshrrev_b32 v2, 4, v1
    v_and_b32 v3, 15, v1
    v_lshlrev_b32 v16, 4, v1
    s_mul_i32 s6, s6, 3
    s_add_u32 s6, s6, s3
    s_add_u32 s6, s6, s74
    s_sub_u32 s7, s6, 14
    s_cmp_ge_u32 s6, 14
    s_cselect_b32 s6, s7, s6
    s_sub_u32 s7, s6, 7
    s_cmp_ge_u32 s6, 7
    s_cselect_b32 s6, s7, s6
    s_sub_u32 s7, s6, 7
    s_cmp_ge_u32 s6, 7
    s_cselect_b32 s6, s7, s6
    s_lshl_b32 s5, s73, 3
    s_lshl_b32 s7, s72, 1
    s_add_u32 s77, s5, s7
    s_mul_i32 s78, s77, 14336
    v_lshrrev_b32 v4, 3, v1
    v_and_b32 v5, 7, v1
    v_xor_b32 v5, v5, v2
    s_movk_i32 s8, 896
    s_movk_i32 s9, 2688
    v_mul_u32_u24 v4, s8, v4
    v_lshl_add_u32 v4, v5, 4, v4
    v_add_u32 v246, s78, v4
    v_xor_b32 v4, 64, v246
    v_add_u32 v247, 6144, v4
    v_add_u32 v248, 12288, v246
    v_add_u32 v249, 12288, v247
    v_lshrrev_b32 v4, 2, v0
    v_and_b32 v5, 3, v1
    v_bfe_u32 v6, v1, 5, 1
    v_xor_b32 v5, v5, v6
    v_lshlrev_b32 v6, 4, v5
    s_lshl_b32 s5, s74, 6
    v_add_u32 v7, s5, v6
    v_mad_u32_u24 v18, v4, s8, v7
    v_cmp_eq_u32 vcc, 3, v5
    s_nop 1
    v_cndmask_b32 v17, v6, 40, vcc
    s_mul_i32 s5, s74, 56
    v_add_u32 v6, s5, v17
    v_mad_u32_u24 v19, v4, s9, v6
    s_lshl_b32 s84, s6, 7
    s_add_u32 s85, s84, 128
    s_cmp_eq_u32 s85, 896
    s_cselect_b32 s85, 0, s85
    s_lshl_b32 s90, s72, 10
    s_lshl_b32 s96, s72, 12
    s_add_u32 s96, s96, 86016
    s_add_u32 s86, s85, 128
    s_cmp_eq_u32 s86, 896
    s_cselect_b32 s86, 0, s86
    s_add_u32 s87, s86, 128
    s_cmp_eq_u32 s87, 896
    s_cselect_b32 s87, 0, s87
    s_add_u32 s88, s87, 128
    s_cmp_eq_u32 s88, 896
    s_cselect_b32 s88, 0, s88
    s_add_u32 s89, s88, 128
    s_cmp_eq_u32 s89, 896
    s_cselect_b32 s89, 0, s89
    s_add_u32 s43, s89, 128
    s_cmp_eq_u32 s43, 896
    s_cselect_b32 s43, 0, s43
    s_waitcnt lgkmcnt(0)
    s_mov_b32 s44, s16
    s_and_b32 s45, s17, 0xffff
    s_mov_b32 s46, 0x1c0000
    s_mov_b32 s47, 0x00020000
    s_cmp_ge_u32 s4, 28
    s_nop 0
    s_cbranch_scc1 L_side
    s_mov_b32 s48, s26
    s_and_b32 s49, s27, 0xffff
    s_mov_b32 s50, 0x62000
    s_mov_b32 s51, 0x00020000
    s_mul_i32 s42, s84, 448
    s_add_u32 m0, s90, 0
    s_nop 0
    buffer_load_dwordx4 v18, s[48:51], s42 offen lds
    s_add_u32 m0, s96, 0
    s_nop 0
    buffer_load_dwordx4 v246, s[44:47], s84 offen offset:0 lds
    buffer_load_dwordx4 v247, s[44:47], s84 offen offset:1024 lds
    buffer_load_dwordx4 v248, s[44:47], s84 offen offset:2048 lds
    buffer_load_dwordx4 v249, s[44:47], s84 offen offset:3072 lds
    s_mul_i32 s42, s85, 448
    s_add_u32 m0, s90, 4096
    s_nop 0
    buffer_load_dwordx4 v18, s[48:51], s42 offen lds
    s_add_u32 m0, s96, 16384
    s_nop 0
    buffer_load_dwordx4 v246, s[44:47], s85 offen offset:0 lds
    buffer_load_dwordx4 v247, s[44:47], s85 offen offset:1024 lds
    buffer_load_dwordx4 v248, s[44:47], s85 offen offset:2048 lds
    buffer_load_dwordx4 v249, s[44:47], s85 offen offset:3072 lds
    s_mov_b32 s52, s18
    s_and_b32 s53, s19, 0xffff
    s_mov_b32 s54, 0x126000
    s_mov_b32 s55, 0x00020000
    s_mov_b32 s56, s40
    s_and_b32 s57, s41, 0xffff
    s_mov_b32 s58, 0x4000000
    s_mov_b32 s59, 0x00020000
    s_lshl_b32 s5, s2, 2
    s_add_u32 s5, s5, s72
    s_lshl_b32 s91, s5, 7
    s_add_u32 s91, s91, 0x3c0000
    v_add_u32 v252, 896, v19
    v_add_u32 v253, 1792, v19
    v_lshrrev_b32 v4, 1, v3
    v_xor_b32 v4, v4, v2
    v_lshl_add_u32 v4, v4, 4, s96
    v_lshl_add_u32 v250, v3, 7, v4
    v_xor_b32 v251, 64, v250
    v_bfe_u32 v4, v1, 2, 2
    v_and_b32 v5, 3, v1
    v_lshl_add_u32 v6, v2, 3, v4
    v_lshlrev_b32 v6, 6, v6
    v_and_b32 v7, 1, v2
    v_xor_b32 v7, v7, v5
    v_lshl_add_u32 v6, v7, 4, v6
    v_and_b32 v7, 1, v5
    v_lshl_add_u32 v20, v7, 3, v6
    v_xor_b32 v21, 8, v20
    v_add_u32 v22, 57344, v20
    v_add_u32 v24, 114688, v20
    v_add_u32 v23, 57344, v21
    v_add_u32 v25, 114688, v21
    v_cmp_eq_u32 s[100:101], 3, v2
    s_mov_b32 s80, 0x3fb8aa3b
    s_mov_b32 s81, 0x3fb8aa3b
    s_mov_b32 s82, 0xbfb8aa3b
    s_mov_b32 s83, 0xbfb8aa3b
    v_mov_b32 v63, 1
    v_lshrrev_b32 v4, 3, v1
    v_and_b32 v5, 7, v1
    v_bfe_u32 v6, v4, 1, 1
    v_lshlrev_b32 v6, 2, v6
    v_xor_b32 v5, v5, v6
    v_lshlrev_b32 v5, 4, v5
    s_movk_i32 s8, 896
    s_movk_i32 s9, 3584
    s_and_b32 s10, s72, 1
    s_lshl_b32 s10, s10, 4
    v_xor_b32 v5, s10, v5
    v_mad_u32_u24 v30, v4, s9, v5
    v_mad_u32_u24 v57, v4, s8, v5
    v_bfe_u32 v4, v1, 2, 2
    v_and_b32 v5, 3, v1
    v_and_b32 v8, 1, v2
    v_lshl_add_u32 v6, v2, 3, v4
    v_lshl_add_u32 v6, v8, 2, v6
    v_lshlrev_b32 v6, 7, v6
    v_lshrrev_b32 v7, 1, v4
    v_lshlrev_b32 v7, 2, v7
    v_or_b32 v7, v7, v8
    v_xor_b32 v7, v7, v5
    v_lshl_add_u32 v6, v7, 4, v6
    v_and_b32 v7, 1, v5
    v_lshl_add_u32 v6, v7, 3, v6
    v_mov_b32 v32, v6
    v_add_u32 v40, 65536, v32
    v_add_u32 v48, 131072, v32
    v_xor_b32 v33, 512, v6
    v_add_u32 v41, 65536, v33
    v_add_u32 v49, 131072, v33
    v_xor_b32 v34, 8, v6
    v_add_u32 v42, 65536, v34
    v_add_u32 v50, 131072, v34
    v_xor_b32 v35, 520, v6
    v_add_u32 v43, 65536, v35
    v_add_u32 v51, 131072, v35
    v_xor_b32 v36, 64, v6
    v_add_u32 v44, 65536, v36
    v_add_u32 v52, 131072, v36
    v_xor_b32 v37, 576, v6
    v_add_u32 v45, 65536, v37
    v_add_u32 v53, 131072, v37
    v_xor_b32 v38, 72, v6
    v_add_u32 v46, 65536, v38
    v_add_u32 v54, 131072, v38
    v_xor_b32 v39, 584, v6
    v_add_u32 v47, 65536, v39
    v_add_u32 v55, 131072, v39
    v_lshrrev_b32 v4, 3, v1
    s_sub_u32 s8, s77, 1
    v_add_u32 v4, s8, v4
    v_and_b32 v6, 7, v1
    v_bfe_u32 v7, v4, 2, 2
    v_lshl_add_u32 v7, v6, 2, v7
    v_lshrrev_b32 v8, 4, v4
    v_lshl_add_u32 v7, v7, 3, v8
    v_and_b32 v8, 3, v4
    v_lshl_add_u32 v7, v7, 2, v8
    v_lshlrev_b32 v7, 7, v7
    v_add_u32 v26, 0x3c0000, v7
    s_lshr_b32 s8, 0x3c78, s74
    s_and_b32 s8, s8, 1
    s_mul_i32 s8, s8, 0x7f
    s_lshr_b32 s9, 0x78f, s74
    s_and_b32 s9, s9, 1
    s_mul_i32 s9, s9, 0x7f000000
    s_or_b32 s8, s8, s9
    s_or_b32 s8, s8, 0x7f7f00
    v_cmp_gt_u32 vcc, 128, v4
    s_and_b32 s26, s8, vcc_lo
    s_mov_b32 s27, 0
    s_add_u32 s9, s74, 224
    s_lshl_b32 s9, s9, 2
    s_add_u32 s9, s9, s72
    s_lshl_b32 s9, s9, 7
    s_add_u32 s9, s9, 0x3c001c
    v_lshl_add_u32 v31, v1, 13, s9
    v_mov_b32 v192, 0x3f803f80
    v_mov_b32 v193, 0x3f803f80
    v_mov_b32 v194, 0x3f803f80
    v_mov_b32 v195, 0x3f803f80
    s_mov_b32 s60, s28
    s_and_b32 s61, s29, 0xffff
    s_mov_b32 s62, 0x62000
    s_mov_b32 s63, 0x00020000
    s_mov_b32 s64, s30
    s_and_b32 s65, s31, 0xffff
    s_mov_b32 s66, 0x188000
    s_mov_b32 s67, 0x00020000
    s_mul_i32 s8, s72, 7168
    s_lshl_b32 s9, s76, 7
    s_add_u32 s93, s8, s9
    s_lshl_b32 s8, s76, 9
    s_lshl_b32 s9, s72, 7
    s_add_u32 s94, s8, s9
    s_and_b32 s8, s75, 3
    s_mul_i32 s9, s8, 7
    s_lshr_b32 s10, s9, 1
    s_add_u32 s10, s10, s3
    s_sub_u32 s11, s10, 14
    s_cselect_b32 s10, s10, s11
    s_lshl_b32 s35, s10, 10
    s_cmp_ge_u32 s10, 7
    s_cselect_b32 s11, 78848, 0
    s_add_u32 s35, s35, s11
    s_mul_i32 s10, s10, 114688
    s_add_u32 s94, s94, s10
    s_add_u32 s10, s9, 2
    s_lshr_b32 s10, s10, 2
    s_add_u32 s10, s10, s3
    s_sub_u32 s11, s10, 7
    s_cselect_b32 s10, s10, s11
    s_lshl_b32 s0, s10, 12
    s_mul_i32 s10, s8, 3
    s_lshr_b32 s10, s10, 1
    s_add_u32 s10, s10, s3
    s_sub_u32 s11, s10, 6
    s_cselect_b32 s1, s10, s11
    s_lshl_b32 s16, s72, 12
    s_lshl_b32 s17, s75, 2
    s_add_u32 s17, s17, s72
    s_and_b32 s10, s72, 1
    s_lshl_b32 s10, s10, 4
    v_xor_b32 v124, s10, v30
    v_xor_b32 v4, 16, v124
    v_add_u32 v125, 27648, v4
    v_add_u32 v126, 55296, v124
    v_add_u32 v127, 82944, v4
    s_and_b32 s8, s75, 3
    s_lshl_b32 s8, s8, 3
    s_add_u32 s8, s8, s3
    s_lshl_b32 s8, s8, 9
    s_add_u32 s8, s8, 0x3c0000
    s_lshl_b32 s9, s72, 7
    s_add_u32 s9, s9, s8
    s_add_u32 s9, s9, 4
    v_lshl_add_u32 v27, v1, 14, s9
    s_mov_b64 exec, 0
    s_cmp_eq_u32 s72, 1
    s_cbranch_scc1 L_hop2
    s_cmp_eq_u32 s72, 2
    s_cbranch_scc1 L_hop4
    s_cmp_eq_u32 s72, 3
    s_cbranch_scc1 L_hop6
    s_branch L_hop0
L_hret0:
L_hret1:
L_hret2:
L_hret3:
    s_mov_b64 exec, -1
    s_mul_i32 s42, s86, 448
    s_add_u32 m0, s90, 8192
    s_nop 0
    buffer_load_dwordx4 v18, s[48:51], s42 offen lds
    s_add_u32 m0, s96, 32768
    s_nop 0
    buffer_load_dwordx4 v246, s[44:47], s86 offen offset:0 lds
    buffer_load_dwordx4 v247, s[44:47], s86 offen offset:1024 lds
    buffer_load_dwordx4 v248, s[44:47], s86 offen offset:2048 lds
    buffer_load_dwordx4 v249, s[44:47], s86 offen offset:3072 lds
    s_mov_b32 s68, s20
    s_and_b32 s69, s21, 0xffff
    s_mov_b32 s70, 0x6200
    s_mov_b32 s71, 0x00020000
    v_lshrrev_b32 v4, 2, v1
    s_and_b32 s8, s72, 1
    s_lshl_b32 s9, s8, 4
    v_mov_b32 v5, v17
    v_add_u32 v4, s9, v4
    v_subrev_u32 v6, 4, v4
    v_cmp_le_u32 vcc, 28, v4
    s_nop 1
    v_cndmask_b32 v6, v4, v6, vcc
    v_mad_u32_u24 v5, v6, 56, v5
    v_subrev_u32 v4, 24, v4
    v_cmp_gt_u32 vcc, 4, v4
    v_mov_b32 v6, 0x7fffffff
    s_nop 0
    v_cndmask_b32 v5, v5, v6, vcc
    s_lshl_b32 s8, s8, 10
    s_add_u32 m0, s8, 159744
    s_mul_i32 s9, s74, 1568
    buffer_load_dwordx4 v5, s[68:71], s9 offen lds
    v_mov_b32 v104, -1
    v_mov_b32 v105, -1
    v_mov_b32 v106, -1
    v_mov_b32 v107, -1
    s_lshl_b32 s8, s74, 10
    s_add_u32 s18, s8, s78
    s_add_u32 s19, s18, 14336
    s_mul_i32 s20, s17, 14336
    s_lshl_b32 s7, s76, 11
    s_add_u32 s20, s20, s7
    s_add_u32 s20, s20, 0x200000
    v_lshrrev_b32 v108, 5, v1
    v_lshlrev_b32 v108, 2, v108
    v_lshl_add_u32 v108, v3, 6, v108
    s_lshl_b32 s21, s17, 10
    s_lshl_b32 s7, s76, 3
    s_add_u32 s21, s21, s7
    s_add_u32 s21, s21, 0x1c0000
    s_waitcnt vmcnt(11)
    ds_read_b128 a[0:3], v250 offset:0
    ds_read_b128 a[4:7], v250 offset:2048
    ds_read_b128 a[8:11], v251 offset:0
    ds_read_b128 a[12:15], v251 offset:2048
    s_barrier
    ds_read_b64_tr_b16 v[64:65], v20 offset:0
    ds_read_b64_tr_b16 v[66:67], v20 offset:256
    ds_read_b64_tr_b16 v[68:69], v21 offset:0
    ds_read_b64_tr_b16 v[70:71], v21 offset:256
    ds_read_b64_tr_b16 v[72:73], v20 offset:2048
    ds_read_b64_tr_b16 v[74:75], v20 offset:2304
    ds_read_b64_tr_b16 v[76:77], v21 offset:2048
    ds_read_b64_tr_b16 v[78:79], v21 offset:2304
    s_waitcnt lgkmcnt(8)
    v_mfma_f32_16x16x32_bf16 v[196:199], v[192:195], a[0:3], 0
    s_mul_i32 s42, s87, 448
    s_add_u32 m0, s90, 12288
    s_nop 0
    buffer_load_dwordx4 v18, s[48:51], s42 offen lds
    v_mfma_f32_16x16x32_bf16 v[204:207], a[0:3], a[0:3], 0
    buffer_store_dwordx4 v[104:107], v16, s[56:59], s18 offen sc1
    s_add_u32 m0, s96, 49152
    v_mfma_f32_16x16x32_bf16 v[200:203], v[192:195], a[4:7], 0
    buffer_load_dwordx4 v246, s[44:47], s87 offen offset:0 lds
    v_mfma_f32_16x16x32_bf16 v[208:211], a[4:7], a[4:7], 0
    v_mfma_f32_16x16x32_bf16 v[196:199], v[192:195], a[8:11], v[196:199]
    v_mfma_f32_16x16x32_bf16 v[204:207], a[8:11], a[8:11], v[204:207]
    buffer_load_dwordx4 v247, s[44:47], s87 offen offset:1024 lds
    v_mfma_f32_16x16x32_bf16 v[200:203], v[192:195], a[12:15], v[200:203]
    v_mfma_f32_16x16x32_bf16 v[208:211], a[12:15], a[12:15], v[208:211]
    s_waitcnt lgkmcnt(0)
    v_mfma_f32_16x16x32_bf16 v[128:131], v[64:67], a[0:3], 0
    v_mfma_f32_16x16x32_bf16 v[136:139], v[64:67], a[4:7], 0
    s_waitcnt vmcnt(10)
    ds_read_b128 a[16:19], v250 offset:16384
    v_mfma_f32_16x16x32_bf16 v[132:135], v[68:71], a[0:3], 0
    ds_read_b128 a[20:23], v250 offset:18432
    ds_read_b128 a[24:27], v251 offset:16384
    v_mfma_f32_16x16x32_bf16 v[140:143], v[68:71], a[4:7], 0
    ds_read_b128 a[28:31], v251 offset:18432
    s_barrier
    v_mfma_f32_16x16x32_bf16 v[212:215], v[64:67], v[192:195], 0
    ds_read_b64_tr_b16 v[80:81], v20 offset:4096
    ds_read_b64_tr_b16 v[82:83], v20 offset:4352
    v_mfma_f32_16x16x32_bf16 v[216:219], v[68:71], v[192:195], 0
    ds_read_b64_tr_b16 v[84:85], v21 offset:4096
    ds_read_b64_tr_b16 v[86:87], v21 offset:4352
    v_mfma_f32_16x16x32_bf16 v[128:131], v[72:75], a[8:11], v[128:131]
    ds_read_b64_tr_b16 v[88:89], v20 offset:6144
    ds_read_b64_tr_b16 v[90:91], v20 offset:6400
    v_mfma_f32_16x16x32_bf16 v[136:139], v[72:75], a[12:15], v[136:139]
    ds_read_b64_tr_b16 v[92:93], v21 offset:6144
    ds_read_b64_tr_b16 v[94:95], v21 offset:6400
    buffer_load_dwordx4 v248, s[44:47], s87 offen offset:2048 lds
    v_mfma_f32_16x16x32_bf16 v[132:135], v[76:79], a[8:11], v[132:135]
    buffer_store_dwordx4 v[104:107], v16, s[56:59], s19 offen sc1
    buffer_load_dwordx4 v249, s[44:47], s87 offen offset:3072 lds
    v_mfma_f32_16x16x32_bf16 v[140:143], v[76:79], a[12:15], v[140:143]
    v_mfma_f32_16x16x32_bf16 v[212:215], v[72:75], v[192:195], v[212:215]
    v_mfma_f32_16x16x32_bf16 v[216:219], v[76:79], v[192:195], v[216:219]
    s_waitcnt lgkmcnt(8)
    s_mul_i32 s42, s88, 448
    s_add_u32 m0, s90, 16384
    v_mfma_f32_16x16x32_bf16 v[196:199], v[192:195], a[16:19], v[196:199]
    buffer_load_dwordx4 v18, s[48:51], s42 offen lds
    v_mfma_f32_16x16x32_bf16 v[204:207], a[16:19], a[16:19], v[204:207]
    v_mfma_f32_16x16x32_bf16 v[200:203], v[192:195], a[20:23], v[200:203]
    v_mfma_f32_16x16x32_bf16 v[208:211], a[20:23], a[20:23], v[208:211]
    v_mfma_f32_16x16x32_bf16 v[196:199], v[192:195], a[24:27], v[196:199]
    s_add_u32 m0, s96, 0
    s_nop 0
    buffer_load_dwordx4 v246, s[44:47], s88 offen offset:0 lds
    v_mfma_f32_16x16x32_bf16 v[204:207], a[24:27], a[24:27], v[204:207]
    v_mfma_f32_16x16x32_bf16 v[200:203], v[192:195], a[28:31], v[200:203]
    v_mfma_f32_16x16x32_bf16 v[208:211], a[28:31], a[28:31], v[208:211]
    s_waitcnt lgkmcnt(0)
    v_mfma_f32_16x16x32_bf16 v[128:131], v[80:83], a[16:19], v[128:131]
    buffer_load_dwordx4 v247, s[44:47], s88 offen offset:1024 lds
    v_mfma_f32_16x16x32_bf16 v[136:139], v[80:83], a[20:23], v[136:139]
    s_waitcnt vmcnt(11)
    ds_read_b128 a[32:35], v250 offset:32768
    v_mfma_f32_16x16x32_bf16 v[132:135], v[84:87], a[16:19], v[132:135]
    ds_read_b128 a[36:39], v250 offset:34816
    ds_read_b128 a[40:43], v251 offset:32768
    v_mfma_f32_16x16x32_bf16 v[140:143], v[84:87], a[20:23], v[140:143]
    ds_read_b128 a[44:47], v251 offset:34816
    s_barrier
    v_mfma_f32_16x16x32_bf16 v[212:215], v[80:83], v[192:195], v[212:215]
    ds_read_b64_tr_b16 v[64:65], v20 offset:8192
    ds_read_b64_tr_b16 v[66:67], v20 offset:8448
    v_mfma_f32_16x16x32_bf16 v[216:219], v[84:87], v[192:195], v[216:219]
    ds_read_b64_tr_b16 v[68:69], v21 offset:8192
    ds_read_b64_tr_b16 v[70:71], v21 offset:8448
    v_mfma_f32_16x16x32_bf16 v[128:131], v[88:91], a[24:27], v[128:131]
    ds_read_b64_tr_b16 v[72:73], v20 offset:10240
    ds_read_b64_tr_b16 v[74:75], v20 offset:10496
    v_mfma_f32_16x16x32_bf16 v[136:139], v[88:91], a[28:31], v[136:139]
    ds_read_b64_tr_b16 v[76:77], v21 offset:10240
    ds_read_b64_tr_b16 v[78:79], v21 offset:10496
    v_mfma_f32_16x16x32_bf16 v[132:135], v[92:95], a[24:27], v[132:135]
    buffer_load_dwordx4 v248, s[44:47], s88 offen offset:2048 lds
    buffer_load_dwordx4 v249, s[44:47], s88 offen offset:3072 lds
    v_mfma_f32_16x16x32_bf16 v[140:143], v[92:95], a[28:31], v[140:143]
    v_mfma_f32_16x16x32_bf16 v[212:215], v[88:91], v[192:195], v[212:215]
    v_mfma_f32_16x16x32_bf16 v[216:219], v[92:95], v[192:195], v[216:219]
    s_waitcnt lgkmcnt(8)
    s_mul_i32 s42, s89, 448
    s_add_u32 m0, s90, 20480
    v_mfma_f32_16x16x32_bf16 v[196:199], v[192:195], a[32:35], v[196:199]
    buffer_load_dwordx4 v18, s[48:51], s42 offen lds
    v_mfma_f32_16x16x32_bf16 v[204:207], a[32:35], a[32:35], v[204:207]
    v_mfma_f32_16x16x32_bf16 v[200:203], v[192:195], a[36:39], v[200:203]
    v_mfma_f32_16x16x32_bf16 v[208:211], a[36:39], a[36:39], v[208:211]
    v_mfma_f32_16x16x32_bf16 v[196:199], v[192:195], a[40:43], v[196:199]
    s_add_u32 m0, s96, 16384
    s_nop 0
    buffer_load_dwordx4 v246, s[44:47], s89 offen offset:0 lds
    v_mfma_f32_16x16x32_bf16 v[204:207], a[40:43], a[40:43], v[204:207]
    v_mfma_f32_16x16x32_bf16 v[200:203], v[192:195], a[44:47], v[200:203]
    v_mfma_f32_16x16x32_bf16 v[208:211], a[44:47], a[44:47], v[208:211]
    s_waitcnt lgkmcnt(0)
    buffer_load_dwordx4 v247, s[44:47], s89 offen offset:1024 lds
    v_mfma_f32_16x16x32_bf16 v[128:131], v[64:67], a[32:35], v[128:131]
    v_mfma_f32_16x16x32_bf16 v[136:139], v[64:67], a[36:39], v[136:139]
    s_waitcnt vmcnt(8)
    ds_read_b128 a[48:51], v250 offset:49152
    v_mfma_f32_16x16x32_bf16 v[132:135], v[68:71], a[32:35], v[132:135]
    ds_read_b128 a[52:55], v250 offset:51200
    ds_read_b128 a[56:59], v251 offset:49152
    v_mfma_f32_16x16x32_bf16 v[140:143], v[68:71], a[36:39], v[140:143]
    ds_read_b128 a[60:63], v251 offset:51200
    s_barrier
    v_mfma_f32_16x16x32_bf16 v[212:215], v[64:67], v[192:195], v[212:215]
    ds_read_b64_tr_b16 v[80:81], v20 offset:12288
    ds_read_b64_tr_b16 v[82:83], v20 offset:12544
    v_mfma_f32_16x16x32_bf16 v[216:219], v[68:71], v[192:195], v[216:219]
    ds_read_b64_tr_b16 v[84:85], v21 offset:12288
    ds_read_b64_tr_b16 v[86:87], v21 offset:12544
    v_mfma_f32_16x16x32_bf16 v[128:131], v[72:75], a[40:43], v[128:131]
    ds_read_b64_tr_b16 v[88:89], v20 offset:14336
    ds_read_b64_tr_b16 v[90:91], v20 offset:14592
    v_mfma_f32_16x16x32_bf16 v[136:139], v[72:75], a[44:47], v[136:139]
    ds_read_b64_tr_b16 v[92:93], v21 offset:14336
    ds_read_b64_tr_b16 v[94:95], v21 offset:14592
    v_mfma_f32_16x16x32_bf16 v[132:135], v[76:79], a[40:43], v[132:135]
    buffer_load_dwordx4 v248, s[44:47], s89 offen offset:2048 lds
    buffer_load_dwordx4 v249, s[44:47], s89 offen offset:3072 lds
    v_mfma_f32_16x16x32_bf16 v[140:143], v[76:79], a[44:47], v[140:143]
    v_mfma_f32_16x16x32_bf16 v[212:215], v[72:75], v[192:195], v[212:215]
    v_mfma_f32_16x16x32_bf16 v[216:219], v[76:79], v[192:195], v[216:219]
    s_waitcnt lgkmcnt(8)
    s_mul_i32 s42, s43, 448
    s_add_u32 m0, s90, 24576
    v_mfma_f32_16x16x32_bf16 v[196:199], v[192:195], a[48:51], v[196:199]
    buffer_load_dwordx4 v18, s[48:51], s42 offen lds
    s_mov_b32 s68, s38
    s_and_b32 s69, s39, 0xffff
    s_mov_b32 s70, 0x100
    s_mov_b32 s71, 0x00020000
    v_mov_b32 v61, 252
    buffer_load_dword v61, v61, s[68:71], 0 offen sc1
    v_mfma_f32_16x16x32_bf16 v[204:207], a[48:51], a[48:51], v[204:207]
    v_mfma_f32_16x16x32_bf16 v[200:203], v[192:195], a[52:55], v[200:203]
    v_mfma_f32_16x16x32_bf16 v[208:211], a[52:55], a[52:55], v[208:211]
    s_add_u32 m0, s96, 32768
    s_nop 0
    buffer_load_dwordx4 v246, s[44:47], s43 offen offset:0 lds
    v_mfma_f32_16x16x32_bf16 v[196:199], v[192:195], a[56:59], v[196:199]
    v_mfma_f32_16x16x32_bf16 v[204:207], a[56:59], a[56:59], v[204:207]
    v_mfma_f32_16x16x32_bf16 v[200:203], v[192:195], a[60:63], v[200:203]
    v_mfma_f32_16x16x32_bf16 v[208:211], a[60:63], a[60:63], v[208:211]
    s_waitcnt lgkmcnt(0)
    buffer_load_dwordx4 v247, s[44:47], s43 offen offset:1024 lds
    v_mfma_f32_16x16x32_bf16 v[128:131], v[80:83], a[48:51], v[128:131]
    v_mfma_f32_16x16x32_bf16 v[136:139], v[80:83], a[52:55], v[136:139]
    s_waitcnt vmcnt(9)
    ds_read_b128 a[64:67], v250 offset:0
    v_mfma_f32_16x16x32_bf16 v[132:135], v[84:87], a[48:51], v[132:135]
    ds_read_b128 a[68:71], v250 offset:2048
    ds_read_b128 a[72:75], v251 offset:0
    v_mfma_f32_16x16x32_bf16 v[140:143], v[84:87], a[52:55], v[140:143]
    ds_read_b128 a[76:79], v251 offset:2048
    s_barrier
    v_mfma_f32_16x16x32_bf16 v[212:215], v[80:83], v[192:195], v[212:215]
    ds_read_b64_tr_b16 v[64:65], v20 offset:16384
    ds_read_b64_tr_b16 v[66:67], v20 offset:16640
    v_mfma_f32_16x16x32_bf16 v[216:219], v[84:87], v[192:195], v[216:219]
    ds_read_b64_tr_b16 v[68:69], v21 offset:16384
    ds_read_b64_tr_b16 v[70:71], v21 offset:16640
    v_mfma_f32_16x16x32_bf16 v[128:131], v[88:91], a[56:59], v[128:131]
    ds_read_b64_tr_b16 v[72:73], v20 offset:18432
    ds_read_b64_tr_b16 v[74:75], v20 offset:18688
    v_mfma_f32_16x16x32_bf16 v[136:139], v[88:91], a[60:63], v[136:139]
    ds_read_b64_tr_b16 v[76:77], v21 offset:18432
    ds_read_b64_tr_b16 v[78:79], v21 offset:18688
    v_mfma_f32_16x16x32_bf16 v[132:135], v[92:95], a[56:59], v[132:135]
    buffer_load_dwordx4 v248, s[44:47], s43 offen offset:2048 lds
    buffer_load_dwordx4 v249, s[44:47], s43 offen offset:3072 lds
    v_mfma_f32_16x16x32_bf16 v[140:143], v[92:95], a[60:63], v[140:143]
    s_mul_i32 s42, s84, 1344
    s_add_u32 m0, s90, 28672
    v_mfma_f32_16x16x32_bf16 v[212:215], v[88:91], v[192:195], v[212:215]
    buffer_load_dwordx4 v252, s[52:55], s42 offen lds
    v_mfma_f32_16x16x32_bf16 v[216:219], v[92:95], v[192:195], v[216:219]
    s_waitcnt lgkmcnt(8)
    v_mfma_f32_16x16x32_bf16 v[196:199], v[192:195], a[64:67], v[196:199]
    v_mfma_f32_16x16x32_bf16 v[204:207], a[64:67], a[64:67], v[204:207]
    v_mfma_f32_16x16x32_bf16 v[200:203], v[192:195], a[68:71], v[200:203]
    v_mfma_f32_16x16x32_bf16 v[208:211], a[68:71], a[68:71], v[208:211]
    v_mfma_f32_16x16x32_bf16 v[196:199], v[192:195], a[72:75], v[196:199]
    s_add_u32 m0, s90, 57344
    s_nop 0
    buffer_load_dwordx4 v253, s[52:55], s42 offen lds
    v_mfma_f32_16x16x32_bf16 v[204:207], a[72:75], a[72:75], v[204:207]
    v_mfma_f32_16x16x32_bf16 v[200:203], v[192:195], a[76:79], v[200:203]
    v_mfma_f32_16x16x32_bf16 v[208:211], a[76:79], a[76:79], v[208:211]
    s_waitcnt lgkmcnt(0)
    v_mfma_f32_16x16x32_bf16 v[128:131], v[64:67], a[64:67], v[128:131]
    v_mfma_f32_16x16x32_bf16 v[136:139], v[64:67], a[68:71], v[136:139]
    s_waitcnt vmcnt(8)
    ds_read_b128 a[80:83], v250 offset:16384
    v_mfma_f32_16x16x32_bf16 v[132:135], v[68:71], a[64:67], v[132:135]
    ds_read_b128 a[84:87], v250 offset:18432
    ds_read_b128 a[88:91], v251 offset:16384
    v_mfma_f32_16x16x32_bf16 v[140:143], v[68:71], a[68:71], v[140:143]
    ds_read_b128 a[92:95], v251 offset:18432
    s_barrier
    v_mfma_f32_16x16x32_bf16 v[212:215], v[64:67], v[192:195], v[212:215]
    ds_read_b64_tr_b16 v[80:81], v20 offset:20480
    ds_read_b64_tr_b16 v[82:83], v20 offset:20736
    v_mfma_f32_16x16x32_bf16 v[216:219], v[68:71], v[192:195], v[216:219]
    ds_read_b64_tr_b16 v[84:85], v21 offset:20480
    ds_read_b64_tr_b16 v[86:87], v21 offset:20736
    v_mfma_f32_16x16x32_bf16 v[128:131], v[72:75], a[72:75], v[128:131]
    ds_read_b64_tr_b16 v[88:89], v20 offset:22528
    ds_read_b64_tr_b16 v[90:91], v20 offset:22784
    v_mfma_f32_16x16x32_bf16 v[136:139], v[72:75], a[76:79], v[136:139]
    ds_read_b64_tr_b16 v[92:93], v21 offset:22528
    ds_read_b64_tr_b16 v[94:95], v21 offset:22784
    v_mfma_f32_16x16x32_bf16 v[132:135], v[76:79], a[72:75], v[132:135]
    s_mul_i32 s42, s85, 1344
    s_add_u32 m0, s90, 32768
    v_mfma_f32_16x16x32_bf16 v[140:143], v[76:79], a[76:79], v[140:143]
    buffer_load_dwordx4 v252, s[52:55], s42 offen lds
    v_mfma_f32_16x16x32_bf16 v[212:215], v[72:75], v[192:195], v[212:215]
    v_mfma_f32_16x16x32_bf16 v[216:219], v[76:79], v[192:195], v[216:219]
    s_waitcnt lgkmcnt(8)
    v_mfma_f32_16x16x32_bf16 v[196:199], v[192:195], a[80:83], v[196:199]
    s_add_u32 m0, s90, 61440
    s_nop 0
    buffer_load_dwordx4 v253, s[52:55], s42 offen lds
    v_mfma_f32_16x16x32_bf16 v[204:207], a[80:83], a[80:83], v[204:207]
    v_mfma_f32_16x16x32_bf16 v[200:203], v[192:195], a[84:87], v[200:203]
    v_mfma_f32_16x16x32_bf16 v[208:211], a[84:87], a[84:87], v[208:211]
    v_mfma_f32_16x16x32_bf16 v[196:199], v[192:195], a[88:91], v[196:199]
    v_mfma_f32_16x16x32_bf16 v[204:207], a[88:91], a[88:91], v[204:207]
    v_mfma_f32_16x16x32_bf16 v[200:203], v[192:195], a[92:95], v[200:203]
    v_mfma_f32_16x16x32_bf16 v[208:211], a[92:95], a[92:95], v[208:211]
    s_waitcnt lgkmcnt(0)
    v_mfma_f32_16x16x32_bf16 v[128:131], v[80:83], a[80:83], v[128:131]
    v_mfma_f32_16x16x32_bf16 v[136:139], v[80:83], a[84:87], v[136:139]
    s_waitcnt vmcnt(4)
    ds_read_b128 a[96:99], v250 offset:32768
    v_mfma_f32_16x16x32_bf16 v[132:135], v[84:87], a[80:83], v[132:135]
L_hop0:
    s_cbranch_execz L_hop1
    ds_read_b128 a[100:103], v250 offset:34816
    ds_read_b128 a[104:107], v251 offset:32768
    v_mfma_f32_16x16x32_bf16 v[140:143], v[84:87], a[84:87], v[140:143]
    ds_read_b128 a[108:111], v251 offset:34816
    s_barrier
    v_mfma_f32_16x16x32_bf16 v[212:215], v[80:83], v[192:195], v[212:215]
    ds_read_b64_tr_b16 v[64:65], v20 offset:24576
    ds_read_b64_tr_b16 v[66:67], v20 offset:24832
    v_mfma_f32_16x16x32_bf16 v[216:219], v[84:87], v[192:195], v[216:219]
    ds_read_b64_tr_b16 v[68:69], v21 offset:24576
    ds_read_b64_tr_b16 v[70:71], v21 offset:24832
    v_mfma_f32_16x16x32_bf16 v[128:131], v[88:91], a[88:91], v[128:131]
    ds_read_b64_tr_b16 v[72:73], v20 offset:26624
    ds_read_b64_tr_b16 v[74:75], v20 offset:26880
    v_mfma_f32_16x16x32_bf16 v[136:139], v[88:91], a[92:95], v[136:139]
    ds_read_b64_tr_b16 v[76:77], v21 offset:26624
    ds_read_b64_tr_b16 v[78:79], v21 offset:26880
    v_mfma_f32_16x16x32_bf16 v[132:135], v[92:95], a[88:91], v[132:135]
    s_mul_i32 s42, s86, 1344
    s_add_u32 m0, s90, 36864
    v_mfma_f32_16x16x32_bf16 v[140:143], v[92:95], a[92:95], v[140:143]
    buffer_load_dwordx4 v252, s[52:55], s42 offen lds
    s_add_u32 m0, s90, 65536
    v_mfma_f32_16x16x32_bf16 v[212:215], v[88:91], v[192:195], v[212:215]
    buffer_load_dwordx4 v253, s[52:55], s42 offen lds
    v_mfma_f32_16x16x32_bf16 v[216:219], v[92:95], v[192:195], v[216:219]
    s_waitcnt lgkmcnt(8)
    v_mfma_f32_16x16x32_bf16 v[196:199], v[192:195], a[96:99], v[196:199]
    v_mfma_f32_16x16x32_bf16 v[204:207], a[96:99], a[96:99], v[204:207]
    v_mfma_f32_16x16x32_bf16 v[200:203], v[192:195], a[100:103], v[200:203]
    v_mfma_f32_16x16x32_bf16 v[208:211], a[100:103], a[100:103], v[208:211]
    v_mfma_f32_16x16x32_bf16 v[196:199], v[192:195], a[104:107], v[196:199]
    v_mfma_f32_16x16x32_bf16 v[204:207], a[104:107], a[104:107], v[204:207]
    v_mfma_f32_16x16x32_bf16 v[200:203], v[192:195], a[108:111], v[200:203]
    s_mul_i32 s42, s87, 1344
    s_add_u32 m0, s90, 40960
    v_mfma_f32_16x16x32_bf16 v[208:211], a[108:111], a[108:111], v[208:211]
    s_waitcnt lgkmcnt(0)
    buffer_load_dwordx4 v252, s[52:55], s42 offen lds
    v_mfma_f32_16x16x32_bf16 v[128:131], v[64:67], a[96:99], v[128:131]
    v_mfma_f32_16x16x32_bf16 v[136:139], v[64:67], a[100:103], v[136:139]
    v_mfma_f32_16x16x32_bf16 v[132:135], v[68:71], a[96:99], v[132:135]
    v_mfma_f32_16x16x32_bf16 v[140:143], v[68:71], a[100:103], v[140:143]
    v_mfma_f32_16x16x32_bf16 v[212:215], v[64:67], v[192:195], v[212:215]
    v_mfma_f32_16x16x32_bf16 v[216:219], v[68:71], v[192:195], v[216:219]
    v_mfma_f32_16x16x32_bf16 v[128:131], v[72:75], a[104:107], v[128:131]
    v_mfma_f32_16x16x32_bf16 v[136:139], v[72:75], a[108:111], v[136:139]
    s_add_u32 m0, s90, 69632
    s_nop 0
    buffer_load_dwordx4 v253, s[52:55], s42 offen lds
    v_mfma_f32_16x16x32_bf16 v[132:135], v[76:79], a[104:107], v[132:135]
    v_mfma_f32_16x16x32_bf16 v[140:143], v[76:79], a[108:111], v[140:143]
    v_mfma_f32_16x16x32_bf16 v[212:215], v[72:75], v[192:195], v[212:215]
    v_mfma_f32_16x16x32_bf16 v[216:219], v[76:79], v[192:195], v[216:219]
    v_and_b32 v4, 3, v3
    v_cmp_eq_u32 s[10:11], 1, v4
    v_cmp_eq_u32 s[12:13], 2, v4
    v_cmp_eq_u32 s[14:15], 3, v4
    v_lshrrev_b32 v5, 2, v3
    v_lshl_add_u32 v5, v5, 4, v3
    v_lshlrev_b32 v5, 2, v5
    v_cndmask_b32 v6, v204, v205, s[10:11]
    v_cndmask_b32 v6, v6, v206, s[12:13]
    v_cndmask_b32 v6, v6, v207, s[14:15]
    v_cndmask_b32 v7, v208, v209, s[10:11]
    v_cndmask_b32 v7, v7, v210, s[12:13]
    v_cndmask_b32 v7, v7, v211, s[14:15]
    ds_bpermute_b32 v8, v5, v6
    ds_bpermute_b32 v9, v5, v7
    v_mul_f32 v64, 0xbb124925, v196
    v_mul_f32 v72, 0xbb124925, v200
    s_lshl_b32 s8, s74, 10
    s_add_u32 s8, s8, s78
    s_add_u32 s9, s8, 14336
    s_waitcnt lgkmcnt(0)
    v_mul_f32 v8, 0x3b124925, v8
    s_mul_i32 s42, s88, 1344
    s_add_u32 m0, s90, 45056
    s_nop 0
    buffer_load_dwordx4 v252, s[52:55], s42 offen lds
    v_mul_f32 v9, 0x3b124925, v9
    v_fma_f32 v8, -v64, v64, v8
    v_fma_f32 v9, -v72, v72, v9
    v_add_f32 v8, 0x3727c5ac, v8
    v_add_f32 v9, 0x3727c5ac, v9
    v_rsq_f32 v10, v8
    v_rsq_f32 v11, v9
    v_mul_f32 v66, v8, v10
    v_mul_f32 v74, v9, v11
    v_mul_f32 v68, 0xc0135761, v10
    v_mul_f32 v76, 0xc0135761, v11
    v_mul_f32 v8, v10, v10
    v_mul_f32 v9, v11, v11
    v_mul_f32 v8, 0xbdd2d3e8, v8
    v_mul_f32 v9, 0xbdd2d3e8, v9
    v_mul_f32 v70, v8, v10
    v_mul_f32 v78, v9, v11
    v_pk_fma_f32 v[128:129], v[212:213], v[64:65], v[128:129] op_sel_hi:[1,0,1]
    v_pk_fma_f32 v[136:137], v[212:213], v[72:73], v[136:137] op_sel_hi:[1,0,1]
    v_pk_fma_f32 v[130:131], v[214:215], v[64:65], v[130:131] op_sel_hi:[1,0,1]
    v_pk_fma_f32 v[138:139], v[214:215], v[72:73], v[138:139] op_sel_hi:[1,0,1]
    v_pk_fma_f32 v[132:133], v[216:217], v[64:65], v[132:133] op_sel_hi:[1,0,1]
    v_pk_fma_f32 v[140:141], v[216:217], v[72:73], v[140:141] op_sel_hi:[1,0,1]
    v_pk_fma_f32 v[134:135], v[218:219], v[64:65], v[134:135] op_sel_hi:[1,0,1]
    v_pk_fma_f32 v[142:143], v[218:219], v[72:73], v[142:143] op_sel_hi:[1,0,1]
    v_pk_mul_f32 v[80:81], v[128:129], v[128:129]
    s_add_u32 m0, s90, 73728
    s_nop 0
    buffer_load_dwordx4 v253, s[52:55], s42 offen lds
    v_pk_mul_f32 v[92:93], v[136:137], v[136:137]
    v_pk_mul_f32 v[82:83], v[130:131], v[130:131]
    v_pk_mul_f32 v[94:95], v[138:139], v[138:139]
    v_pk_mul_f32 v[84:85], v[132:133], v[132:133]
    v_pk_mul_f32 v[96:97], v[140:141], v[140:141]
    v_pk_mul_f32 v[86:87], v[134:135], v[134:135]
    v_pk_mul_f32 v[98:99], v[142:143], v[142:143]
    v_pk_fma_f32 v[80:81], v[80:81], v[70:71], v[68:69] op_sel_hi:[1,0,0]
    v_pk_fma_f32 v[92:93], v[92:93], v[78:79], v[76:77] op_sel_hi:[1,0,0]
    v_pk_fma_f32 v[82:83], v[82:83], v[70:71], v[68:69] op_sel_hi:[1,0,0]
    v_pk_fma_f32 v[94:95], v[94:95], v[78:79], v[76:77] op_sel_hi:[1,0,0]
    v_pk_fma_f32 v[84:85], v[84:85], v[70:71], v[68:69] op_sel_hi:[1,0,0]
    v_pk_fma_f32 v[96:97], v[96:97], v[78:79], v[76:77] op_sel_hi:[1,0,0]
    v_pk_fma_f32 v[86:87], v[86:87], v[70:71], v[68:69] op_sel_hi:[1,0,0]
    v_pk_fma_f32 v[98:99], v[98:99], v[78:79], v[76:77] op_sel_hi:[1,0,0]
    v_pk_mul_f32 v[80:81], v[80:81], v[128:129]
    v_pk_mul_f32 v[92:93], v[92:93], v[136:137]
    v_pk_mul_f32 v[82:83], v[82:83], v[130:131]
    v_pk_mul_f32 v[94:95], v[94:95], v[138:139]
    v_pk_mul_f32 v[84:85], v[84:85], v[132:133]
    v_pk_mul_f32 v[96:97], v[96:97], v[140:141]
    v_pk_mul_f32 v[86:87], v[86:87], v[134:135]
    v_pk_mul_f32 v[98:99], v[98:99], v[142:143]
    v_exp_f32 v80, v80
    v_exp_f32 v92, v92
    v_exp_f32 v81, v81
    v_exp_f32 v93, v93
    v_exp_f32 v82, v82
    s_mul_i32 s42, s89, 1344
    s_add_u32 m0, s90, 49152
    s_nop 0
    buffer_load_dwordx4 v252, s[52:55], s42 offen lds
    v_exp_f32 v94, v94
    v_exp_f32 v83, v83
    v_exp_f32 v95, v95
    v_exp_f32 v84, v84
    v_exp_f32 v96, v96
    v_exp_f32 v85, v85
    v_exp_f32 v97, v97
    v_exp_f32 v86, v86
    v_exp_f32 v98, v98
    v_exp_f32 v87, v87
    v_exp_f32 v99, v99
    v_pk_fma_f32 v[80:81], v[80:81], v[66:67], v[66:67] op_sel_hi:[1,0,0]
    v_pk_fma_f32 v[92:93], v[92:93], v[74:75], v[74:75] op_sel_hi:[1,0,0]
    v_pk_fma_f32 v[82:83], v[82:83], v[66:67], v[66:67] op_sel_hi:[1,0,0]
    v_pk_fma_f32 v[94:95], v[94:95], v[74:75], v[74:75] op_sel_hi:[1,0,0]
    v_pk_fma_f32 v[84:85], v[84:85], v[66:67], v[66:67] op_sel_hi:[1,0,0]
    v_pk_fma_f32 v[96:97], v[96:97], v[74:75], v[74:75] op_sel_hi:[1,0,0]
    v_pk_fma_f32 v[86:87], v[86:87], v[66:67], v[66:67] op_sel_hi:[1,0,0]
    v_pk_fma_f32 v[98:99], v[98:99], v[74:75], v[74:75] op_sel_hi:[1,0,0]
    v_rcp_f32 v80, v80
    s_add_u32 m0, s90, 77824
    s_nop 0
    buffer_load_dwordx4 v253, s[52:55], s42 offen lds
    v_rcp_f32 v92, v92
    v_rcp_f32 v81, v81
    v_rcp_f32 v93, v93
    v_rcp_f32 v82, v82
    v_rcp_f32 v94, v94
    v_rcp_f32 v83, v83
    v_rcp_f32 v95, v95
    v_rcp_f32 v84, v84
    v_rcp_f32 v96, v96
    v_rcp_f32 v85, v85
    v_rcp_f32 v97, v97
    v_rcp_f32 v86, v86
    v_rcp_f32 v98, v98
    v_rcp_f32 v87, v87
    v_rcp_f32 v99, v99
    v_pk_mul_f32 v[80:81], v[80:81], v[128:129]
    v_pk_mul_f32 v[92:93], v[92:93], v[136:137]
    v_pk_mul_f32 v[82:83], v[82:83], v[130:131]
    s_mul_i32 s42, s43, 1344
    s_add_u32 m0, s90, 53248
    s_nop 0
    buffer_load_dwordx4 v252, s[52:55], s42 offen lds
    v_pk_mul_f32 v[94:95], v[94:95], v[138:139]
    v_pk_mul_f32 v[84:85], v[84:85], v[132:133]
    v_pk_mul_f32 v[96:97], v[96:97], v[140:141]
    v_pk_mul_f32 v[86:87], v[86:87], v[134:135]
    v_pk_mul_f32 v[98:99], v[98:99], v[142:143]
    v_cvt_pk_bf16_f32 v88, v80, v81
    v_cvt_pk_bf16_f32 v100, v92, v93
    v_cvt_pk_bf16_f32 v89, v82, v83
    v_cvt_pk_bf16_f32 v101, v94, v95
    v_cvt_pk_bf16_f32 v90, v84, v85
    v_cvt_pk_bf16_f32 v102, v96, v97
    v_cvt_pk_bf16_f32 v91, v86, v87
    v_cvt_pk_bf16_f32 v103, v98, v99
    s_waitcnt vmcnt(30)
    buffer_store_dwordx4 v[88:91], v16, s[56:59], s8 offen sc1
    buffer_store_dwordx4 v[100:103], v16, s[56:59], s9 offen sc1
    s_waitcnt vmcnt(19)
    v_readfirstlane_b32 s8, v61
    s_cmp_ge_u32 s8, 32
    s_nop 3
    s_cbranch_scc1 L_root_ok_m
    s_mov_b32 s68, s38
    s_and_b32 s69, s39, 0xffff
    s_mov_b32 s70, 0x100
    s_mov_b32 s71, 0x00020000
    s_mov_b32 s9, 0
    v_mov_b32 v56, 252
    s_nop 4
L_root_poll_m:
    buffer_load_dword v59, v56, s[68:71], 0 offen sc1
    s_add_u32 s9, s9, 1
    s_waitcnt vmcnt(0)
    v_readfirstlane_b32 s8, v59
    s_cmp_ge_u32 s8, 32
    s_nop 3
    s_cbranch_scc1 L_root_ok_m
    s_cmp_lt_u32 s9, 20000
    s_nop 0
    s_cbranch_scc1 L_root_poll_m
    s_nop 0
L_root_ok_m:
    s_mov_b64 exec, s[26:27]
    buffer_atomic_add v63, v26, s[56:59], 0 offen offset:0 sc1
    s_mov_b64 exec, -1
    s_waitcnt vmcnt(14)
    s_barrier
    ds_read_b64_tr_b16 v[64:65], v20 offset:28672
    ds_read_b64_tr_b16 v[66:67], v20 offset:28928
    ds_read_b64_tr_b16 v[68:69], v21 offset:28672
    ds_read_b64_tr_b16 v[70:71], v21 offset:28928
    ds_read_b64_tr_b16 v[72:73], v22 offset:0
    ds_read_b64_tr_b16 v[74:75], v22 offset:256
    ds_read_b64_tr_b16 v[76:77], v23 offset:0
    ds_read_b64_tr_b16 v[78:79], v23 offset:256
    s_waitcnt lgkmcnt(0)
    v_mfma_f32_16x16x32_bf16 v[144:147], v[64:67], a[0:3], 0
    ds_read_b64_tr_b16 v[80:81], v20 offset:30720
    ds_read_b64_tr_b16 v[82:83], v20 offset:30976
    v_mfma_f32_16x16x32_bf16 v[152:155], v[64:67], a[4:7], 0
    ds_read_b64_tr_b16 v[84:85], v21 offset:30720
    ds_read_b64_tr_b16 v[86:87], v21 offset:30976
    v_mfma_f32_16x16x32_bf16 v[148:151], v[68:71], a[0:3], 0
    ds_read_b64_tr_b16 v[88:89], v22 offset:2048
    ds_read_b64_tr_b16 v[90:91], v22 offset:2304
    v_mfma_f32_16x16x32_bf16 v[156:159], v[68:71], a[4:7], 0
    ds_read_b64_tr_b16 v[92:93], v23 offset:2048
    ds_read_b64_tr_b16 v[94:95], v23 offset:2304
    v_mfma_f32_16x16x32_bf16 v[160:163], v[72:75], a[0:3], 0
    s_mov_b32 s48, s40
    s_and_b32 s49, s41, 0xffff
    s_mul_i32 s42, s43, 1344
    v_mfma_f32_16x16x32_bf16 v[168:171], v[72:75], a[4:7], 0
    s_mov_b32 s50, 0x1c0000
    s_mov_b32 s51, 0x00020000
    s_add_u32 m0, s90, 81920
    v_mfma_f32_16x16x32_bf16 v[164:167], v[76:79], a[0:3], 0
    s_mul_i32 s6, s17, 14336
    v_lshl_add_u32 v10, v2, 8, s6
    v_mfma_f32_16x16x32_bf16 v[172:175], v[76:79], a[4:7], 0
    s_waitcnt lgkmcnt(0)
    buffer_load_dwordx4 v253, s[52:55], s42 offen lds
    v_mfma_f32_16x16x32_bf16 v[144:147], v[80:83], a[8:11], v[144:147]
    s_waitcnt vmcnt(13)
    s_barrier
    ds_read_b64_tr_b16 v[64:65], v20 offset:32768
    s_mul_i32 s42, s0, 7
    s_add_u32 s42, s42, s93
    s_add_u32 m0, s90, s0
    s_nop 0
    buffer_load_dwordx4 v57, s[60:63], s42 offen lds
    ds_read_b64_tr_b16 v[66:67], v20 offset:33024
    v_mfma_f32_16x16x32_bf16 v[152:155], v[80:83], a[12:15], v[152:155]
    ds_read_b64_tr_b16 v[68:69], v21 offset:32768
    ds_read_b64_tr_b16 v[70:71], v21 offset:33024
    v_mfma_f32_16x16x32_bf16 v[148:151], v[84:87], a[8:11], v[148:151]
    ds_read_b64_tr_b16 v[72:73], v22 offset:4096
    ds_read_b64_tr_b16 v[74:75], v22 offset:4352
    v_mfma_f32_16x16x32_bf16 v[156:159], v[84:87], a[12:15], v[156:159]
    ds_read_b64_tr_b16 v[76:77], v23 offset:4096
    ds_read_b64_tr_b16 v[78:79], v23 offset:4352
    v_mfma_f32_16x16x32_bf16 v[160:163], v[88:91], a[8:11], v[160:163]
    v_cmp_le_u32 vcc, 2, v2
    v_add_u32 v5, -1, v3
    v_mfma_f32_16x16x32_bf16 v[168:171], v[88:91], a[12:15], v[168:171]
    v_ashrrev_i32 v6, 4, v5
    v_and_b32 v5, 15, v5
    v_mfma_f32_16x16x32_bf16 v[164:167], v[92:95], a[8:11], v[164:167]
    v_mul_i32_i24 v6, 14336, v6
    v_lshl_add_u32 v5, v5, 4, v6
    v_mfma_f32_16x16x32_bf16 v[172:175], v[92:95], a[12:15], v[172:175]
    s_waitcnt lgkmcnt(0)
    s_mul_i32 s42, s0, 7
    s_add_u32 s42, s42, s93
    v_mfma_f32_16x16x32_bf16 v[144:147], v[64:67], a[16:19], v[144:147]
    ds_read_b64_tr_b16 v[80:81], v20 offset:34816
    ds_read_b64_tr_b16 v[82:83], v20 offset:35072
    v_mfma_f32_16x16x32_bf16 v[152:155], v[64:67], a[20:23], v[152:155]
    ds_read_b64_tr_b16 v[84:85], v21 offset:34816
    ds_read_b64_tr_b16 v[86:87], v21 offset:35072
    v_mfma_f32_16x16x32_bf16 v[148:151], v[68:71], a[16:19], v[148:151]
    ds_read_b64_tr_b16 v[88:89], v22 offset:6144
    ds_read_b64_tr_b16 v[90:91], v22 offset:6400
    v_mfma_f32_16x16x32_bf16 v[156:159], v[68:71], a[20:23], v[156:159]
    ds_read_b64_tr_b16 v[92:93], v23 offset:6144
    ds_read_b64_tr_b16 v[94:95], v23 offset:6400
    v_mfma_f32_16x16x32_bf16 v[160:163], v[72:75], a[16:19], v[160:163]
    v_add_u32 v5, v5, v10
    v_add_u32 v128, 0, v5
    s_add_u32 m0, m0, 86016
    s_add_u32 s42, s42, 200704
    v_mfma_f32_16x16x32_bf16 v[168:171], v[72:75], a[20:23], v[168:171]
    v_add_u32 v129, 1024, v5
    v_add_u32 v130, 2048, v5
    buffer_load_dwordx4 v57, s[60:63], s42 offen lds
    v_mfma_f32_16x16x32_bf16 v[164:167], v[76:79], a[16:19], v[164:167]
    v_cndmask_b32 v5, -1, 1, vcc
    v_add_u32 v5, v5, v3
    v_mfma_f32_16x16x32_bf16 v[172:175], v[76:79], a[20:23], v[172:175]
    s_waitcnt lgkmcnt(0)
    v_mfma_f32_16x16x32_bf16 v[144:147], v[80:83], a[24:27], v[144:147]
    s_waitcnt vmcnt(13)
    s_barrier
    ds_read_b64_tr_b16 v[64:65], v20 offset:36864
    s_add_u32 s0, s0, 4096
    s_cmp_eq_u32 s0, 28672
    s_cselect_b32 s0, 0, s0
    ds_read_b64_tr_b16 v[66:67], v20 offset:37120
    s_mul_i32 s42, s0, 7
    s_add_u32 s42, s42, s93
    s_add_u32 m0, s90, s0
    s_nop 0
    buffer_load_dwordx4 v57, s[60:63], s42 offen lds
    v_mfma_f32_16x16x32_bf16 v[152:155], v[80:83], a[28:31], v[152:155]
    ds_read_b64_tr_b16 v[68:69], v21 offset:36864
    ds_read_b64_tr_b16 v[70:71], v21 offset:37120
    v_mfma_f32_16x16x32_bf16 v[148:151], v[84:87], a[24:27], v[148:151]
    ds_read_b64_tr_b16 v[72:73], v22 offset:8192
    ds_read_b64_tr_b16 v[74:75], v22 offset:8448
    v_mfma_f32_16x16x32_bf16 v[156:159], v[84:87], a[28:31], v[156:159]
    ds_read_b64_tr_b16 v[76:77], v23 offset:8192
    ds_read_b64_tr_b16 v[78:79], v23 offset:8448
    s_mul_i32 s42, s0, 7
    s_add_u32 s42, s42, s93
    v_mfma_f32_16x16x32_bf16 v[160:163], v[88:91], a[24:27], v[160:163]
    v_ashrrev_i32 v6, 4, v5
    v_and_b32 v5, 15, v5
    s_add_u32 m0, m0, 86016
    s_add_u32 s42, s42, 200704
    v_mfma_f32_16x16x32_bf16 v[168:171], v[88:91], a[28:31], v[168:171]
    v_mul_i32_i24 v6, 14336, v6
    v_lshl_add_u32 v5, v5, 4, v6
    buffer_load_dwordx4 v57, s[60:63], s42 offen lds
    v_mfma_f32_16x16x32_bf16 v[164:167], v[92:95], a[24:27], v[164:167]
    v_add_u32 v5, v5, v10
    v_add_u32 v131, 3072, v5
    v_mfma_f32_16x16x32_bf16 v[172:175], v[92:95], a[28:31], v[172:175]
    s_waitcnt lgkmcnt(0)
    v_mfma_f32_16x16x32_bf16 v[144:147], v[64:67], a[32:35], v[144:147]
    ds_read_b64_tr_b16 v[80:81], v20 offset:38912
    ds_read_b64_tr_b16 v[82:83], v20 offset:39168
    v_mfma_f32_16x16x32_bf16 v[152:155], v[64:67], a[36:39], v[152:155]
    ds_read_b64_tr_b16 v[84:85], v21 offset:38912
    ds_read_b64_tr_b16 v[86:87], v21 offset:39168
    v_mfma_f32_16x16x32_bf16 v[148:151], v[68:71], a[32:35], v[148:151]
    ds_read_b64_tr_b16 v[88:89], v22 offset:10240
    ds_read_b64_tr_b16 v[90:91], v22 offset:10496
    v_mfma_f32_16x16x32_bf16 v[156:159], v[68:71], a[36:39], v[156:159]
    ds_read_b64_tr_b16 v[92:93], v23 offset:10240
    ds_read_b64_tr_b16 v[94:95], v23 offset:10496
    v_mfma_f32_16x16x32_bf16 v[160:163], v[72:75], a[32:35], v[160:163]
    v_add_u32 v5, 1, v3
    v_ashrrev_i32 v6, 4, v5
    v_mfma_f32_16x16x32_bf16 v[168:171], v[72:75], a[36:39], v[168:171]
    v_and_b32 v5, 15, v5
    v_mul_i32_i24 v6, 14336, v6
    v_mfma_f32_16x16x32_bf16 v[164:167], v[76:79], a[32:35], v[164:167]
    v_lshl_add_u32 v5, v5, 4, v6
    v_add_u32 v5, v5, v10
    v_mfma_f32_16x16x32_bf16 v[172:175], v[76:79], a[36:39], v[172:175]
    s_waitcnt lgkmcnt(0)
    s_add_u32 s0, s0, 4096
    s_cmp_eq_u32 s0, 28672
    s_cselect_b32 s0, 0, s0
    s_mul_i32 s42, s0, 7
    v_mfma_f32_16x16x32_bf16 v[144:147], v[80:83], a[40:43], v[144:147]
    s_waitcnt vmcnt(13)
    s_barrier
    ds_read_b64_tr_b16 v[64:65], v20 offset:40960
    s_add_u32 s42, s42, s93
    s_add_u32 m0, s90, s0
    s_nop 0
    buffer_load_dwordx4 v57, s[60:63], s42 offen lds
    ds_read_b64_tr_b16 v[66:67], v20 offset:41216
    s_mul_i32 s42, s0, 7
    s_add_u32 s42, s42, s93
    s_add_u32 m0, m0, 86016
    s_add_u32 s42, s42, 200704
    buffer_load_dwordx4 v57, s[60:63], s42 offen lds
    s_add_u32 s0, s0, 4096
    s_cmp_eq_u32 s0, 28672
    s_cselect_b32 s0, 0, s0
    v_mfma_f32_16x16x32_bf16 v[152:155], v[80:83], a[44:47], v[152:155]
    ds_read_b64_tr_b16 v[68:69], v21 offset:40960
    ds_read_b64_tr_b16 v[70:71], v21 offset:41216
    v_mfma_f32_16x16x32_bf16 v[148:151], v[84:87], a[40:43], v[148:151]
    ds_read_b64_tr_b16 v[72:73], v22 offset:12288
    ds_read_b64_tr_b16 v[74:75], v22 offset:12544
    v_mfma_f32_16x16x32_bf16 v[156:159], v[84:87], a[44:47], v[156:159]
    ds_read_b64_tr_b16 v[76:77], v23 offset:12288
    ds_read_b64_tr_b16 v[78:79], v23 offset:12544
    v_mfma_f32_16x16x32_bf16 v[160:163], v[88:91], a[40:43], v[160:163]
    v_add_u32 v132, 4096, v5
    v_add_u32 v133, 5120, v5
    v_mfma_f32_16x16x32_bf16 v[168:171], v[88:91], a[44:47], v[168:171]
    v_add_u32 v134, 6144, v5
    v_add_u32 v5, -2, v3
    s_mul_i32 s42, s0, 7
    s_add_u32 s42, s42, s93
    v_mfma_f32_16x16x32_bf16 v[164:167], v[92:95], a[40:43], v[164:167]
    v_ashrrev_i32 v6, 4, v5
    v_and_b32 v5, 15, v5
    s_add_u32 m0, s90, s0
    s_nop 0
    buffer_load_dwordx4 v57, s[60:63], s42 offen lds
    v_mfma_f32_16x16x32_bf16 v[172:175], v[92:95], a[44:47], v[172:175]
    s_waitcnt lgkmcnt(0)
    s_mul_i32 s42, s0, 7
    s_add_u32 s42, s42, s93
    v_mfma_f32_16x16x32_bf16 v[144:147], v[64:67], a[48:51], v[144:147]
    ds_read_b64_tr_b16 v[80:81], v20 offset:43008
    ds_read_b64_tr_b16 v[82:83], v20 offset:43264
    v_mfma_f32_16x16x32_bf16 v[152:155], v[64:67], a[52:55], v[152:155]
    ds_read_b64_tr_b16 v[84:85], v21 offset:43008
    ds_read_b64_tr_b16 v[86:87], v21 offset:43264
    s_add_u32 m0, m0, 86016
    s_add_u32 s42, s42, 200704
    v_mfma_f32_16x16x32_bf16 v[148:151], v[68:71], a[48:51], v[148:151]
    ds_read_b64_tr_b16 v[88:89], v22 offset:14336
    ds_read_b64_tr_b16 v[90:91], v22 offset:14592
    buffer_load_dwordx4 v57, s[60:63], s42 offen lds
    v_mfma_f32_16x16x32_bf16 v[156:159], v[68:71], a[52:55], v[156:159]
    ds_read_b64_tr_b16 v[92:93], v23 offset:14336
    ds_read_b64_tr_b16 v[94:95], v23 offset:14592
    v_mfma_f32_16x16x32_bf16 v[160:163], v[72:75], a[48:51], v[160:163]
    v_mul_i32_i24 v6, 14336, v6
    v_lshl_add_u32 v5, v5, 4, v6
    v_mfma_f32_16x16x32_bf16 v[168:171], v[72:75], a[52:55], v[168:171]
    v_add_u32 v5, v5, v10
    v_add_u32 v135, 7168, v5
    v_mfma_f32_16x16x32_bf16 v[164:167], v[76:79], a[48:51], v[164:167]
    v_add_u32 v136, 8192, v5
    v_add_u32 v137, 9216, v5
    v_mfma_f32_16x16x32_bf16 v[172:175], v[76:79], a[52:55], v[172:175]
    s_waitcnt lgkmcnt(0)
    s_add_u32 s0, s0, 4096
    s_cmp_eq_u32 s0, 28672
    s_cselect_b32 s0, 0, s0
    s_mul_i32 s42, s0, 7
    v_mfma_f32_16x16x32_bf16 v[144:147], v[80:83], a[56:59], v[144:147]
    s_waitcnt vmcnt(15)
    s_barrier
    ds_read_b64_tr_b16 v[64:65], v20 offset:45056
    s_add_u32 s42, s42, s93
    s_add_u32 m0, s90, s0
    s_nop 0
    buffer_load_dwordx4 v57, s[60:63], s42 offen lds
    ds_read_b64_tr_b16 v[66:67], v20 offset:45312
    s_mul_i32 s42, s0, 7
    s_add_u32 s42, s42, s93
    s_add_u32 m0, m0, 86016
    s_add_u32 s42, s42, 200704
    buffer_load_dwordx4 v57, s[60:63], s42 offen lds
    s_add_u32 s0, s0, 4096
    s_cmp_eq_u32 s0, 28672
    s_cselect_b32 s0, 0, s0
    v_mfma_f32_16x16x32_bf16 v[152:155], v[80:83], a[60:63], v[152:155]
    ds_read_b64_tr_b16 v[68:69], v21 offset:45056
    ds_read_b64_tr_b16 v[70:71], v21 offset:45312
    v_mfma_f32_16x16x32_bf16 v[148:151], v[84:87], a[56:59], v[148:151]
    ds_read_b64_tr_b16 v[72:73], v22 offset:16384
    ds_read_b64_tr_b16 v[74:75], v22 offset:16640
    v_mfma_f32_16x16x32_bf16 v[156:159], v[84:87], a[60:63], v[156:159]
    ds_read_b64_tr_b16 v[76:77], v23 offset:16384
    ds_read_b64_tr_b16 v[78:79], v23 offset:16640
    v_mfma_f32_16x16x32_bf16 v[160:163], v[88:91], a[56:59], v[160:163]
    v_cndmask_b32 v5, -2, 2, vcc
    v_add_u32 v5, v5, v3
    v_mfma_f32_16x16x32_bf16 v[168:171], v[88:91], a[60:63], v[168:171]
    v_ashrrev_i32 v6, 4, v5
    v_and_b32 v5, 15, v5
    s_mul_i32 s42, s0, 7
    s_add_u32 s42, s42, s93
    v_mfma_f32_16x16x32_bf16 v[164:167], v[92:95], a[56:59], v[164:167]
    v_mul_i32_i24 v6, 14336, v6
    v_lshl_add_u32 v5, v5, 4, v6
    s_add_u32 m0, s90, s0
    s_nop 0
    buffer_load_dwordx4 v57, s[60:63], s42 offen lds
    v_mfma_f32_16x16x32_bf16 v[172:175], v[92:95], a[60:63], v[172:175]
    s_waitcnt lgkmcnt(0)
    s_mul_i32 s42, s0, 7
    s_add_u32 s42, s42, s93
    v_mfma_f32_16x16x32_bf16 v[144:147], v[64:67], a[64:67], v[144:147]
    ds_read_b64_tr_b16 v[80:81], v20 offset:47104
    ds_read_b64_tr_b16 v[82:83], v20 offset:47360
    v_mfma_f32_16x16x32_bf16 v[152:155], v[64:67], a[68:71], v[152:155]
    ds_read_b64_tr_b16 v[84:85], v21 offset:47104
    ds_read_b64_tr_b16 v[86:87], v21 offset:47360
    s_add_u32 m0, m0, 86016
    s_add_u32 s42, s42, 200704
    v_mfma_f32_16x16x32_bf16 v[148:151], v[68:71], a[64:67], v[148:151]
    ds_read_b64_tr_b16 v[88:89], v22 offset:18432
    ds_read_b64_tr_b16 v[90:91], v22 offset:18688
    buffer_load_dwordx4 v57, s[60:63], s42 offen lds
    v_mfma_f32_16x16x32_bf16 v[156:159], v[68:71], a[68:71], v[156:159]
    ds_read_b64_tr_b16 v[92:93], v23 offset:18432
    ds_read_b64_tr_b16 v[94:95], v23 offset:18688
    v_mfma_f32_16x16x32_bf16 v[160:163], v[72:75], a[64:67], v[160:163]
    v_add_u32 v5, v5, v10
    v_add_u32 v138, 10240, v5
    v_mfma_f32_16x16x32_bf16 v[168:171], v[72:75], a[68:71], v[168:171]
    v_add_u32 v5, 2, v3
    v_ashrrev_i32 v6, 4, v5
    v_mfma_f32_16x16x32_bf16 v[164:167], v[76:79], a[64:67], v[164:167]
    v_and_b32 v5, 15, v5
    v_mul_i32_i24 v6, 14336, v6
    v_mfma_f32_16x16x32_bf16 v[172:175], v[76:79], a[68:71], v[172:175]
    s_waitcnt lgkmcnt(0)
    s_add_u32 s0, s0, 4096
    s_cmp_eq_u32 s0, 28672
    s_cselect_b32 s0, 0, s0
    s_mul_i32 s42, s0, 7
    v_mfma_f32_16x16x32_bf16 v[144:147], v[80:83], a[72:75], v[144:147]
    s_waitcnt vmcnt(17)
    s_barrier
    ds_read_b64_tr_b16 v[64:65], v20 offset:49152
    s_add_u32 s42, s42, s93
    s_add_u32 m0, s90, s0
    s_nop 0
    buffer_load_dwordx4 v57, s[60:63], s42 offen lds
    ds_read_b64_tr_b16 v[66:67], v20 offset:49408
    s_mul_i32 s42, s0, 7
    s_add_u32 s42, s42, s93
    s_add_u32 m0, m0, 86016
    s_add_u32 s42, s42, 200704
    buffer_load_dwordx4 v57, s[60:63], s42 offen lds
    v_mfma_f32_16x16x32_bf16 v[152:155], v[80:83], a[76:79], v[152:155]
    ds_read_b64_tr_b16 v[68:69], v21 offset:49152
    ds_read_b64_tr_b16 v[70:71], v21 offset:49408
    v_mfma_f32_16x16x32_bf16 v[148:151], v[84:87], a[72:75], v[148:151]
    ds_read_b64_tr_b16 v[72:73], v22 offset:20480
    ds_read_b64_tr_b16 v[74:75], v22 offset:20736
    v_mfma_f32_16x16x32_bf16 v[156:159], v[84:87], a[76:79], v[156:159]
    ds_read_b64_tr_b16 v[76:77], v23 offset:20480
    ds_read_b64_tr_b16 v[78:79], v23 offset:20736
    v_mfma_f32_16x16x32_bf16 v[160:163], v[88:91], a[72:75], v[160:163]
    v_lshl_add_u32 v5, v5, 4, v6
    v_add_u32 v5, v5, v10
    v_mfma_f32_16x16x32_bf16 v[168:171], v[88:91], a[76:79], v[168:171]
    v_add_u32 v139, 11264, v5
    v_add_u32 v140, 12288, v5
    s_mul_i32 s42, s84, 1344
    s_add_u32 m0, s90, 131072
    v_mfma_f32_16x16x32_bf16 v[164:167], v[92:95], a[72:75], v[164:167]
    v_add_u32 v141, 13312, v5
    v_mul_u32_u24 v12, 896, v3
    buffer_load_dwordx4 v19, s[52:55], s42 offen lds
    v_mfma_f32_16x16x32_bf16 v[172:175], v[92:95], a[76:79], v[172:175]
    s_waitcnt lgkmcnt(0)
    s_mul_i32 s42, s85, 1344
    s_add_u32 m0, s90, 135168
    v_mfma_f32_16x16x32_bf16 v[144:147], v[64:67], a[80:83], v[144:147]
    ds_read_b64_tr_b16 v[80:81], v20 offset:51200
    ds_read_b64_tr_b16 v[82:83], v20 offset:51456
    v_mfma_f32_16x16x32_bf16 v[152:155], v[64:67], a[84:87], v[152:155]
    ds_read_b64_tr_b16 v[84:85], v21 offset:51200
    ds_read_b64_tr_b16 v[86:87], v21 offset:51456
    v_mfma_f32_16x16x32_bf16 v[148:151], v[68:71], a[80:83], v[148:151]
    ds_read_b64_tr_b16 v[88:89], v22 offset:22528
    ds_read_b64_tr_b16 v[90:91], v22 offset:22784
    v_mfma_f32_16x16x32_bf16 v[156:159], v[68:71], a[84:87], v[156:159]
    ds_read_b64_tr_b16 v[92:93], v23 offset:22528
    ds_read_b64_tr_b16 v[94:95], v23 offset:22784
    v_mfma_f32_16x16x32_bf16 v[160:163], v[72:75], a[80:83], v[160:163]
    v_lshl_add_u32 v12, v2, 4, v12
    v_and_b32 v13, 1, v2
    v_mfma_f32_16x16x32_bf16 v[168:171], v[72:75], a[84:87], v[168:171]
    v_lshl_add_u32 v12, v13, 3, v12
    v_xor_b32 v13, 8, v12
    v_mfma_f32_16x16x32_bf16 v[164:167], v[76:79], a[80:83], v[164:167]
    s_lshl_b32 s7, s76, 7
    s_add_u32 s95, s6, s7
    v_mfma_f32_16x16x32_bf16 v[172:175], v[76:79], a[84:87], v[172:175]
    s_waitcnt lgkmcnt(0)
    buffer_load_dwordx4 v19, s[52:55], s42 offen lds
    v_mfma_f32_16x16x32_bf16 v[144:147], v[80:83], a[88:91], v[144:147]
    s_waitcnt vmcnt(16)
    s_barrier
L_hop1:
    s_cbranch_execz L_hret0
    ds_read_b64_tr_b16 v[64:65], v20 offset:53248
    s_mul_i32 s42, s86, 1344
    s_add_u32 m0, s90, 139264
    s_nop 0
    buffer_load_dwordx4 v19, s[52:55], s42 offen lds
    ds_read_b64_tr_b16 v[66:67], v20 offset:53504
    v_mfma_f32_16x16x32_bf16 v[152:155], v[80:83], a[92:95], v[152:155]
    ds_read_b64_tr_b16 v[68:69], v21 offset:53248
    ds_read_b64_tr_b16 v[70:71], v21 offset:53504
    v_mfma_f32_16x16x32_bf16 v[148:151], v[84:87], a[88:91], v[148:151]
    ds_read_b64_tr_b16 v[72:73], v22 offset:24576
    ds_read_b64_tr_b16 v[74:75], v22 offset:24832
    v_mfma_f32_16x16x32_bf16 v[156:159], v[84:87], a[92:95], v[156:159]
    ds_read_b64_tr_b16 v[76:77], v23 offset:24576
    ds_read_b64_tr_b16 v[78:79], v23 offset:24832
    v_mfma_f32_16x16x32_bf16 v[160:163], v[88:91], a[88:91], v[160:163]
    s_cmp_eq_u32 s17, 0
    s_cselect_b32 s92, 14, 22
    s_cmp_eq_u32 s17, 127
    s_cselect_b32 s92, 14, s92
    v_mfma_f32_16x16x32_bf16 v[168:171], v[88:91], a[92:95], v[168:171]
    buffer_store_dwordx4 v[104:107], v16, s[56:59], s20 offen offset:0 sc1
    v_mfma_f32_16x16x32_bf16 v[164:167], v[92:95], a[88:91], v[164:167]
    v_mfma_f32_16x16x32_bf16 v[172:175], v[92:95], a[92:95], v[172:175]
    s_waitcnt lgkmcnt(0)
    s_mul_i32 s42, s87, 1344
    s_add_u32 m0, s90, 143360
    v_mfma_f32_16x16x32_bf16 v[144:147], v[64:67], a[96:99], v[144:147]
    ds_read_b64_tr_b16 v[80:81], v20 offset:55296
    ds_read_b64_tr_b16 v[82:83], v20 offset:55552
    v_mfma_f32_16x16x32_bf16 v[152:155], v[64:67], a[100:103], v[152:155]
    ds_read_b64_tr_b16 v[84:85], v21 offset:55296
    ds_read_b64_tr_b16 v[86:87], v21 offset:55552
    v_mfma_f32_16x16x32_bf16 v[148:151], v[68:71], a[96:99], v[148:151]
    ds_read_b64_tr_b16 v[88:89], v22 offset:26624
    ds_read_b64_tr_b16 v[90:91], v22 offset:26880
    v_mfma_f32_16x16x32_bf16 v[156:159], v[68:71], a[100:103], v[156:159]
    ds_read_b64_tr_b16 v[92:93], v23 offset:26624
    ds_read_b64_tr_b16 v[94:95], v23 offset:26880
    v_mfma_f32_16x16x32_bf16 v[160:163], v[72:75], a[96:99], v[160:163]
    buffer_load_dwordx4 v19, s[52:55], s42 offen lds
    v_mfma_f32_16x16x32_bf16 v[168:171], v[72:75], a[100:103], v[168:171]
    v_mfma_f32_16x16x32_bf16 v[164:167], v[76:79], a[96:99], v[164:167]
    v_mfma_f32_16x16x32_bf16 v[172:175], v[76:79], a[100:103], v[172:175]
    s_waitcnt lgkmcnt(0)
    v_mfma_f32_16x16x32_bf16 v[144:147], v[80:83], a[104:107], v[144:147]
    v_mfma_f32_16x16x32_bf16 v[152:155], v[80:83], a[108:111], v[152:155]
    s_mul_i32 s42, s88, 1344
    s_add_u32 m0, s90, 147456
    v_mfma_f32_16x16x32_bf16 v[148:151], v[84:87], a[104:107], v[148:151]
    buffer_load_dwordx4 v19, s[52:55], s42 offen lds
    v_mfma_f32_16x16x32_bf16 v[156:159], v[84:87], a[108:111], v[156:159]
    v_mfma_f32_16x16x32_bf16 v[160:163], v[88:91], a[104:107], v[160:163]
    v_mfma_f32_16x16x32_bf16 v[168:171], v[88:91], a[108:111], v[168:171]
    v_mfma_f32_16x16x32_bf16 v[164:167], v[92:95], a[104:107], v[164:167]
    v_mfma_f32_16x16x32_bf16 v[172:175], v[92:95], a[108:111], v[172:175]
    buffer_store_dwordx4 v[104:107], v16, s[56:59], s20 offen offset:1024 sc1
    buffer_store_dword v104, v108, s[56:59], s21 offen sc1
    s_buffer_load_dword s79, s[56:59], s91 offset:0x0 glc
    s_barrier
    v_and_b32 v4, 1, v2
    v_lshl_add_u32 v6, v4, 8, v24
    v_xor_b32 v7, 256, v6
    v_lshl_add_u32 v8, v4, 8, v25
    v_xor_b32 v9, 256, v8
    ds_read_b64_tr_b16 v[240:241], v6 offset:45056
    ds_read_b64_tr_b16 v[242:243], v7 offset:45056
    ds_read_b64_tr_b16 v[244:245], v8 offset:45056
    ds_read_b64_tr_b16 v[246:247], v9 offset:45056
    v_bfe_u32 v4, v3, 1, 2
    v_xor_b32 v4, v4, v2
    s_mul_i32 s42, s89, 1344
    s_add_u32 m0, s90, 151552
    s_nop 0
    buffer_load_dwordx4 v19, s[52:55], s42 offen lds
    v_lshlrev_b32 v4, 4, v4
    v_lshl_add_u32 v4, v3, 6, v4
    s_lshl_b32 s8, s72, 11
    s_add_u32 s8, s8, 28672
    v_add_u32 v15, s8, v4
    v_cndmask_b32 v164, v164, 1.0, s[100:101]
    v_cvt_pk_bf16_f32 v248, v160, v161
    v_cvt_pk_bf16_f32 v249, v162, v163
    v_cvt_pk_bf16_f32 v250, v164, v165
    v_cvt_pk_bf16_f32 v251, v166, v167
    v_cndmask_b32 v172, v172, 1.0, s[100:101]
    v_cvt_pk_bf16_f32 v252, v168, v169
    v_cvt_pk_bf16_f32 v253, v170, v171
    v_cvt_pk_bf16_f32 v254, v172, v173
    v_cvt_pk_bf16_f32 v255, v174, v175
    s_lshr_b32 s8, s72, 1
    s_lshl_b32 s8, s8, 15
    v_add_u32 v5, s8, v15
    ds_write_b128 v5, v[248:251] offset:16384
    ds_write_b128 v5, v[252:255] offset:17408
    v_cvt_pk_bf16_f32 v192, v144, v145
    v_cvt_pk_bf16_f32 v193, v146, v147
    v_cvt_pk_bf16_f32 v194, v148, v149
    v_cvt_pk_bf16_f32 v195, v150, v151
    v_cvt_pk_bf16_f32 v216, v152, v153
    v_cvt_pk_bf16_f32 v217, v154, v155
    v_cvt_pk_bf16_f32 v218, v156, v157
    v_cvt_pk_bf16_f32 v219, v158, v159
    s_waitcnt lgkmcnt(0)
    s_waitcnt lgkmcnt(0)
    s_cmp_ge_u32 s79, s92
    s_cselect_b64 s[24:25], -1, 0
    v_mfma_f32_16x16x32_bf16 v[196:199], v[240:243], v[192:195], 0
    s_mov_b64 exec, s[24:25]
    buffer_load_dwordx4 a[112:115], v128, s[48:51], 0 offen
    s_mov_b64 exec, -1
    v_mfma_f32_16x16x32_bf16 v[200:203], v[244:247], v[192:195], 0
    v_mfma_f32_16x16x32_bf16 v[220:223], v[240:243], v[216:219], 0
    v_mfma_f32_16x16x32_bf16 v[224:227], v[244:247], v[216:219], 0
    v_mov_b32 v14, 0xf149f2ca
    v_cndmask_b32 v14, 0, v14, s[100:101]
    v_max3_f32 v64, v196, v197, v198
    s_nop 3
    v_max3_f32 v96, v220, v221, v222
    s_mov_b64 exec, s[24:25]
    buffer_load_dwordx4 a[116:119], v129, s[48:51], 0 offen
    s_mov_b64 exec, -1
    v_max3_f32 v66, -v196, -v197, -v198
    v_max3_f32 v98, -v220, -v221, -v222
    v_max3_f32 v64, v64, v199, v200
    v_max3_f32 v96, v96, v223, v224
    v_max3_f32 v66, v66, -v199, -v200
    s_add_u32 s12, s16, 32768
    s_add_u32 s13, s16, 114688
    v_add_u32 v160, s12, v32
    s_mov_b64 exec, s[24:25]
    buffer_load_dwordx4 a[120:123], v130, s[48:51], 0 offen
    s_mov_b64 exec, -1
    v_add_u32 v168, s13, v32
    v_add_u32 v161, s12, v33
    v_add_u32 v169, s13, v33
    v_add_u32 v162, s12, v34
    v_add_u32 v170, s13, v34
    v_add_u32 v163, s12, v35
    v_add_u32 v171, s13, v35
    v_add_u32 v164, s12, v36
    v_add_u32 v172, s13, v36
    v_add_u32 v165, s12, v37
    s_mov_b64 exec, s[24:25]
    buffer_load_dwordx4 a[124:127], v131, s[48:51], 0 offen
    s_mov_b64 exec, -1
    v_add_u32 v173, s13, v37
    v_add_u32 v166, s12, v38
    v_add_u32 v174, s13, v38
    v_add_u32 v167, s12, v39
    v_add_u32 v175, s13, v39
    v_max3_f32 v98, v98, -v223, -v224
    v_max3_f32 v64, v64, v201, v202
    v_max3_f32 v96, v96, v225, v226
    v_max3_f32 v66, v66, -v201, -v202
    v_max3_f32 v98, v98, -v225, -v226
    v_max_f32 v64, v64, v203
    s_mov_b64 exec, s[24:25]
    buffer_load_dwordx4 a[128:131], v132, s[48:51], 0 offen
    s_mov_b64 exec, -1
    v_max_f32 v96, v96, v227
    v_max_f32_e64 v66, v66, -v203
    v_max_f32_e64 v98, v98, -v227
    s_nop 0
    v_permlane32_swap_b32 v64, v66
    v_permlane32_swap_b32 v96, v98
    v_max_f32 v64, v64, v66
    v_max_f32 v96, v96, v98
    v_mov_b32 v66, v64
    v_mov_b32 v98, v96
    s_nop 0
    v_permlane16_swap_b32 v64, v66
    s_mov_b64 exec, s[24:25]
    buffer_load_dwordx4 a[132:135], v133, s[48:51], 0 offen
    s_mov_b64 exec, -1
    v_permlane16_swap_b32 v96, v98
    v_max_f32 v64, v64, v66
    v_max_f32 v96, v96, v98
    v_mul_f32 v64, s82, v64
    v_mul_f32 v96, s82, v96
    v_mov_b32 v66, v64
    v_mov_b32 v98, v96
    s_nop 0
    v_permlane32_swap_b32 v64, v66
    v_permlane32_swap_b32 v96, v98
    s_mov_b64 exec, s[24:25]
    buffer_load_dwordx4 a[136:139], v134, s[48:51], 0 offen
    s_mov_b64 exec, -1
    v_add_f32 v68, v64, v14
    v_add_f32 v100, v96, v14
    v_add_f32 v70, v66, v14
    v_add_f32 v102, v98, v14
    v_pk_fma_f32 v[76:77], v[196:197], s[80:81], v[64:65] op_sel_hi:[1,1,0]
    v_pk_fma_f32 v[108:109], v[220:221], s[80:81], v[96:97] op_sel_hi:[1,1,0]
    v_pk_fma_f32 v[84:85], v[196:197], s[82:83], v[66:67] op_sel_hi:[1,1,0]
    v_pk_fma_f32 v[116:117], v[220:221], s[82:83], v[98:99] op_sel_hi:[1,1,0]
    v_pk_fma_f32 v[78:79], v[198:199], s[80:81], v[64:65] op_sel_hi:[1,1,0]
    v_pk_fma_f32 v[110:111], v[222:223], s[80:81], v[96:97] op_sel_hi:[1,1,0]
    v_pk_fma_f32 v[86:87], v[198:199], s[82:83], v[66:67] op_sel_hi:[1,1,0]
    s_mov_b64 exec, s[24:25]
    buffer_load_dwordx4 a[140:143], v135, s[48:51], 0 offen
    s_mov_b64 exec, -1
    v_pk_fma_f32 v[118:119], v[222:223], s[82:83], v[98:99] op_sel_hi:[1,1,0]
    v_pk_fma_f32 v[80:81], v[200:201], s[80:81], v[68:69] op_sel_hi:[1,1,0]
    v_pk_fma_f32 v[112:113], v[224:225], s[80:81], v[100:101] op_sel_hi:[1,1,0]
    v_pk_fma_f32 v[88:89], v[200:201], s[82:83], v[70:71] op_sel_hi:[1,1,0]
    v_pk_fma_f32 v[120:121], v[224:225], s[82:83], v[102:103] op_sel_hi:[1,1,0]
    v_pk_fma_f32 v[82:83], v[202:203], s[80:81], v[68:69] op_sel_hi:[1,1,0]
    s_buffer_load_dword s79, s[56:59], s91 offset:0x0 glc
    v_pk_fma_f32 v[114:115], v[226:227], s[80:81], v[100:101] op_sel_hi:[1,1,0]
    v_pk_fma_f32 v[90:91], v[202:203], s[82:83], v[70:71] op_sel_hi:[1,1,0]
    v_pk_fma_f32 v[122:123], v[226:227], s[82:83], v[102:103] op_sel_hi:[1,1,0]
    v_exp_f32 v76, v76
    s_mov_b64 exec, s[24:25]
    buffer_load_dwordx4 a[144:147], v136, s[48:51], 0 offen
    s_mov_b64 exec, -1
    v_exp_f32 v108, v108
    v_exp_f32 v84, v84
    v_exp_f32 v116, v116
    v_exp_f32 v77, v77
    v_exp_f32 v109, v109
    s_mov_b64 exec, s[24:25]
    buffer_load_dwordx4 a[148:151], v137, s[48:51], 0 offen
    s_mov_b64 exec, -1
    v_exp_f32 v85, v85
    v_exp_f32 v117, v117
    v_exp_f32 v78, v78
    v_exp_f32 v110, v110
    v_exp_f32 v86, v86
    v_exp_f32 v118, v118
    s_mov_b64 exec, s[24:25]
    buffer_load_dwordx4 a[152:155], v138, s[48:51], 0 offen
    s_mov_b64 exec, -1
    v_exp_f32 v79, v79
    v_exp_f32 v111, v111
    v_exp_f32 v87, v87
    v_exp_f32 v119, v119
    v_exp_f32 v80, v80
    v_exp_f32 v112, v112
    s_mov_b64 exec, s[24:25]
    buffer_load_dwordx4 a[156:159], v139, s[48:51], 0 offen
    s_mov_b64 exec, -1
    v_exp_f32 v88, v88
    v_exp_f32 v120, v120
    v_exp_f32 v81, v81
    v_exp_f32 v113, v113
    v_exp_f32 v89, v89
    v_exp_f32 v121, v121
    s_mov_b64 exec, s[24:25]
    buffer_load_dwordx4 a[160:163], v140, s[48:51], 0 offen
    s_mov_b64 exec, -1
    v_exp_f32 v82, v82
    v_exp_f32 v114, v114
    v_exp_f32 v90, v90
    v_exp_f32 v122, v122
    v_exp_f32 v83, v83
    v_exp_f32 v115, v115
    s_mov_b64 exec, s[24:25]
    buffer_load_dwordx4 a[164:167], v141, s[48:51], 0 offen
    s_mov_b64 exec, -1
    v_exp_f32 v91, v91
    v_exp_f32 v123, v123
    s_waitcnt lgkmcnt(0)
    s_cmp_ge_u32 s79, s92
    s_cselect_b64 s[10:11], -1, 0
    s_andn2_b64 s[24:25], s[10:11], s[24:25]
    v_pk_add_f32 v[72:73], v[76:77], v[78:79]
    v_pk_add_f32 v[104:105], v[108:109], v[110:111]
    v_pk_add_f32 v[74:75], v[84:85], v[86:87]
    s_mov_b64 exec, s[24:25]
    buffer_load_dwordx4 a[112:115], v128, s[48:51], 0 offen
    s_mov_b64 exec, -1
    v_pk_add_f32 v[106:107], v[116:117], v[118:119]
    v_pk_add_f32 v[68:69], v[80:81], v[82:83]
    v_pk_add_f32 v[100:101], v[112:113], v[114:115]
    s_mov_b64 exec, s[24:25]
    buffer_load_dwordx4 a[116:119], v129, s[48:51], 0 offen
    s_mov_b64 exec, -1
    v_pk_add_f32 v[70:71], v[88:89], v[90:91]
    v_pk_add_f32 v[102:103], v[120:121], v[122:123]
    s_mov_b64 exec, s[24:25]
    buffer_load_dwordx4 a[120:123], v130, s[48:51], 0 offen
    s_mov_b64 exec, -1
    v_pk_add_f32 v[72:73], v[72:73], v[68:69]
    v_pk_add_f32 v[104:105], v[104:105], v[100:101]
    v_pk_add_f32 v[74:75], v[74:75], v[70:71]
    s_mov_b64 exec, s[24:25]
    buffer_load_dwordx4 a[124:127], v131, s[48:51], 0 offen
    s_mov_b64 exec, -1
    v_pk_add_f32 v[106:107], v[106:107], v[102:103]
    v_add_f32 v64, v72, v73
    v_add_f32 v96, v104, v105
    s_mov_b64 exec, s[24:25]
    buffer_load_dwordx4 a[128:131], v132, s[48:51], 0 offen
    s_mov_b64 exec, -1
    v_add_f32 v66, v74, v75
    v_add_f32 v98, v106, v107
    s_mov_b64 exec, s[24:25]
    buffer_load_dwordx4 a[132:135], v133, s[48:51], 0 offen
    s_mov_b64 exec, -1
    v_permlane32_swap_b32 v64, v66
    v_permlane32_swap_b32 v96, v98
    v_add_f32 v64, v64, v66
    s_mov_b64 exec, s[24:25]
    buffer_load_dwordx4 a[136:139], v134, s[48:51], 0 offen
    s_mov_b64 exec, -1
    v_add_f32 v96, v96, v98
    v_mov_b32 v66, v64
    v_mov_b32 v98, v96
    s_mov_b64 exec, s[24:25]
    buffer_load_dwordx4 a[140:143], v135, s[48:51], 0 offen
    s_mov_b64 exec, -1
    v_permlane16_swap_b32 v64, v66
    v_permlane16_swap_b32 v96, v98
    s_mov_b64 exec, s[24:25]
    buffer_load_dwordx4 a[144:147], v136, s[48:51], 0 offen
    s_mov_b64 exec, -1
    v_add_f32 v64, v64, v66
    v_add_f32 v96, v96, v98
    v_rcp_f32 v64, v64
    s_mov_b64 exec, s[24:25]
    buffer_load_dwordx4 a[148:151], v137, s[48:51], 0 offen
    s_mov_b64 exec, -1
    v_rcp_f32 v96, v96
    s_mov_b64 exec, s[24:25]
    buffer_load_dwordx4 a[152:155], v138, s[48:51], 0 offen
    s_mov_b64 exec, -1
    v_mov_b32 v66, v64
    v_mov_b32 v98, v96
    s_nop 0
    v_permlane32_swap_b32 v64, v66
    s_mov_b64 exec, s[24:25]
    buffer_load_dwordx4 a[156:159], v139, s[48:51], 0 offen
    s_mov_b64 exec, -1
    v_permlane32_swap_b32 v96, v98
    v_pk_mul_f32 v[76:77], v[76:77], v[64:65] op_sel_hi:[1,0]
    s_mov_b64 exec, s[24:25]
    buffer_load_dwordx4 a[160:163], v140, s[48:51], 0 offen
    s_mov_b64 exec, -1
    v_pk_mul_f32 v[108:109], v[108:109], v[96:97] op_sel_hi:[1,0]
    v_pk_mul_f32 v[84:85], v[84:85], v[66:67] op_sel_hi:[1,0]
    s_mov_b64 exec, s[24:25]
    buffer_load_dwordx4 a[164:167], v141, s[48:51], 0 offen
    s_mov_b64 exec, -1
    v_pk_mul_f32 v[116:117], v[116:117], v[98:99] op_sel_hi:[1,0]
    v_pk_mul_f32 v[78:79], v[78:79], v[64:65] op_sel_hi:[1,0]
    v_pk_mul_f32 v[110:111], v[110:111], v[96:97] op_sel_hi:[1,0]
    s_mul_i32 s42, s43, 1344
    s_add_u32 m0, s90, 155648
    s_nop 0
    buffer_load_dwordx4 v19, s[52:55], s42 offen lds
    v_pk_mul_f32 v[86:87], v[86:87], v[66:67] op_sel_hi:[1,0]
    v_pk_mul_f32 v[118:119], v[118:119], v[98:99] op_sel_hi:[1,0]
    v_pk_mul_f32 v[80:81], v[80:81], v[64:65] op_sel_hi:[1,0]
    v_pk_mul_f32 v[112:113], v[112:113], v[96:97] op_sel_hi:[1,0]
    v_pk_mul_f32 v[88:89], v[88:89], v[66:67] op_sel_hi:[1,0]
    v_pk_mul_f32 v[120:121], v[120:121], v[98:99] op_sel_hi:[1,0]
    v_pk_mul_f32 v[82:83], v[82:83], v[64:65] op_sel_hi:[1,0]
    v_pk_mul_f32 v[114:115], v[114:115], v[96:97] op_sel_hi:[1,0]
    v_pk_mul_f32 v[90:91], v[90:91], v[66:67] op_sel_hi:[1,0]
    v_pk_mul_f32 v[122:123], v[122:123], v[98:99] op_sel_hi:[1,0]
    v_cvt_pk_bf16_f32 v204, v76, v77
    v_cvt_pk_bf16_f32 v228, v108, v109
    v_cvt_pk_bf16_f32 v208, v84, v85
    v_cvt_pk_bf16_f32 v232, v116, v117
    v_cvt_pk_bf16_f32 v205, v78, v79
    v_cvt_pk_bf16_f32 v229, v110, v111
    v_cvt_pk_bf16_f32 v209, v86, v87
    v_cvt_pk_bf16_f32 v233, v118, v119
    v_cvt_pk_bf16_f32 v206, v80, v81
    v_cvt_pk_bf16_f32 v230, v112, v113
    v_cvt_pk_bf16_f32 v210, v88, v89
    v_cvt_pk_bf16_f32 v234, v120, v121
    v_cvt_pk_bf16_f32 v207, v82, v83
    v_cvt_pk_bf16_f32 v231, v114, v115
    v_cvt_pk_bf16_f32 v211, v90, v91
    v_cvt_pk_bf16_f32 v235, v122, v123
    ds_write_b128 v15, v[204:207] offset:0
    ds_write_b128 v15, v[208:211] offset:8192
    ds_write_b128 v15, v[228:231] offset:1024
    ds_write_b128 v15, v[232:235] offset:9216
    v_bfe_u32 v4, v1, 2, 2
    s_add_u32 m0, s16, 114688
    s_nop 0
    buffer_load_dwordx4 v124, s[64:67], s94 offen offset:0 lds
    v_and_b32 v5, 3, v1
    v_lshl_add_u32 v6, v2, 3, v4
    v_lshlrev_b32 v6, 6, v6
    v_lshrrev_b32 v7, 1, v4
    v_xor_b32 v7, v7, v5
    v_lshl_add_u32 v6, v7, 4, v6
    v_xor_b32 v7, 32, v6
    v_add_u32 v7, 256, v7
    s_lshr_b32 s8, s72, 1
    s_lshl_b32 s8, s8, 13
    s_add_u32 s8, s8, 28672
    s_and_b32 s9, s72, 1
    s_lshl_b32 s9, s9, 3
    s_add_u32 s9, s9, 45056
    v_add_u32 v8, s8, v6
    buffer_load_dwordx4 v125, s[64:67], s94 offen offset:1024 lds
    v_add_u32 v9, s8, v7
    v_add_u32 v10, s9, v6
    v_add_u32 v11, s9, v7
    s_waitcnt vmcnt(40)
    s_waitcnt lgkmcnt(0)
    s_barrier
    ds_read_b64_tr_b16 v[64:65], v8 offset:0
    buffer_load_dwordx4 v126, s[64:67], s94 offen offset:2048 lds
    ds_read_b64_tr_b16 v[66:67], v9 offset:0
    ds_read_b64_tr_b16 v[68:69], v8 offset:8
    ds_read_b64_tr_b16 v[70:71], v9 offset:8
    buffer_load_dwordx4 v127, s[64:67], s94 offen offset:3072 lds
    s_add_u32 s94, s94, 114688
    s_sub_u32 s42, s94, 1605632
    s_cselect_b32 s94, s94, s42
    ds_read_b64_tr_b16 v[72:73], v10 offset:0
    ds_read_b64_tr_b16 v[74:75], v11 offset:0
    ds_read_b64_tr_b16 v[76:77], v8 offset:2048
    ds_read_b64_tr_b16 v[78:79], v9 offset:2048
    ds_read_b64_tr_b16 v[80:81], v8 offset:2056
    ds_read_b64_tr_b16 v[82:83], v9 offset:2056
    ds_read_b64_tr_b16 v[84:85], v10 offset:2048
    ds_read_b64_tr_b16 v[86:87], v11 offset:2048
    ds_read_b64_tr_b16 v[88:89], v8 offset:4096
    ds_read_b64_tr_b16 v[90:91], v9 offset:4096
    ds_read_b64_tr_b16 v[92:93], v8 offset:4104
    buffer_load_dwordx2 v[176:177], v12, s[44:47], s95 offen offset:0
    ds_read_b64_tr_b16 v[94:95], v9 offset:4104
    ds_read_b64_tr_b16 v[96:97], v10 offset:36864
    ds_read_b64_tr_b16 v[98:99], v11 offset:36864
    ds_read_b64_tr_b16 v[100:101], v8 offset:6144
    ds_read_b64_tr_b16 v[102:103], v9 offset:6144
    ds_read_b64_tr_b16 v[104:105], v8 offset:6152
    ds_read_b64_tr_b16 v[106:107], v9 offset:6152
    ds_read_b64_tr_b16 v[108:109], v10 offset:38912
    ds_read_b64_tr_b16 v[110:111], v11 offset:38912
    s_lshl_b32 s10, s73, 4
    s_add_u32 s10, s10, s74
    s_lshl_b32 s10, s10, 2
    s_add_u32 s10, s10, s72
    s_lshl_b32 s10, s10, 11
    s_add_u32 s10, s10, 0x480000
    s_waitcnt lgkmcnt(15)
    v_mfma_f32_16x16x32_bf16 v[192:195], v[64:67], v[72:75], 0
    v_mfma_f32_16x16x32_bf16 v[196:199], v[68:71], v[72:75], 0
    s_waitcnt lgkmcnt(12)
    v_mfma_f32_16x16x32_bf16 v[192:195], v[76:79], v[84:87], v[192:195]
    v_mfma_f32_16x16x32_bf16 v[196:199], v[80:83], v[84:87], v[196:199]
    s_waitcnt lgkmcnt(6)
    buffer_load_dwordx2 v[178:179], v13, s[44:47], s95 offen offset:0
    v_mfma_f32_16x16x32_bf16 v[192:195], v[88:91], v[96:99], v[192:195]
    v_mfma_f32_16x16x32_bf16 v[196:199], v[92:95], v[96:99], v[196:199]
    s_waitcnt lgkmcnt(0)
    v_mfma_f32_16x16x32_bf16 v[192:195], v[100:103], v[108:111], v[192:195]
    v_mfma_f32_16x16x32_bf16 v[196:199], v[104:107], v[108:111], v[196:199]
    s_nop 6
    buffer_store_dwordx4 v[192:195], v16, s[56:59], s10 offen offset:0 sc1
    buffer_store_dwordx4 v[196:199], v16, s[56:59], s10 offen offset:1024 sc1
    s_cmp_ge_u32 s79, s92
    s_nop 0
    s_cbranch_scc1 L_h_done
    s_mov_b32 s9, 0
    s_nop 0
L_pl_h:
    s_buffer_load_dword s79, s[56:59], s91 offset:0x0 glc
    s_add_u32 s9, s9, 1
    s_waitcnt lgkmcnt(0)
    s_cmp_ge_u32 s79, s92
    s_nop 0
    s_cbranch_scc1 L_pw_h
    s_cmp_lt_u32 s9, 40000
    s_nop 0
    s_cbranch_scc1 L_pl_h
    s_nop 0
L_pw_h:
    buffer_load_dwordx4 a[112:115], v128, s[48:51], 0 offen
    buffer_load_dwordx4 a[116:119], v129, s[48:51], 0 offen
    buffer_load_dwordx4 a[120:123], v130, s[48:51], 0 offen
    buffer_load_dwordx4 a[124:127], v131, s[48:51], 0 offen
    buffer_load_dwordx4 a[128:131], v132, s[48:51], 0 offen
    buffer_load_dwordx4 a[132:135], v133, s[48:51], 0 offen
    buffer_load_dwordx4 a[136:139], v134, s[48:51], 0 offen
    buffer_load_dwordx4 a[140:143], v135, s[48:51], 0 offen
    buffer_load_dwordx4 a[144:147], v136, s[48:51], 0 offen
    buffer_load_dwordx4 a[148:151], v137, s[48:51], 0 offen
    buffer_load_dwordx4 a[152:155], v138, s[48:51], 0 offen
    buffer_load_dwordx4 a[156:159], v139, s[48:51], 0 offen
    buffer_load_dwordx4 a[160:163], v140, s[48:51], 0 offen
    buffer_load_dwordx4 a[164:167], v141, s[48:51], 0 offen
    s_waitcnt vmcnt(0)
    s_nop 0
L_h_done:
    ds_read_b64_tr_b16 v[64:65], v32 offset:0
    ds_read_b64_tr_b16 v[66:67], v33 offset:0
    ds_read_b64_tr_b16 v[68:69], v34 offset:0
    ds_read_b64_tr_b16 v[70:71], v35 offset:0
    ds_read_b64_tr_b16 v[72:73], v36 offset:0
    ds_read_b64_tr_b16 v[74:75], v37 offset:0
    ds_read_b64_tr_b16 v[76:77], v38 offset:0
    ds_read_b64_tr_b16 v[78:79], v39 offset:0
    s_waitcnt vmcnt(22)
    s_waitcnt lgkmcnt(0)
    v_mfma_f32_16x16x32_bf16 v[128:131], v[64:67], a[112:115], 0
    ds_read_b64_tr_b16 v[80:81], v32 offset:4096
    ds_read_b64_tr_b16 v[82:83], v33 offset:4096
    v_mfma_f32_16x16x32_bf16 v[132:135], v[68:71], a[112:115], 0
    ds_read_b64_tr_b16 v[84:85], v34 offset:4096
    ds_read_b64_tr_b16 v[86:87], v35 offset:4096
    v_mfma_f32_16x16x32_bf16 v[136:139], v[72:75], a[112:115], 0
    ds_read_b64_tr_b16 v[88:89], v36 offset:4096
    ds_read_b64_tr_b16 v[90:91], v37 offset:4096
    v_mfma_f32_16x16x32_bf16 v[140:143], v[76:79], a[112:115], 0
    ds_read_b64_tr_b16 v[92:93], v38 offset:4096
    ds_read_b64_tr_b16 v[94:95], v39 offset:4096
    s_waitcnt vmcnt(21)
    s_waitcnt lgkmcnt(0)
    v_mfma_f32_16x16x32_bf16 v[128:131], v[80:83], a[116:119], v[128:131]
    ds_read_b64_tr_b16 v[64:65], v32 offset:8192
    ds_read_b64_tr_b16 v[66:67], v33 offset:8192
    s_add_u32 s12, s16, 32768
    s_add_u32 s13, s16, 114688
    v_add_u32 v96, s12, v32
    buffer_load_dwordx2 v[180:181], v12, s[44:47], s95 offen offset:64
    v_mfma_f32_16x16x32_bf16 v[132:135], v[84:87], a[116:119], v[132:135]
    ds_read_b64_tr_b16 v[68:69], v34 offset:8192
    ds_read_b64_tr_b16 v[70:71], v35 offset:8192
    v_add_u32 v104, s13, v32
    v_add_u32 v97, s12, v33
    v_add_u32 v105, s13, v33
    v_mfma_f32_16x16x32_bf16 v[136:139], v[88:91], a[116:119], v[136:139]
    ds_read_b64_tr_b16 v[72:73], v36 offset:8192
    ds_read_b64_tr_b16 v[74:75], v37 offset:8192
    v_add_u32 v98, s12, v34
    v_add_u32 v106, s13, v34
    v_add_u32 v99, s12, v35
    v_mfma_f32_16x16x32_bf16 v[140:143], v[92:95], a[116:119], v[140:143]
    ds_read_b64_tr_b16 v[76:77], v38 offset:8192
    ds_read_b64_tr_b16 v[78:79], v39 offset:8192
    s_barrier
    s_waitcnt vmcnt(21)
    s_waitcnt lgkmcnt(0)
    v_mfma_f32_16x16x32_bf16 v[128:131], v[64:67], a[120:123], v[128:131]
    ds_read_b64_tr_b16 v[80:81], v32 offset:12288
    ds_read_b64_tr_b16 v[82:83], v33 offset:12288
    v_add_u32 v107, s13, v35
    v_add_u32 v100, s12, v36
    buffer_load_dwordx2 v[182:183], v13, s[44:47], s95 offen offset:64
    v_add_u32 v108, s13, v36
    v_mfma_f32_16x16x32_bf16 v[132:135], v[68:71], a[120:123], v[132:135]
    ds_read_b64_tr_b16 v[84:85], v34 offset:12288
    ds_read_b64_tr_b16 v[86:87], v35 offset:12288
    v_add_u32 v101, s12, v37
    v_add_u32 v109, s13, v37
    v_add_u32 v102, s12, v38
    v_mfma_f32_16x16x32_bf16 v[136:139], v[72:75], a[120:123], v[136:139]
    ds_read_b64_tr_b16 v[88:89], v36 offset:12288
    ds_read_b64_tr_b16 v[90:91], v37 offset:12288
    v_add_u32 v110, s13, v38
    v_add_u32 v103, s12, v39
    s_add_u32 m0, s16, 49152
    s_nop 0
    buffer_load_dwordx4 v124, s[64:67], s94 offen offset:0 lds
    v_add_u32 v111, s13, v39
    v_mfma_f32_16x16x32_bf16 v[140:143], v[76:79], a[120:123], v[140:143]
    ds_read_b64_tr_b16 v[92:93], v38 offset:12288
    ds_read_b64_tr_b16 v[94:95], v39 offset:12288
    s_waitcnt vmcnt(22)
    s_waitcnt lgkmcnt(0)
    v_mfma_f32_16x16x32_bf16 v[128:131], v[80:83], a[124:127], v[128:131]
    ds_read_b64_tr_b16 v[64:65], v32 offset:16384
    ds_read_b64_tr_b16 v[66:67], v33 offset:16384
    s_mul_i32 s18, s17, 14336
    s_add_u32 s18, s18, 0x200000
    s_mul_i32 s19, s72, 7168
    v_mfma_f32_16x16x32_bf16 v[132:135], v[84:87], a[124:127], v[132:135]
    ds_read_b64_tr_b16 v[68:69], v34 offset:16384
    ds_read_b64_tr_b16 v[70:71], v35 offset:16384
    s_lshl_b32 s20, s75, 12
    s_add_u32 s20, s20, 0x1c0000
    s_lshl_b32 s34, s75, 3
    v_mfma_f32_16x16x32_bf16 v[136:139], v[88:91], a[124:127], v[136:139]
    ds_read_b64_tr_b16 v[72:73], v36 offset:16384
    ds_read_b64_tr_b16 v[74:75], v37 offset:16384
    s_add_u32 s34, s34, s76
    v_mfma_f32_16x16x32_bf16 v[140:143], v[92:95], a[124:127], v[140:143]
    ds_read_b64_tr_b16 v[76:77], v38 offset:16384
    ds_read_b64_tr_b16 v[78:79], v39 offset:16384
    s_waitcnt vmcnt(21)
    s_waitcnt lgkmcnt(0)
    v_mfma_f32_16x16x32_bf16 v[128:131], v[64:67], a[128:131], v[128:131]
    ds_read_b64_tr_b16 v[80:81], v32 offset:20480
    ds_read_b64_tr_b16 v[82:83], v33 offset:20480
    s_lshl_b32 s34, s34, 2
    s_add_u32 s34, s34, s72
    s_lshl_b32 s34, s34, 14
    v_mfma_f32_16x16x32_bf16 v[132:135], v[68:71], a[128:131], v[132:135]
    ds_read_b64_tr_b16 v[84:85], v34 offset:20480
    ds_read_b64_tr_b16 v[86:87], v35 offset:20480
    s_add_u32 s34, s34, 0xa00000
    s_lshl_b32 s21, s17, 14
    s_add_u32 s21, s21, 0x700000
    v_mfma_f32_16x16x32_bf16 v[136:139], v[72:75], a[128:131], v[136:139]
    ds_read_b64_tr_b16 v[88:89], v36 offset:20480
    ds_read_b64_tr_b16 v[90:91], v37 offset:20480
    v_mfma_f32_16x16x32_bf16 v[140:143], v[76:79], a[128:131], v[140:143]
    ds_read_b64_tr_b16 v[92:93], v38 offset:20480
    ds_read_b64_tr_b16 v[94:95], v39 offset:20480
    s_waitcnt vmcnt(20)
    s_waitcnt lgkmcnt(0)
    v_mfma_f32_16x16x32_bf16 v[128:131], v[80:83], a[132:135], v[128:131]
    ds_read_b64_tr_b16 v[64:65], v32 offset:24576
    ds_read_b64_tr_b16 v[66:67], v33 offset:24576
    buffer_load_dwordx4 v125, s[64:67], s94 offen offset:1024 lds
    v_mfma_f32_16x16x32_bf16 v[132:135], v[84:87], a[132:135], v[132:135]
    ds_read_b64_tr_b16 v[68:69], v34 offset:24576
    ds_read_b64_tr_b16 v[70:71], v35 offset:24576
    v_mfma_f32_16x16x32_bf16 v[136:139], v[88:91], a[132:135], v[136:139]
    ds_read_b64_tr_b16 v[72:73], v36 offset:24576
    ds_read_b64_tr_b16 v[74:75], v37 offset:24576
    v_mfma_f32_16x16x32_bf16 v[140:143], v[92:95], a[132:135], v[140:143]
    ds_read_b64_tr_b16 v[76:77], v38 offset:24576
    ds_read_b64_tr_b16 v[78:79], v39 offset:24576
    s_waitcnt vmcnt(20)
    s_waitcnt lgkmcnt(0)
    v_mfma_f32_16x16x32_bf16 v[128:131], v[64:67], a[136:139], v[128:131]
    ds_read_b64_tr_b16 v[80:81], v40 offset:20480
    ds_read_b64_tr_b16 v[82:83], v41 offset:20480
    buffer_load_dwordx4 v126, s[64:67], s94 offen offset:2048 lds
    v_mfma_f32_16x16x32_bf16 v[132:135], v[68:71], a[136:139], v[132:135]
    ds_read_b64_tr_b16 v[84:85], v42 offset:20480
    ds_read_b64_tr_b16 v[86:87], v43 offset:20480
    v_mfma_f32_16x16x32_bf16 v[136:139], v[72:75], a[136:139], v[136:139]
    ds_read_b64_tr_b16 v[88:89], v44 offset:20480
    ds_read_b64_tr_b16 v[90:91], v45 offset:20480
    v_mfma_f32_16x16x32_bf16 v[140:143], v[76:79], a[136:139], v[140:143]
    ds_read_b64_tr_b16 v[92:93], v46 offset:20480
    ds_read_b64_tr_b16 v[94:95], v47 offset:20480
    s_waitcnt vmcnt(20)
    s_waitcnt lgkmcnt(0)
    v_mfma_f32_16x16x32_bf16 v[128:131], v[80:83], a[140:143], v[128:131]
    ds_read_b64_tr_b16 v[64:65], v40 offset:24576
    ds_read_b64_tr_b16 v[66:67], v41 offset:24576
    buffer_load_dwordx4 v127, s[64:67], s94 offen offset:3072 lds
L_hop2:
    s_cbranch_execz L_hop3
    v_mfma_f32_16x16x32_bf16 v[132:135], v[84:87], a[140:143], v[132:135]
    ds_read_b64_tr_b16 v[68:69], v42 offset:24576
    ds_read_b64_tr_b16 v[70:71], v43 offset:24576
    v_mfma_f32_16x16x32_bf16 v[136:139], v[88:91], a[140:143], v[136:139]
    ds_read_b64_tr_b16 v[72:73], v44 offset:24576
    ds_read_b64_tr_b16 v[74:75], v45 offset:24576
    v_mfma_f32_16x16x32_bf16 v[140:143], v[92:95], a[140:143], v[140:143]
    ds_read_b64_tr_b16 v[76:77], v46 offset:24576
    ds_read_b64_tr_b16 v[78:79], v47 offset:24576
    s_waitcnt vmcnt(20)
    s_waitcnt lgkmcnt(0)
    v_mfma_f32_16x16x32_bf16 v[128:131], v[64:67], a[144:147], v[128:131]
    ds_read_b64_tr_b16 v[80:81], v40 offset:28672
    ds_read_b64_tr_b16 v[82:83], v41 offset:28672
    v_mfma_f32_16x16x32_bf16 v[132:135], v[68:71], a[144:147], v[132:135]
    ds_read_b64_tr_b16 v[84:85], v42 offset:28672
    ds_read_b64_tr_b16 v[86:87], v43 offset:28672
    v_mfma_f32_16x16x32_bf16 v[136:139], v[72:75], a[144:147], v[136:139]
    ds_read_b64_tr_b16 v[88:89], v44 offset:28672
    ds_read_b64_tr_b16 v[90:91], v45 offset:28672
    v_mfma_f32_16x16x32_bf16 v[140:143], v[76:79], a[144:147], v[140:143]
    ds_read_b64_tr_b16 v[92:93], v46 offset:28672
    ds_read_b64_tr_b16 v[94:95], v47 offset:28672
    s_waitcnt vmcnt(19)
    s_waitcnt lgkmcnt(0)
    v_mfma_f32_16x16x32_bf16 v[128:131], v[80:83], a[148:151], v[128:131]
    ds_read_b64_tr_b16 v[64:65], v40 offset:32768
    ds_read_b64_tr_b16 v[66:67], v41 offset:32768
    v_mfma_f32_16x16x32_bf16 v[132:135], v[84:87], a[148:151], v[132:135]
    ds_read_b64_tr_b16 v[68:69], v42 offset:32768
    ds_read_b64_tr_b16 v[70:71], v43 offset:32768
    v_mfma_f32_16x16x32_bf16 v[136:139], v[88:91], a[148:151], v[136:139]
    ds_read_b64_tr_b16 v[72:73], v44 offset:32768
    ds_read_b64_tr_b16 v[74:75], v45 offset:32768
    v_mfma_f32_16x16x32_bf16 v[140:143], v[92:95], a[148:151], v[140:143]
    ds_read_b64_tr_b16 v[76:77], v46 offset:32768
    ds_read_b64_tr_b16 v[78:79], v47 offset:32768
    s_waitcnt vmcnt(18)
    s_waitcnt lgkmcnt(0)
    v_mfma_f32_16x16x32_bf16 v[128:131], v[64:67], a[152:155], v[128:131]
    ds_read_b64_tr_b16 v[80:81], v40 offset:36864
    ds_read_b64_tr_b16 v[82:83], v41 offset:36864
    v_mfma_f32_16x16x32_bf16 v[132:135], v[68:71], a[152:155], v[132:135]
    ds_read_b64_tr_b16 v[84:85], v42 offset:36864
    ds_read_b64_tr_b16 v[86:87], v43 offset:36864
    v_mfma_f32_16x16x32_bf16 v[136:139], v[72:75], a[152:155], v[136:139]
    ds_read_b64_tr_b16 v[88:89], v44 offset:36864
    ds_read_b64_tr_b16 v[90:91], v45 offset:36864
    v_mfma_f32_16x16x32_bf16 v[140:143], v[76:79], a[152:155], v[140:143]
    ds_read_b64_tr_b16 v[92:93], v46 offset:36864
    ds_read_b64_tr_b16 v[94:95], v47 offset:36864
    s_waitcnt vmcnt(17)
    s_waitcnt lgkmcnt(0)
    v_mfma_f32_16x16x32_bf16 v[128:131], v[80:83], a[156:159], v[128:131]
    ds_read_b64_tr_b16 v[64:65], v40 offset:40960
    ds_read_b64_tr_b16 v[66:67], v41 offset:40960
    v_mfma_f32_16x16x32_bf16 v[132:135], v[84:87], a[156:159], v[132:135]
    ds_read_b64_tr_b16 v[68:69], v42 offset:40960
    ds_read_b64_tr_b16 v[70:71], v43 offset:40960
    v_mfma_f32_16x16x32_bf16 v[136:139], v[88:91], a[156:159], v[136:139]
    ds_read_b64_tr_b16 v[72:73], v44 offset:40960
    ds_read_b64_tr_b16 v[74:75], v45 offset:40960
    v_mfma_f32_16x16x32_bf16 v[140:143], v[92:95], a[156:159], v[140:143]
    ds_read_b64_tr_b16 v[76:77], v46 offset:40960
    ds_read_b64_tr_b16 v[78:79], v47 offset:40960
    s_waitcnt vmcnt(16)
    s_waitcnt lgkmcnt(0)
    v_mfma_f32_16x16x32_bf16 v[128:131], v[64:67], a[160:163], v[128:131]
    ds_read_b64_tr_b16 v[80:81], v40 offset:45056
    ds_read_b64_tr_b16 v[82:83], v41 offset:45056
    v_mfma_f32_16x16x32_bf16 v[132:135], v[68:71], a[160:163], v[132:135]
    ds_read_b64_tr_b16 v[84:85], v42 offset:45056
    ds_read_b64_tr_b16 v[86:87], v43 offset:45056
    s_add_u32 s94, s94, 114688
    s_sub_u32 s42, s94, 1605632
    s_cselect_b32 s94, s94, s42
    s_waitcnt vmcnt(6)
    s_mov_b64 exec, 0x3
    buffer_atomic_add v63, v31, s[56:59], 0 offen offset:0 sc1
    s_mov_b64 exec, -1
    v_mfma_f32_16x16x32_bf16 v[136:139], v[72:75], a[160:163], v[136:139]
    ds_read_b64_tr_b16 v[88:89], v44 offset:45056
    ds_read_b64_tr_b16 v[90:91], v45 offset:45056
    s_add_u32 m0, s16, 65536
    s_nop 0
    buffer_load_dwordx4 v124, s[64:67], s94 offen offset:0 lds
    v_mfma_f32_16x16x32_bf16 v[140:143], v[76:79], a[160:163], v[140:143]
    ds_read_b64_tr_b16 v[92:93], v46 offset:45056
    ds_read_b64_tr_b16 v[94:95], v47 offset:45056
    s_waitcnt vmcnt(17)
    s_waitcnt lgkmcnt(0)
    v_mfma_f32_16x16x32_bf16 v[128:131], v[80:83], a[164:167], v[128:131]
    buffer_load_dwordx4 v125, s[64:67], s94 offen offset:1024 lds
    buffer_load_dwordx4 v126, s[64:67], s94 offen offset:2048 lds
    v_mfma_f32_16x16x32_bf16 v[132:135], v[84:87], a[164:167], v[132:135]
    buffer_load_dwordx4 v127, s[64:67], s94 offen offset:3072 lds
    s_add_u32 s94, s94, 114688
    s_sub_u32 s42, s94, 1605632
    s_cselect_b32 s94, s94, s42
    s_waitcnt vmcnt(15)
    v_mfma_f32_16x16x32_bf16 v[136:139], v[88:91], a[164:167], v[136:139]
    ds_read_b64_tr_b16 a[176:177], v104 offset:0
    ds_read_b64_tr_b16 a[178:179], v105 offset:0
    v_mfma_f32_16x16x32_bf16 v[140:143], v[92:95], a[164:167], v[140:143]
    v_cmp_u_f32 vcc, v128, v128
    s_nop 6
    s_cbranch_vccnz L_p2redo
    s_nop 0
L_p2ok:
    s_waitcnt vmcnt(9)
    v_lshlrev_b32 v64, 16, v176
    ds_read_b64_tr_b16 a[180:181], v106 offset:0
    v_and_b32 v65, 0xffff0000, v176
    ds_read_b64_tr_b16 a[182:183], v107 offset:0
    v_lshlrev_b32 v66, 16, v177
    ds_read_b64_tr_b16 a[184:185], v108 offset:0
    v_and_b32 v67, 0xffff0000, v177
    ds_read_b64_tr_b16 a[186:187], v109 offset:0
    v_lshlrev_b32 v68, 16, v178
    ds_read_b64_tr_b16 a[188:189], v110 offset:0
    v_and_b32 v69, 0xffff0000, v178
    ds_read_b64_tr_b16 a[190:191], v111 offset:0
    v_lshlrev_b32 v70, 16, v179
    v_and_b32 v71, 0xffff0000, v179
    v_lshlrev_b32 v72, 16, v180
    v_and_b32 v73, 0xffff0000, v180
    v_lshlrev_b32 v74, 16, v181
    v_and_b32 v75, 0xffff0000, v181
    v_lshlrev_b32 v76, 16, v182
    v_and_b32 v77, 0xffff0000, v182
    v_lshlrev_b32 v78, 16, v183
    v_and_b32 v79, 0xffff0000, v183
    s_mul_i32 s6, s17, 14336
    s_lshl_b32 s7, s76, 11
    s_add_u32 s6, s6, s7
    s_add_u32 s6, s6, 0x200000
    v_pk_add_f32 v[128:129], v[128:129], v[64:65]
    v_pk_add_f32 v[130:131], v[130:131], v[66:67]
    v_pk_add_f32 v[132:133], v[132:133], v[68:69]
    v_pk_add_f32 v[134:135], v[134:135], v[70:71]
    v_pk_add_f32 v[136:137], v[136:137], v[72:73]
    v_pk_add_f32 v[138:139], v[138:139], v[74:75]
    v_pk_add_f32 v[140:141], v[140:141], v[76:77]
    v_pk_add_f32 v[142:143], v[142:143], v[78:79]
    v_cvt_pk_bf16_f32 v80, v128, v129
    v_cvt_pk_bf16_f32 v81, v130, v131
    v_cvt_pk_bf16_f32 v82, v132, v133
    v_cvt_pk_bf16_f32 v83, v134, v135
    v_cvt_pk_bf16_f32 v84, v136, v137
    v_cvt_pk_bf16_f32 v85, v138, v139
    s_waitcnt lgkmcnt(0)
    v_cvt_pk_bf16_f32 v86, v140, v141
    s_add_u32 m0, s16, 114688
    s_nop 0
    buffer_load_dwordx4 v124, s[64:67], s94 offen offset:0 lds
    v_cvt_pk_bf16_f32 v87, v142, v143
    buffer_load_dwordx4 v125, s[64:67], s94 offen offset:1024 lds
    s_waitcnt vmcnt(51)
    buffer_store_dwordx4 v[80:83], v16, s[56:59], s6 offen offset:0 sc1
    buffer_store_dwordx4 v[84:87], v16, s[56:59], s6 offen offset:1024 sc1
    s_mov_b64 exec, 0x7f
    buffer_atomic_add v63, v27, s[56:59], 0 offen offset:0 sc1
    s_mov_b64 exec, -1
    v_pk_add_f32 v[64:65], v[128:129], v[130:131]
    v_pk_mul_f32 v[66:67], v[128:129], v[128:129]
    v_pk_fma_f32 v[66:67], v[130:131], v[130:131], v[66:67]
    v_pk_add_f32 v[64:65], v[64:65], v[132:133]
    v_pk_fma_f32 v[66:67], v[132:133], v[132:133], v[66:67]
    v_pk_add_f32 v[64:65], v[64:65], v[134:135]
    v_pk_fma_f32 v[66:67], v[134:135], v[134:135], v[66:67]
    v_pk_add_f32 v[64:65], v[64:65], v[136:137]
    buffer_load_dwordx4 v126, s[64:67], s94 offen offset:2048 lds
    v_pk_fma_f32 v[66:67], v[136:137], v[136:137], v[66:67]
    v_pk_add_f32 v[64:65], v[64:65], v[138:139]
    v_pk_fma_f32 v[66:67], v[138:139], v[138:139], v[66:67]
    v_pk_add_f32 v[64:65], v[64:65], v[140:141]
    v_pk_fma_f32 v[66:67], v[140:141], v[140:141], v[66:67]
    v_pk_add_f32 v[64:65], v[64:65], v[142:143]
    v_pk_fma_f32 v[66:67], v[142:143], v[142:143], v[66:67]
    v_add_f32 v6, v64, v65
    v_add_f32 v7, v66, v67
    s_nop 1
    v_permlane32_swap_b32 v6, v7
    v_add_f32 v6, v6, v7
    v_mov_b32 v7, v6
    buffer_load_dwordx4 v127, s[64:67], s94 offen offset:3072 lds
    s_add_u32 s94, s94, 114688
    s_sub_u32 s42, s94, 1605632
    s_cselect_b32 s94, s94, s42
    v_permlane16_swap_b32 v6, v7
    v_add_f32 v6, v6, v7
    v_lshrrev_b32 v7, 5, v1
    v_lshlrev_b32 v7, 2, v7
    v_lshl_add_u32 v7, v3, 6, v7
    s_lshl_b32 s5, s17, 10
    s_lshl_b32 s7, s76, 3
    s_add_u32 s5, s5, s7
    s_add_u32 s5, s5, 0x1c0000
    buffer_store_dword v6, v7, s[56:59], s5 offen sc1
    s_waitcnt vmcnt(63)
    s_barrier
    ds_read_b64_tr_b16 v[64:65], v24 offset:16384
    ds_read_b64_tr_b16 v[66:67], v24 offset:16640
    ds_read_b64_tr_b16 v[68:69], v25 offset:16384
    ds_read_b64_tr_b16 v[70:71], v25 offset:16640
    s_waitcnt lgkmcnt(0)
    v_mfma_f32_16x16x32_bf16 v[176:179], v[64:67], a[0:3], 0
    ds_read_b64_tr_b16 v[80:81], v24 offset:18432
    ds_read_b64_tr_b16 v[82:83], v24 offset:18688
    v_mfma_f32_16x16x32_bf16 v[184:187], v[64:67], a[4:7], 0
    ds_read_b64_tr_b16 v[84:85], v25 offset:18432
    ds_read_b64_tr_b16 v[86:87], v25 offset:18688
    v_mfma_f32_16x16x32_bf16 v[180:183], v[68:71], a[0:3], 0
    s_waitcnt vmcnt(13)
    ds_read_b64_tr_b16 a[192:193], v96 offset:16384
    v_mfma_f32_16x16x32_bf16 v[188:191], v[68:71], a[4:7], 0
    s_waitcnt lgkmcnt(0)
    ds_read_b64_tr_b16 a[194:195], v97 offset:16384
    v_mfma_f32_16x16x32_bf16 v[176:179], v[80:83], a[8:11], v[176:179]
    s_waitcnt vmcnt(63)
    s_barrier
    ds_read_b64_tr_b16 v[64:65], v24 offset:20480
    ds_read_b64_tr_b16 a[196:197], v98 offset:16384
    ds_read_b64_tr_b16 v[66:67], v24 offset:20736
    ds_read_b64_tr_b16 a[198:199], v99 offset:16384
    v_mfma_f32_16x16x32_bf16 v[184:187], v[80:83], a[12:15], v[184:187]
    ds_read_b64_tr_b16 v[68:69], v25 offset:20480
    ds_read_b64_tr_b16 v[70:71], v25 offset:20736
    v_mfma_f32_16x16x32_bf16 v[180:183], v[84:87], a[8:11], v[180:183]
    ds_read_b64_tr_b16 a[200:201], v100 offset:16384
    ds_read_b64_tr_b16 a[202:203], v101 offset:16384
    v_mfma_f32_16x16x32_bf16 v[188:191], v[84:87], a[12:15], v[188:191]
    s_waitcnt lgkmcnt(0)
    ds_read_b64_tr_b16 a[204:205], v102 offset:16384
    v_mfma_f32_16x16x32_bf16 v[176:179], v[64:67], a[16:19], v[176:179]
    ds_read_b64_tr_b16 v[80:81], v24 offset:22528
    ds_read_b64_tr_b16 v[82:83], v24 offset:22784
    v_mfma_f32_16x16x32_bf16 v[184:187], v[64:67], a[20:23], v[184:187]
    ds_read_b64_tr_b16 v[84:85], v25 offset:22528
    ds_read_b64_tr_b16 v[86:87], v25 offset:22784
    v_mfma_f32_16x16x32_bf16 v[180:183], v[68:71], a[16:19], v[180:183]
    ds_read_b64_tr_b16 a[206:207], v103 offset:16384
    v_mfma_f32_16x16x32_bf16 v[188:191], v[68:71], a[20:23], v[188:191]
    s_waitcnt lgkmcnt(0)
    v_mfma_f32_16x16x32_bf16 v[176:179], v[80:83], a[24:27], v[176:179]
    s_waitcnt vmcnt(62)
    s_barrier
    ds_read_b64_tr_b16 v[64:65], v24 offset:24576
    ds_read_b64_tr_b16 v[66:67], v24 offset:24832
    v_mfma_f32_16x16x32_bf16 v[184:187], v[80:83], a[28:31], v[184:187]
    ds_read_b64_tr_b16 v[68:69], v25 offset:24576
    ds_read_b64_tr_b16 v[70:71], v25 offset:24832
    v_mfma_f32_16x16x32_bf16 v[180:183], v[84:87], a[24:27], v[180:183]
    v_mfma_f32_16x16x32_bf16 v[188:191], v[84:87], a[28:31], v[188:191]
    s_waitcnt lgkmcnt(0)
    s_waitcnt lgkmcnt(4)
    s_add_u32 m0, s16, 49152
    s_nop 0
    buffer_load_dwordx4 v124, s[64:67], s94 offen offset:0 lds
    v_mfma_f32_16x16x32_bf16 v[176:179], v[64:67], a[32:35], v[176:179]
    ds_read_b64_tr_b16 v[80:81], v24 offset:26624
    ds_read_b64_tr_b16 v[82:83], v24 offset:26880
    v_mfma_f32_16x16x32_bf16 v[184:187], v[64:67], a[36:39], v[184:187]
    ds_read_b64_tr_b16 v[84:85], v25 offset:26624
    ds_read_b64_tr_b16 v[86:87], v25 offset:26880
    v_mfma_f32_16x16x32_bf16 v[180:183], v[68:71], a[32:35], v[180:183]
    buffer_load_dwordx4 v125, s[64:67], s94 offen offset:1024 lds
    buffer_load_dwordx4 v126, s[64:67], s94 offen offset:2048 lds
    v_mfma_f32_16x16x32_bf16 v[188:191], v[68:71], a[36:39], v[188:191]
    s_waitcnt lgkmcnt(0)
    buffer_load_dwordx4 v127, s[64:67], s94 offen offset:3072 lds
    v_mfma_f32_16x16x32_bf16 v[176:179], v[80:83], a[40:43], v[176:179]
    s_waitcnt vmcnt(63)
    s_barrier
    ds_read_b64_tr_b16 v[64:65], v24 offset:28672
    s_add_u32 s94, s94, 114688
    s_sub_u32 s42, s94, 1605632
    s_cselect_b32 s94, s94, s42
    ds_read_b64_tr_b16 v[66:67], v24 offset:28928
    v_mfma_f32_16x16x32_bf16 v[184:187], v[80:83], a[44:47], v[184:187]
    ds_read_b64_tr_b16 v[68:69], v25 offset:28672
    ds_read_b64_tr_b16 v[70:71], v25 offset:28928
    v_mfma_f32_16x16x32_bf16 v[180:183], v[84:87], a[40:43], v[180:183]
    v_mfma_f32_16x16x32_bf16 v[188:191], v[84:87], a[44:47], v[188:191]
    s_waitcnt lgkmcnt(0)
    v_mfma_f32_16x16x32_bf16 v[176:179], v[64:67], a[48:51], v[176:179]
    ds_read_b64_tr_b16 v[80:81], v24 offset:30720
    ds_read_b64_tr_b16 v[82:83], v24 offset:30976
    v_mfma_f32_16x16x32_bf16 v[184:187], v[64:67], a[52:55], v[184:187]
    ds_read_b64_tr_b16 v[84:85], v25 offset:30720
    ds_read_b64_tr_b16 v[86:87], v25 offset:30976
    v_mfma_f32_16x16x32_bf16 v[180:183], v[68:71], a[48:51], v[180:183]
    v_mfma_f32_16x16x32_bf16 v[188:191], v[68:71], a[52:55], v[188:191]
    s_waitcnt lgkmcnt(0)
    s_waitcnt vmcnt(12)
    v_mfma_f32_16x16x32_bf16 v[176:179], v[80:83], a[56:59], v[176:179]
    s_waitcnt vmcnt(63)
    s_barrier
    ds_read_b64_tr_b16 v[64:65], v24 offset:32768
    ds_read_b64_tr_b16 a[208:209], v96 offset:32768
    ds_read_b64_tr_b16 v[66:67], v24 offset:33024
    ds_read_b64_tr_b16 a[210:211], v97 offset:32768
    v_mfma_f32_16x16x32_bf16 v[184:187], v[80:83], a[60:63], v[184:187]
    ds_read_b64_tr_b16 v[68:69], v25 offset:32768
    ds_read_b64_tr_b16 v[70:71], v25 offset:33024
    v_mfma_f32_16x16x32_bf16 v[180:183], v[84:87], a[56:59], v[180:183]
    ds_read_b64_tr_b16 a[212:213], v98 offset:32768
    ds_read_b64_tr_b16 a[214:215], v99 offset:32768
    v_mfma_f32_16x16x32_bf16 v[188:191], v[84:87], a[60:63], v[188:191]
    s_waitcnt lgkmcnt(0)
    ds_read_b64_tr_b16 a[216:217], v100 offset:32768
    v_mfma_f32_16x16x32_bf16 v[176:179], v[64:67], a[64:67], v[176:179]
    ds_read_b64_tr_b16 v[80:81], v24 offset:34816
    ds_read_b64_tr_b16 v[82:83], v24 offset:35072
    v_mfma_f32_16x16x32_bf16 v[184:187], v[64:67], a[68:71], v[184:187]
    ds_read_b64_tr_b16 v[84:85], v25 offset:34816
    ds_read_b64_tr_b16 v[86:87], v25 offset:35072
    v_mfma_f32_16x16x32_bf16 v[180:183], v[68:71], a[64:67], v[180:183]
    ds_read_b64_tr_b16 a[218:219], v101 offset:32768
    ds_read_b64_tr_b16 a[220:221], v102 offset:32768
    v_mfma_f32_16x16x32_bf16 v[188:191], v[68:71], a[68:71], v[188:191]
    s_waitcnt lgkmcnt(0)
    ds_read_b64_tr_b16 a[222:223], v103 offset:32768
    v_mfma_f32_16x16x32_bf16 v[176:179], v[80:83], a[72:75], v[176:179]
    s_waitcnt vmcnt(60)
    s_barrier
    ds_read_b64_tr_b16 v[64:65], v24 offset:36864
    ds_read_b64_tr_b16 v[66:67], v24 offset:37120
    v_mfma_f32_16x16x32_bf16 v[184:187], v[80:83], a[76:79], v[184:187]
    ds_read_b64_tr_b16 v[68:69], v25 offset:36864
    ds_read_b64_tr_b16 v[70:71], v25 offset:37120
    v_mfma_f32_16x16x32_bf16 v[180:183], v[84:87], a[72:75], v[180:183]
    v_mfma_f32_16x16x32_bf16 v[188:191], v[84:87], a[76:79], v[188:191]
    s_waitcnt lgkmcnt(0)
    v_mfma_f32_16x16x32_bf16 v[176:179], v[64:67], a[80:83], v[176:179]
    ds_read_b64_tr_b16 v[80:81], v24 offset:38912
    ds_read_b64_tr_b16 v[82:83], v24 offset:39168
    v_mfma_f32_16x16x32_bf16 v[184:187], v[64:67], a[84:87], v[184:187]
    ds_read_b64_tr_b16 v[84:85], v25 offset:38912
    ds_read_b64_tr_b16 v[86:87], v25 offset:39168
    v_mfma_f32_16x16x32_bf16 v[180:183], v[68:71], a[80:83], v[180:183]
    v_mfma_f32_16x16x32_bf16 v[188:191], v[68:71], a[84:87], v[188:191]
    s_waitcnt lgkmcnt(0)
    v_mfma_f32_16x16x32_bf16 v[176:179], v[80:83], a[88:91], v[176:179]
    s_waitcnt vmcnt(31)
    s_barrier
    ds_read_b64_tr_b16 v[64:65], v24 offset:40960
    s_waitcnt lgkmcnt(9)
    ds_read_b64_tr_b16 v[66:67], v24 offset:41216
    s_add_u32 m0, s16, 65536
    s_nop 0
    buffer_load_dwordx4 v124, s[64:67], s94 offen offset:0 lds
    v_mfma_f32_16x16x32_bf16 v[184:187], v[80:83], a[92:95], v[184:187]
    ds_read_b64_tr_b16 v[68:69], v25 offset:40960
    ds_read_b64_tr_b16 v[70:71], v25 offset:41216
    v_mfma_f32_16x16x32_bf16 v[180:183], v[84:87], a[88:91], v[180:183]
    buffer_load_dwordx4 v125, s[64:67], s94 offen offset:1024 lds
    buffer_load_dwordx4 v126, s[64:67], s94 offen offset:2048 lds
    v_mfma_f32_16x16x32_bf16 v[188:191], v[84:87], a[92:95], v[188:191]
    s_waitcnt lgkmcnt(0)
    buffer_load_dwordx4 v127, s[64:67], s94 offen offset:3072 lds
    v_mfma_f32_16x16x32_bf16 v[176:179], v[64:67], a[96:99], v[176:179]
    ds_read_b64_tr_b16 v[80:81], v24 offset:43008
    ds_read_b64_tr_b16 v[82:83], v24 offset:43264
    v_mfma_f32_16x16x32_bf16 v[184:187], v[64:67], a[100:103], v[184:187]
    ds_read_b64_tr_b16 v[84:85], v25 offset:43008
    ds_read_b64_tr_b16 v[86:87], v25 offset:43264
    v_mfma_f32_16x16x32_bf16 v[180:183], v[68:71], a[96:99], v[180:183]
    s_add_u32 s94, s94, 114688
    s_sub_u32 s42, s94, 1605632
    s_cselect_b32 s94, s94, s42
    v_mfma_f32_16x16x32_bf16 v[188:191], v[68:71], a[100:103], v[188:191]
    s_waitcnt lgkmcnt(0)
    s_waitcnt vmcnt(9)
    v_mfma_f32_16x16x32_bf16 v[176:179], v[80:83], a[104:107], v[176:179]
    ds_read_b64_tr_b16 a[224:225], v104 offset:0
    ds_read_b64_tr_b16 a[226:227], v105 offset:0
    v_mfma_f32_16x16x32_bf16 v[184:187], v[80:83], a[108:111], v[184:187]
    ds_read_b64_tr_b16 a[228:229], v106 offset:0
    ds_read_b64_tr_b16 a[230:231], v107 offset:0
    v_mfma_f32_16x16x32_bf16 v[180:183], v[84:87], a[104:107], v[180:183]
    ds_read_b64_tr_b16 a[232:233], v108 offset:0
    ds_read_b64_tr_b16 a[234:235], v109 offset:0
    v_mfma_f32_16x16x32_bf16 v[188:191], v[84:87], a[108:111], v[188:191]
    ds_read_b64_tr_b16 a[236:237], v110 offset:0
    ds_read_b64_tr_b16 a[238:239], v111 offset:0
    s_buffer_load_dword s28, s[56:59], s91 offset:0x4 glc
    s_barrier
    v_cvt_pk_bf16_f32 v192, v176, v177
    v_cvt_pk_bf16_f32 v193, v178, v179
    v_cvt_pk_bf16_f32 v194, v180, v181
    v_cvt_pk_bf16_f32 v195, v182, v183
    v_cvt_pk_bf16_f32 v216, v184, v185
    v_cvt_pk_bf16_f32 v217, v186, v187
    v_cvt_pk_bf16_f32 v218, v188, v189
    v_cvt_pk_bf16_f32 v219, v190, v191
    s_waitcnt lgkmcnt(0)
    s_waitcnt lgkmcnt(0)
    s_cmp_ge_u32 s28, 7
    s_cselect_b64 s[24:25], -1, 0
    v_mfma_f32_16x16x32_bf16 v[196:199], v[240:243], v[192:195], 0
    s_add_u32 m0, s19, 0
    s_add_u32 s42, s18, 0
    v_mfma_f32_16x16x32_bf16 v[200:203], v[244:247], v[192:195], 0
    s_mov_b64 exec, s[24:25]
    buffer_load_dwordx4 v16, s[56:59], s42 offen offset:0 lds
    s_mov_b64 exec, -1
    v_mfma_f32_16x16x32_bf16 v[220:223], v[240:243], v[216:219], 0
    s_mov_b64 exec, s[24:25]
    buffer_load_dwordx4 v16, s[56:59], s42 offen offset:1024 lds
    s_mov_b64 exec, -1
    v_mfma_f32_16x16x32_bf16 v[224:227], v[244:247], v[216:219], 0
    v_mov_b32 v14, 0xf149f2ca
    v_cndmask_b32 v14, 0, v14, s[100:101]
    v_max3_f32 v64, v196, v197, v198
    s_nop 0
    v_max3_f32 v144, v220, v221, v222
    s_mov_b64 exec, s[24:25]
    buffer_load_dwordx4 v16, s[56:59], s42 offen offset:2048 lds
    s_mov_b64 exec, -1
    v_max3_f32 v66, -v196, -v197, -v198
    s_mov_b64 exec, s[24:25]
    buffer_load_dwordx4 v16, s[56:59], s42 offen offset:3072 lds
    s_mov_b64 exec, -1
    v_max3_f32 v146, -v220, -v221, -v222
    s_add_u32 m0, s19, 4096
    s_add_u32 s42, s18, 4096
    s_mov_b64 exec, s[24:25]
    buffer_load_dwordx4 v16, s[56:59], s42 offen offset:0 lds
    s_mov_b64 exec, -1
    v_max3_f32 v64, v64, v199, v200
    s_mov_b64 exec, s[24:25]
    buffer_load_dwordx4 v16, s[56:59], s42 offen offset:1024 lds
    s_mov_b64 exec, -1
    v_max3_f32 v144, v144, v223, v224
    s_mov_b64 exec, s[24:25]
    buffer_load_dwordx4 v16, s[56:59], s42 offen offset:2048 lds
    s_mov_b64 exec, -1
    v_max3_f32 v66, v66, -v199, -v200
    s_add_u32 m0, s19, 86016
    s_add_u32 s42, s18, 7168
    s_mov_b64 exec, s[24:25]
    buffer_load_dwordx4 v16, s[56:59], s42 offen offset:0 lds
    s_mov_b64 exec, -1
    s_mov_b32 s60, s32
    s_and_b32 s61, s33, 0xffff
    s_mov_b32 s62, 0x188000
    s_mov_b32 s63, 0x00020000
    s_mov_b32 s52, s22
    s_and_b32 s53, s23, 0xffff
    s_mov_b32 s54, 0x62000
    s_mov_b32 s55, 0x00020000
    s_lshl_b32 s13, s76, 2
    s_add_u32 s13, s13, s72
    s_mul_i32 s13, s13, 57344
    s_add_u32 s15, s76, 1
    s_add_u32 s12, s15, s1
    s_sub_u32 s14, s12, 7
    s_cselect_b32 s12, s12, s14
    s_lshl_b32 s14, s12, 7
    s_add_u32 s84, s13, s14
    s_add_u32 s1, s1, 1
    s_cmp_eq_u32 s1, 6
    s_cselect_b32 s1, 0, s1
    s_add_u32 s12, s15, s1
    s_sub_u32 s14, s12, 7
    s_cselect_b32 s12, s12, s14
    s_lshl_b32 s14, s12, 7
    s_add_u32 s85, s13, s14
    s_add_u32 s1, s1, 1
    s_cmp_eq_u32 s1, 6
    s_cselect_b32 s1, 0, s1
    s_add_u32 s12, s15, s1
    s_sub_u32 s14, s12, 7
    s_cselect_b32 s12, s12, s14
    s_lshl_b32 s14, s12, 7
    s_add_u32 s86, s13, s14
    s_add_u32 s1, s1, 1
    s_cmp_eq_u32 s1, 6
    s_cselect_b32 s1, 0, s1
    s_add_u32 s12, s15, s1
    s_sub_u32 s14, s12, 7
    s_cselect_b32 s12, s12, s14
    s_lshl_b32 s14, s12, 7
    s_add_u32 s87, s13, s14
    s_add_u32 s1, s1, 1
    s_cmp_eq_u32 s1, 6
    s_cselect_b32 s1, 0, s1
    s_add_u32 s12, s15, s1
    s_sub_u32 s14, s12, 7
    s_cselect_b32 s12, s12, s14
    s_lshl_b32 s14, s12, 7
    s_add_u32 s88, s13, s14
    s_add_u32 s1, s1, 1
    s_cmp_eq_u32 s1, 6
    s_cselect_b32 s1, 0, s1
    s_add_u32 s12, s15, s1
    s_sub_u32 s14, s12, 7
    s_cselect_b32 s12, s12, s14
    s_lshl_b32 s14, s12, 7
    s_add_u32 s89, s13, s14
    s_lshl_b32 s14, s76, 7
    s_add_u32 s43, s13, s14
    s_mul_i32 s13, s72, 50176
    s_add_u32 s93, s13, s14
    s_and_b32 s12, s72, 1
    s_lshl_b32 s12, s12, 4
    v_xor_b32 v17, s12, v57
    s_mov_b64 exec, s[24:25]
    buffer_load_dwordx4 v16, s[56:59], s42 offen offset:1024 lds
    s_mov_b64 exec, -1
    v_xor_b32 v12, 16, v17
    s_mov_b64 exec, s[24:25]
    buffer_load_dwordx4 v16, s[56:59], s42 offen offset:2048 lds
    s_mov_b64 exec, -1
    v_add_u32 v18, 6144, v12
    s_mov_b64 exec, s[24:25]
    buffer_load_dwordx4 v16, s[56:59], s42 offen offset:3072 lds
    s_mov_b64 exec, -1
    v_add_u32 v19, 12288, v17
    s_add_u32 m0, s19, 90112
    s_add_u32 s42, s18, 11264
    s_mov_b64 exec, s[24:25]
    buffer_load_dwordx4 v16, s[56:59], s42 offen offset:0 lds
    s_mov_b64 exec, -1
    v_add_u32 v20, 18432, v12
    s_mov_b64 exec, s[24:25]
    buffer_load_dwordx4 v16, s[56:59], s42 offen offset:1024 lds
    s_mov_b64 exec, -1
    v_add_u32 v12, 14848, v12
    s_mov_b64 exec, s[24:25]
    buffer_load_dwordx4 v16, s[56:59], s42 offen offset:2048 lds
    s_mov_b64 exec, -1
    v_mov_b32 v13, 0x7ffffff0
    s_waitcnt lgkmcnt(0)
    v_cmp_gt_u32 vcc, 32, v1
    s_add_u32 m0, s16, 114688
    s_nop 0
    buffer_load_dwordx4 v124, s[64:67], s94 offen offset:0 lds
    v_cndmask_b32 v21, v12, v13, vcc
    buffer_load_dwordx4 v125, s[64:67], s94 offen offset:1024 lds
    v_max3_f32 v146, v146, -v223, -v224
    buffer_load_dwordx4 v126, s[64:67], s94 offen offset:2048 lds
    v_max3_f32 v64, v64, v201, v202
    v_max3_f32 v144, v144, v225, v226
    s_waitcnt vmcnt(21)
    v_max3_f32 v66, v66, -v201, -v202
    ds_read_b64_tr_b16 a[112:113], v96 offset:16384
    v_max3_f32 v146, v146, -v225, -v226
    ds_read_b64_tr_b16 a[114:115], v97 offset:16384
    v_max_f32 v64, v64, v203
    ds_read_b64_tr_b16 a[116:117], v98 offset:16384
    v_max_f32 v144, v144, v227
    buffer_load_dwordx4 v127, s[64:67], s94 offen offset:3072 lds
    s_add_u32 s94, s94, 114688
    s_sub_u32 s42, s94, 1605632
    s_cselect_b32 s94, s94, s42
    s_add_u32 s12, s72, 0
    s_and_b32 s12, s12, 3
    s_lshl_b32 s12, s12, 10
    v_add_u32 v22, s12, v16
    ds_read_b64_tr_b16 a[118:119], v99 offset:16384
    s_add_u32 s12, s72, 1
    s_and_b32 s12, s12, 3
    s_lshl_b32 s12, s12, 10
    v_add_u32 v23, s12, v16
    ds_read_b64_tr_b16 a[120:121], v100 offset:16384
    s_add_u32 s12, s72, 2
    s_and_b32 s12, s12, 3
    s_lshl_b32 s12, s12, 10
    v_add_u32 v24, s12, v16
    s_add_u32 m0, s16, 32768
    s_nop 0
    buffer_load_dwordx4 v124, s[64:67], s94 offen offset:0 lds
    s_add_u32 s12, s72, 3
    s_and_b32 s12, s12, 3
    s_lshl_b32 s12, s12, 10
    v_add_u32 v25, s12, v16
    ds_read_b64_tr_b16 a[122:123], v101 offset:16384
    s_lshl_b32 s12, s72, 13
    v_add_u32 v28, s12, v16
    ds_read_b64_tr_b16 a[124:125], v102 offset:16384
    v_max_f32_e64 v66, v66, -v203
    buffer_load_dwordx4 v125, s[64:67], s94 offen offset:1024 lds
    v_max_f32_e64 v146, v146, -v227
    ds_read_b64_tr_b16 a[126:127], v103 offset:16384
    v_permlane32_swap_b32 v64, v66
    v_permlane32_swap_b32 v144, v146
    v_max_f32 v64, v64, v66
    v_max_f32 v144, v144, v146
    v_mov_b32 v66, v64
    v_mov_b32 v146, v144
    s_nop 0
    v_permlane16_swap_b32 v64, v66
    v_permlane16_swap_b32 v144, v146
    buffer_load_dwordx4 v126, s[64:67], s94 offen offset:2048 lds
    v_max_f32 v64, v64, v66
    v_max_f32 v144, v144, v146
    v_mul_f32 v64, s82, v64
    v_mul_f32 v144, s82, v144
    v_mov_b32 v66, v64
    v_mov_b32 v146, v144
    s_nop 0
    v_permlane32_swap_b32 v64, v66
    v_permlane32_swap_b32 v144, v146
    v_add_f32 v68, v64, v14
    v_add_f32 v148, v144, v14
    v_add_f32 v70, v66, v14
    s_buffer_load_dword s28, s[56:59], s91 offset:0x4 glc
    v_add_f32 v150, v146, v14
    buffer_load_dwordx4 v127, s[64:67], s94 offen offset:3072 lds
    s_add_u32 s94, s94, 114688
    s_sub_u32 s42, s94, 1605632
    s_cselect_b32 s94, s94, s42
    v_pk_fma_f32 v[76:77], v[196:197], s[80:81], v[64:65] op_sel_hi:[1,1,0]
    s_waitcnt lgkmcnt(0)
    v_pk_fma_f32 v[156:157], v[220:221], s[80:81], v[144:145] op_sel_hi:[1,1,0]
    v_pk_fma_f32 v[84:85], v[196:197], s[82:83], v[66:67] op_sel_hi:[1,1,0]
    s_waitcnt vmcnt(22)
    v_pk_fma_f32 v[164:165], v[220:221], s[82:83], v[146:147] op_sel_hi:[1,1,0]
    ds_read_b64_tr_b16 a[128:129], v96 offset:32768
    v_pk_fma_f32 v[78:79], v[198:199], s[80:81], v[64:65] op_sel_hi:[1,1,0]
    ds_read_b64_tr_b16 a[130:131], v97 offset:32768
    v_pk_fma_f32 v[158:159], v[222:223], s[80:81], v[144:145] op_sel_hi:[1,1,0]
    s_add_u32 m0, s16, 49152
    s_nop 0
    buffer_load_dwordx4 v124, s[64:67], s94 offen offset:0 lds
    v_pk_fma_f32 v[86:87], v[198:199], s[82:83], v[66:67] op_sel_hi:[1,1,0]
    ds_read_b64_tr_b16 a[132:133], v98 offset:32768
    v_pk_fma_f32 v[166:167], v[222:223], s[82:83], v[146:147] op_sel_hi:[1,1,0]
L_hop3:
    s_cbranch_execz L_hret1
    ds_read_b64_tr_b16 a[134:135], v99 offset:32768
    v_pk_fma_f32 v[80:81], v[200:201], s[80:81], v[68:69] op_sel_hi:[1,1,0]
    ds_read_b64_tr_b16 a[136:137], v100 offset:32768
    v_pk_fma_f32 v[160:161], v[224:225], s[80:81], v[148:149] op_sel_hi:[1,1,0]
    ds_read_b64_tr_b16 a[138:139], v101 offset:32768
    v_pk_fma_f32 v[88:89], v[200:201], s[82:83], v[70:71] op_sel_hi:[1,1,0]
    ds_read_b64_tr_b16 a[140:141], v102 offset:32768
    v_pk_fma_f32 v[168:169], v[224:225], s[82:83], v[150:151] op_sel_hi:[1,1,0]
    buffer_load_dwordx4 v125, s[64:67], s94 offen offset:1024 lds
    v_pk_fma_f32 v[82:83], v[202:203], s[80:81], v[68:69] op_sel_hi:[1,1,0]
    ds_read_b64_tr_b16 a[142:143], v103 offset:32768
    v_pk_fma_f32 v[162:163], v[226:227], s[80:81], v[148:149] op_sel_hi:[1,1,0]
    v_pk_fma_f32 v[90:91], v[202:203], s[82:83], v[70:71] op_sel_hi:[1,1,0]
    v_pk_fma_f32 v[170:171], v[226:227], s[82:83], v[150:151] op_sel_hi:[1,1,0]
    v_exp_f32 v76, v76
    v_exp_f32 v156, v156
    v_exp_f32 v84, v84
    v_exp_f32 v164, v164
    buffer_load_dwordx4 v126, s[64:67], s94 offen offset:2048 lds
    v_exp_f32 v77, v77
    v_exp_f32 v157, v157
    v_exp_f32 v85, v85
    v_exp_f32 v165, v165
    v_exp_f32 v78, v78
    v_exp_f32 v158, v158
    v_exp_f32 v86, v86
    buffer_load_dwordx4 v127, s[64:67], s94 offen offset:3072 lds
    s_add_u32 s94, s94, 114688
    s_sub_u32 s42, s94, 1605632
    s_cselect_b32 s94, s94, s42
    v_exp_f32 v166, v166
    s_waitcnt lgkmcnt(0)
    v_exp_f32 v79, v79
    v_exp_f32 v159, v159
    v_exp_f32 v87, v87
    v_exp_f32 v167, v167
    s_add_u32 m0, s16, 65536
    s_nop 0
    buffer_load_dwordx4 v124, s[64:67], s94 offen offset:0 lds
    v_exp_f32 v80, v80
    v_exp_f32 v160, v160
    s_waitcnt lgkmcnt(0)
    s_cmp_ge_u32 s28, 7
    s_cselect_b64 s[10:11], -1, 0
    s_andn2_b64 s[24:25], s[10:11], s[24:25]
    v_exp_f32 v88, v88
    v_exp_f32 v168, v168
    s_add_u32 m0, s19, 0
    s_add_u32 s42, s18, 0
    s_mov_b64 exec, s[24:25]
    buffer_load_dwordx4 v16, s[56:59], s42 offen offset:0 lds
    s_mov_b64 exec, -1
    v_exp_f32 v81, v81
    v_exp_f32 v161, v161
    v_exp_f32 v89, v89
    v_exp_f32 v169, v169
    v_exp_f32 v82, v82
    s_mov_b64 exec, s[24:25]
    buffer_load_dwordx4 v16, s[56:59], s42 offen offset:1024 lds
    s_mov_b64 exec, -1
    v_exp_f32 v162, v162
    v_exp_f32 v90, v90
    v_exp_f32 v170, v170
    v_exp_f32 v83, v83
    v_exp_f32 v163, v163
    v_exp_f32 v91, v91
    s_mov_b64 exec, s[24:25]
    buffer_load_dwordx4 v16, s[56:59], s42 offen offset:2048 lds
    s_mov_b64 exec, -1
    v_exp_f32 v171, v171
    v_pk_add_f32 v[72:73], v[76:77], v[78:79]
    v_pk_add_f32 v[152:153], v[156:157], v[158:159]
    v_pk_add_f32 v[74:75], v[84:85], v[86:87]
    v_pk_add_f32 v[154:155], v[164:165], v[166:167]
    v_pk_add_f32 v[68:69], v[80:81], v[82:83]
    v_pk_add_f32 v[148:149], v[160:161], v[162:163]
    v_pk_add_f32 v[70:71], v[88:89], v[90:91]
    v_pk_add_f32 v[150:151], v[168:169], v[170:171]
    s_mov_b64 exec, s[24:25]
    buffer_load_dwordx4 v16, s[56:59], s42 offen offset:3072 lds
    s_mov_b64 exec, -1
    v_pk_add_f32 v[72:73], v[72:73], v[68:69]
    v_pk_add_f32 v[152:153], v[152:153], v[148:149]
    v_pk_add_f32 v[74:75], v[74:75], v[70:71]
    v_pk_add_f32 v[154:155], v[154:155], v[150:151]
    v_add_f32 v64, v72, v73
    v_add_f32 v144, v152, v153
    v_add_f32 v66, v74, v75
    v_add_f32 v146, v154, v155
    s_nop 0
    v_permlane32_swap_b32 v64, v66
    v_permlane32_swap_b32 v144, v146
    s_add_u32 m0, s19, 4096
    s_add_u32 s42, s18, 4096
    s_mov_b64 exec, s[24:25]
    buffer_load_dwordx4 v16, s[56:59], s42 offen offset:0 lds
    s_mov_b64 exec, -1
    v_add_f32 v64, v64, v66
    v_add_f32 v144, v144, v146
    v_mov_b32 v66, v64
    v_mov_b32 v146, v144
    s_nop 0
    v_permlane16_swap_b32 v64, v66
    v_permlane16_swap_b32 v144, v146
    v_add_f32 v64, v64, v66
    v_add_f32 v144, v144, v146
    s_mov_b64 exec, s[24:25]
    buffer_load_dwordx4 v16, s[56:59], s42 offen offset:1024 lds
    s_mov_b64 exec, -1
    v_rcp_f32 v64, v64
    v_rcp_f32 v144, v144
    v_mov_b32 v66, v64
    v_mov_b32 v146, v144
    s_nop 0
    v_permlane32_swap_b32 v64, v66
    v_permlane32_swap_b32 v144, v146
    v_pk_mul_f32 v[76:77], v[76:77], v[64:65] op_sel_hi:[1,0]
    v_pk_mul_f32 v[156:157], v[156:157], v[144:145] op_sel_hi:[1,0]
    v_pk_mul_f32 v[84:85], v[84:85], v[66:67] op_sel_hi:[1,0]
    s_mov_b64 exec, s[24:25]
    buffer_load_dwordx4 v16, s[56:59], s42 offen offset:2048 lds
    s_mov_b64 exec, -1
    v_pk_mul_f32 v[164:165], v[164:165], v[146:147] op_sel_hi:[1,0]
    v_pk_mul_f32 v[78:79], v[78:79], v[64:65] op_sel_hi:[1,0]
    v_pk_mul_f32 v[158:159], v[158:159], v[144:145] op_sel_hi:[1,0]
    v_pk_mul_f32 v[86:87], v[86:87], v[66:67] op_sel_hi:[1,0]
    v_pk_mul_f32 v[166:167], v[166:167], v[146:147] op_sel_hi:[1,0]
    v_pk_mul_f32 v[80:81], v[80:81], v[64:65] op_sel_hi:[1,0]
    v_pk_mul_f32 v[160:161], v[160:161], v[144:145] op_sel_hi:[1,0]
    v_pk_mul_f32 v[88:89], v[88:89], v[66:67] op_sel_hi:[1,0]
    v_pk_mul_f32 v[168:169], v[168:169], v[146:147] op_sel_hi:[1,0]
    v_pk_mul_f32 v[82:83], v[82:83], v[64:65] op_sel_hi:[1,0]
    v_pk_mul_f32 v[162:163], v[162:163], v[144:145] op_sel_hi:[1,0]
    s_add_u32 m0, s19, 86016
    s_add_u32 s42, s18, 7168
    s_mov_b64 exec, s[24:25]
    buffer_load_dwordx4 v16, s[56:59], s42 offen offset:0 lds
    s_mov_b64 exec, -1
    v_pk_mul_f32 v[90:91], v[90:91], v[66:67] op_sel_hi:[1,0]
    v_pk_mul_f32 v[170:171], v[170:171], v[146:147] op_sel_hi:[1,0]
    v_cvt_pk_bf16_f32 v204, v76, v77
    v_cvt_pk_bf16_f32 v228, v156, v157
    v_cvt_pk_bf16_f32 v208, v84, v85
    v_cvt_pk_bf16_f32 v232, v164, v165
    v_cvt_pk_bf16_f32 v205, v78, v79
    v_cvt_pk_bf16_f32 v229, v158, v159
    v_cvt_pk_bf16_f32 v209, v86, v87
    s_mov_b64 exec, s[24:25]
    buffer_load_dwordx4 v16, s[56:59], s42 offen offset:1024 lds
    s_mov_b64 exec, -1
    v_cvt_pk_bf16_f32 v233, v166, v167
    v_cvt_pk_bf16_f32 v206, v80, v81
    v_cvt_pk_bf16_f32 v230, v160, v161
    v_cvt_pk_bf16_f32 v210, v88, v89
    v_cvt_pk_bf16_f32 v234, v168, v169
    v_cvt_pk_bf16_f32 v207, v82, v83
    v_cvt_pk_bf16_f32 v231, v162, v163
    v_cvt_pk_bf16_f32 v211, v90, v91
    v_cvt_pk_bf16_f32 v235, v170, v171
    v_accvgpr_write_b32 a240, v204
    v_accvgpr_write_b32 a241, v205
    s_mov_b64 exec, s[24:25]
    buffer_load_dwordx4 v16, s[56:59], s42 offen offset:2048 lds
    s_mov_b64 exec, -1
    v_accvgpr_write_b32 a242, v206
    v_accvgpr_write_b32 a243, v207
    v_accvgpr_write_b32 a244, v208
    v_accvgpr_write_b32 a245, v209
    v_accvgpr_write_b32 a246, v210
    v_accvgpr_write_b32 a247, v211
    v_accvgpr_write_b32 a248, v228
    s_waitcnt vmcnt(19)
    v_accvgpr_write_b32 a249, v229
    ds_read_b64_tr_b16 a[144:145], v104 offset:0
    v_accvgpr_write_b32 a250, v230
    s_mov_b64 exec, s[24:25]
    buffer_load_dwordx4 v16, s[56:59], s42 offen offset:3072 lds
    s_mov_b64 exec, -1
    v_accvgpr_write_b32 a251, v231
    ds_read_b64_tr_b16 a[146:147], v105 offset:0
    v_accvgpr_write_b32 a252, v232
    ds_read_b64_tr_b16 a[148:149], v106 offset:0
    v_accvgpr_write_b32 a253, v233
    ds_read_b64_tr_b16 a[150:151], v107 offset:0
    v_accvgpr_write_b32 a254, v234
    ds_read_b64_tr_b16 a[152:153], v108 offset:0
    v_accvgpr_write_b32 a255, v235
    ds_read_b64_tr_b16 a[154:155], v109 offset:0
    v_lshl_add_u32 v4, v1, 5, s19
    s_add_u32 m0, s19, 90112
    s_add_u32 s42, s18, 11264
    s_mov_b64 exec, s[24:25]
    buffer_load_dwordx4 v16, s[56:59], s42 offen offset:0 lds
    s_mov_b64 exec, -1
    v_add_u32 v5, 0x15000, v4
    ds_read_b64_tr_b16 a[156:157], v110 offset:0
    s_mov_b64 exec, s[24:25]
    buffer_load_dwordx4 v16, s[56:59], s42 offen offset:1024 lds
    s_mov_b64 exec, -1
    s_mov_b64 exec, s[24:25]
    buffer_load_dwordx4 v16, s[56:59], s42 offen offset:2048 lds
    s_mov_b64 exec, -1
    s_cmp_ge_u32 s28, 7
    s_nop 0
    s_cbranch_scc1 L_x_done
    s_mov_b32 s9, 0
    s_nop 0
L_pl_x:
    s_buffer_load_dword s28, s[56:59], s91 offset:0x4 glc
    s_add_u32 s9, s9, 1
    s_waitcnt lgkmcnt(0)
    s_cmp_ge_u32 s28, 7
    s_nop 0
    s_cbranch_scc1 L_pw_x
    s_cmp_lt_u32 s9, 40000
    s_nop 0
    s_cbranch_scc1 L_pl_x
    s_nop 0
L_pw_x:
    s_add_u32 m0, s19, 0
    s_add_u32 s42, s18, 0
    buffer_load_dwordx4 v16, s[56:59], s42 offen offset:0 lds
    s_add_u32 m0, s19, 0
    s_add_u32 s42, s18, 0
    buffer_load_dwordx4 v16, s[56:59], s42 offen offset:1024 lds
    s_add_u32 m0, s19, 0
    s_add_u32 s42, s18, 0
    buffer_load_dwordx4 v16, s[56:59], s42 offen offset:2048 lds
    s_add_u32 m0, s19, 0
    s_add_u32 s42, s18, 0
    buffer_load_dwordx4 v16, s[56:59], s42 offen offset:3072 lds
    s_add_u32 m0, s19, 4096
    s_add_u32 s42, s18, 4096
    buffer_load_dwordx4 v16, s[56:59], s42 offen offset:0 lds
    s_add_u32 m0, s19, 4096
    s_add_u32 s42, s18, 4096
    buffer_load_dwordx4 v16, s[56:59], s42 offen offset:1024 lds
    s_add_u32 m0, s19, 4096
    s_add_u32 s42, s18, 4096
    buffer_load_dwordx4 v16, s[56:59], s42 offen offset:2048 lds
    s_add_u32 m0, s19, 86016
    s_add_u32 s42, s18, 7168
    buffer_load_dwordx4 v16, s[56:59], s42 offen offset:0 lds
    s_add_u32 m0, s19, 86016
    s_add_u32 s42, s18, 7168
    buffer_load_dwordx4 v16, s[56:59], s42 offen offset:1024 lds
    s_add_u32 m0, s19, 86016
    s_add_u32 s42, s18, 7168
    buffer_load_dwordx4 v16, s[56:59], s42 offen offset:2048 lds
    s_add_u32 m0, s19, 86016
    s_add_u32 s42, s18, 7168
    buffer_load_dwordx4 v16, s[56:59], s42 offen offset:3072 lds
    s_add_u32 m0, s19, 90112
    s_add_u32 s42, s18, 11264
    buffer_load_dwordx4 v16, s[56:59], s42 offen offset:0 lds
    s_add_u32 m0, s19, 90112
    s_add_u32 s42, s18, 11264
    buffer_load_dwordx4 v16, s[56:59], s42 offen offset:1024 lds
    s_add_u32 m0, s19, 90112
    s_add_u32 s42, s18, 11264
    buffer_load_dwordx4 v16, s[56:59], s42 offen offset:2048 lds
    s_waitcnt vmcnt(0)
    s_nop 0
L_x_done:
    s_waitcnt vmcnt(0)
    ds_read2st64_b32 v[64:65], v4 offset0:0 offset1:8
    ds_read2st64_b32 v[66:67], v4 offset0:16 offset1:20
    ds_read2st64_b32 v[68:69], v5 offset0:0 offset1:8
    ds_read2st64_b32 v[70:71], v5 offset0:16 offset1:20
    s_waitcnt lgkmcnt(0)
    v_max3_u32 v64, v64, v65, v66
    v_max3_u32 v67, v67, v68, v69
    v_max3_u32 v64, v64, v70, v71
    v_max_u32 v64, v64, v67
    v_cmp_eq_u32 vcc, -1, v64
    s_nop 4
    s_cbranch_vccnz L_x1redo
    s_nop 0
L_x1ok:
    s_barrier
    ds_read_b64_tr_b16 a[158:159], v111 offset:0
    v_add_u32 v120, s35, v16
    v_lshlrev_b32 v14, 4, v2
    v_lshl_add_u32 v14, v3, 6, v14
    buffer_load_dwordx4 v[208:211], v14, s[56:59], s20 offen offset:0
    ds_read_b128 a[0:3], v120 offset:0
    s_waitcnt vmcnt(20)
    ds_read_b128 a[4:7], v120 offset:7168
    ds_read_b64_tr_b16 a[160:161], v96 offset:0
    ds_read_b128 a[8:11], v120 offset:14336
    ds_read_b64_tr_b16 a[162:163], v97 offset:0
    ds_read_b128 a[12:15], v120 offset:21504
    buffer_load_dwordx4 v[216:219], v14, s[56:59], s20 offen offset:1024
    s_add_u32 s35, s35, 1024
    s_cmp_eq_u32 s35, 7168
    s_cselect_b32 s35, 86016, s35
    s_cmp_eq_u32 s35, 93184
    s_cselect_b32 s35, 0, s35
    s_waitcnt lgkmcnt(0)
    v_mfma_f32_16x16x32_bf16 v[144:147], a[176:179], a[0:3], 0
    ds_read_b64_tr_b16 a[164:165], v98 offset:0
    ds_read_b64_tr_b16 a[166:167], v99 offset:0
    ds_read_b64_tr_b16 a[168:169], v100 offset:0
    ds_read_b64_tr_b16 a[170:171], v101 offset:0
    ds_read_b64_tr_b16 a[172:173], v102 offset:0
    ds_read_b64_tr_b16 a[174:175], v103 offset:0
    v_mfma_f32_16x16x32_bf16 v[160:163], a[176:179], a[4:7], 0
    v_add_u32 v120, s35, v16
    ds_read_b128 a[16:19], v120 offset:0
    v_mfma_f32_16x16x32_bf16 v[176:179], a[176:179], a[8:11], 0
    ds_read_b128 a[20:23], v120 offset:7168
    ds_read_b128 a[24:27], v120 offset:14336
    v_mfma_f32_16x16x32_bf16 v[192:195], a[176:179], a[12:15], 0
    ds_read_b128 a[28:31], v120 offset:21504
    buffer_load_dwordx4 v[224:227], v14, s[56:59], s20 offen offset:2048
    v_mfma_f32_16x16x32_bf16 v[148:151], a[180:183], a[0:3], 0
    s_add_u32 s35, s35, 1024
    s_cmp_eq_u32 s35, 7168
    s_cselect_b32 s35, 86016, s35
    v_mfma_f32_16x16x32_bf16 v[164:167], a[180:183], a[4:7], 0
    s_cmp_eq_u32 s35, 93184
    s_cselect_b32 s35, 0, s35
    v_mfma_f32_16x16x32_bf16 v[180:183], a[180:183], a[8:11], 0
    buffer_load_dwordx4 v[232:235], v14, s[56:59], s20 offen offset:3072
    s_waitcnt lgkmcnt(15)
    v_mfma_f32_16x16x32_bf16 v[196:199], a[180:183], a[12:15], 0
    v_mfma_f32_16x16x32_bf16 v[152:155], a[184:187], a[0:3], 0
    s_waitcnt lgkmcnt(4)
    v_mfma_f32_16x16x32_bf16 v[168:171], a[184:187], a[4:7], 0
    v_mfma_f32_16x16x32_bf16 v[184:187], a[184:187], a[8:11], 0
    v_mfma_f32_16x16x32_bf16 v[200:203], a[184:187], a[12:15], 0
    s_add_u32 m0, s16, 65536
    s_nop 0
    buffer_load_dwordx4 v125, s[64:67], s94 offen offset:1024 lds
    v_mfma_f32_16x16x32_bf16 v[156:159], a[188:191], a[0:3], 0
    v_mfma_f32_16x16x32_bf16 v[172:175], a[188:191], a[4:7], 0
    v_mfma_f32_16x16x32_bf16 v[188:191], a[188:191], a[8:11], 0
    v_mfma_f32_16x16x32_bf16 v[204:207], a[188:191], a[12:15], 0
    s_waitcnt lgkmcnt(0)
    buffer_load_dwordx4 v126, s[64:67], s94 offen offset:2048 lds
    v_mfma_f32_16x16x32_bf16 v[144:147], a[192:195], a[16:19], v[144:147]
    v_add_u32 v120, s35, v16
    ds_read_b128 a[0:3], v120 offset:0
    v_mfma_f32_16x16x32_bf16 v[160:163], a[192:195], a[20:23], v[160:163]
    ds_read_b128 a[4:7], v120 offset:7168
    ds_read_b128 a[8:11], v120 offset:14336
    v_mfma_f32_16x16x32_bf16 v[176:179], a[192:195], a[24:27], v[176:179]
    ds_read_b128 a[12:15], v120 offset:21504
    v_mfma_f32_16x16x32_bf16 v[192:195], a[192:195], a[28:31], v[192:195]
    s_add_u32 s35, s35, 1024
    s_cmp_eq_u32 s35, 7168
    s_cselect_b32 s35, 86016, s35
    v_mfma_f32_16x16x32_bf16 v[148:151], a[196:199], a[16:19], v[148:151]
    s_cmp_eq_u32 s35, 93184
    s_cselect_b32 s35, 0, s35
    v_mfma_f32_16x16x32_bf16 v[164:167], a[196:199], a[20:23], v[164:167]
    buffer_load_dwordx4 v127, s[64:67], s94 offen offset:3072 lds
    v_mfma_f32_16x16x32_bf16 v[180:183], a[196:199], a[24:27], v[180:183]
    s_add_u32 s94, s94, 114688
    s_sub_u32 s42, s94, 1605632
    s_cselect_b32 s94, s94, s42
    v_mfma_f32_16x16x32_bf16 v[196:199], a[196:199], a[28:31], v[196:199]
    v_mfma_f32_16x16x32_bf16 v[152:155], a[200:203], a[16:19], v[152:155]
    v_mfma_f32_16x16x32_bf16 v[168:171], a[200:203], a[20:23], v[168:171]
    s_add_u32 m0, s16, 114688
    s_nop 0
    buffer_load_dwordx4 v124, s[64:67], s94 offen offset:0 lds
    v_mfma_f32_16x16x32_bf16 v[184:187], a[200:203], a[24:27], v[184:187]
    v_mfma_f32_16x16x32_bf16 v[200:203], a[200:203], a[28:31], v[200:203]
    v_mfma_f32_16x16x32_bf16 v[156:159], a[204:207], a[16:19], v[156:159]
    v_mfma_f32_16x16x32_bf16 v[172:175], a[204:207], a[20:23], v[172:175]
    buffer_load_dwordx4 v125, s[64:67], s94 offen offset:1024 lds
    v_mfma_f32_16x16x32_bf16 v[188:191], a[204:207], a[24:27], v[188:191]
    v_mfma_f32_16x16x32_bf16 v[204:207], a[204:207], a[28:31], v[204:207]
    s_waitcnt lgkmcnt(0)
    v_mfma_f32_16x16x32_bf16 v[144:147], a[208:211], a[0:3], v[144:147]
    v_add_u32 v120, s35, v16
    ds_read_b128 a[16:19], v120 offset:0
    v_mfma_f32_16x16x32_bf16 v[160:163], a[208:211], a[4:7], v[160:163]
    ds_read_b128 a[20:23], v120 offset:7168
    ds_read_b128 a[24:27], v120 offset:14336
    v_mfma_f32_16x16x32_bf16 v[176:179], a[208:211], a[8:11], v[176:179]
    ds_read_b128 a[28:31], v120 offset:21504
    buffer_load_dwordx4 v126, s[64:67], s94 offen offset:2048 lds
    v_mfma_f32_16x16x32_bf16 v[192:195], a[208:211], a[12:15], v[192:195]
    s_add_u32 s35, s35, 1024
    s_cmp_eq_u32 s35, 7168
    s_cselect_b32 s35, 86016, s35
    v_mfma_f32_16x16x32_bf16 v[148:151], a[212:215], a[0:3], v[148:151]
    s_cmp_eq_u32 s35, 93184
    s_cselect_b32 s35, 0, s35
    v_mfma_f32_16x16x32_bf16 v[164:167], a[212:215], a[4:7], v[164:167]
    v_mfma_f32_16x16x32_bf16 v[180:183], a[212:215], a[8:11], v[180:183]
    v_mfma_f32_16x16x32_bf16 v[196:199], a[212:215], a[12:15], v[196:199]
    buffer_load_dwordx4 v127, s[64:67], s94 offen offset:3072 lds
    v_mfma_f32_16x16x32_bf16 v[152:155], a[216:219], a[0:3], v[152:155]
    s_add_u32 s94, s94, 114688
    s_sub_u32 s42, s94, 1605632
    s_cselect_b32 s94, s94, s42
    v_mfma_f32_16x16x32_bf16 v[168:171], a[216:219], a[4:7], v[168:171]
    v_mfma_f32_16x16x32_bf16 v[184:187], a[216:219], a[8:11], v[184:187]
    v_mfma_f32_16x16x32_bf16 v[200:203], a[216:219], a[12:15], v[200:203]
    s_add_u32 m0, s16, 32768
    s_nop 0
    buffer_load_dwordx4 v124, s[64:67], s94 offen offset:0 lds
    v_mfma_f32_16x16x32_bf16 v[156:159], a[220:223], a[0:3], v[156:159]
    v_mfma_f32_16x16x32_bf16 v[172:175], a[220:223], a[4:7], v[172:175]
    v_mfma_f32_16x16x32_bf16 v[188:191], a[220:223], a[8:11], v[188:191]
    v_mfma_f32_16x16x32_bf16 v[204:207], a[220:223], a[12:15], v[204:207]
    s_waitcnt lgkmcnt(0)
    v_mfma_f32_16x16x32_bf16 v[144:147], a[224:227], a[16:19], v[144:147]
    v_add_u32 v120, s35, v16
    ds_read_b128 a[0:3], v120 offset:0
    v_mfma_f32_16x16x32_bf16 v[160:163], a[224:227], a[20:23], v[160:163]
    ds_read_b128 a[4:7], v120 offset:7168
    ds_read_b128 a[8:11], v120 offset:14336
    v_mfma_f32_16x16x32_bf16 v[176:179], a[224:227], a[24:27], v[176:179]
    ds_read_b128 a[12:15], v120 offset:21504
    buffer_load_dwordx4 v125, s[64:67], s94 offen offset:1024 lds
    v_mfma_f32_16x16x32_bf16 v[192:195], a[224:227], a[28:31], v[192:195]
    s_add_u32 s35, s35, 1024
    s_cmp_eq_u32 s35, 7168
    s_cselect_b32 s35, 86016, s35
    v_mfma_f32_16x16x32_bf16 v[148:151], a[228:231], a[16:19], v[148:151]
    s_cmp_eq_u32 s35, 93184
    s_cselect_b32 s35, 0, s35
    v_mfma_f32_16x16x32_bf16 v[164:167], a[228:231], a[20:23], v[164:167]
    buffer_load_dwordx4 v126, s[64:67], s94 offen offset:2048 lds
    v_mfma_f32_16x16x32_bf16 v[180:183], a[228:231], a[24:27], v[180:183]
    v_mfma_f32_16x16x32_bf16 v[196:199], a[228:231], a[28:31], v[196:199]
    v_mfma_f32_16x16x32_bf16 v[152:155], a[232:235], a[16:19], v[152:155]
    v_mfma_f32_16x16x32_bf16 v[168:171], a[232:235], a[20:23], v[168:171]
    buffer_load_dwordx4 v127, s[64:67], s94 offen offset:3072 lds
    v_mfma_f32_16x16x32_bf16 v[184:187], a[232:235], a[24:27], v[184:187]
    s_add_u32 s94, s94, 114688
    s_sub_u32 s42, s94, 1605632
    s_cselect_b32 s94, s94, s42
    v_mfma_f32_16x16x32_bf16 v[200:203], a[232:235], a[28:31], v[200:203]
    v_mfma_f32_16x16x32_bf16 v[156:159], a[236:239], a[16:19], v[156:159]
    v_mfma_f32_16x16x32_bf16 v[172:175], a[236:239], a[20:23], v[172:175]
    v_mfma_f32_16x16x32_bf16 v[188:191], a[236:239], a[24:27], v[188:191]
    s_add_u32 m0, s16, 131072
    s_nop 0
    buffer_load_dwordx4 v124, s[64:67], s94 offen offset:0 lds
    v_mfma_f32_16x16x32_bf16 v[204:207], a[236:239], a[28:31], v[204:207]
    s_waitcnt lgkmcnt(0)
    v_mfma_f32_16x16x32_bf16 v[144:147], a[112:115], a[0:3], v[144:147]
    v_add_u32 v120, s35, v16
    ds_read_b128 a[16:19], v120 offset:0
    v_mfma_f32_16x16x32_bf16 v[160:163], a[112:115], a[4:7], v[160:163]
    ds_read_b128 a[20:23], v120 offset:7168
    ds_read_b128 a[24:27], v120 offset:14336
    v_mfma_f32_16x16x32_bf16 v[176:179], a[112:115], a[8:11], v[176:179]
    ds_read_b128 a[28:31], v120 offset:21504
    buffer_load_dwordx4 v125, s[64:67], s94 offen offset:1024 lds
    v_mfma_f32_16x16x32_bf16 v[192:195], a[112:115], a[12:15], v[192:195]
    s_add_u32 s35, s35, 1024
    s_cmp_eq_u32 s35, 7168
    s_cselect_b32 s35, 86016, s35
    v_mfma_f32_16x16x32_bf16 v[148:151], a[116:119], a[0:3], v[148:151]
    s_cmp_eq_u32 s35, 93184
    s_cselect_b32 s35, 0, s35
    v_mfma_f32_16x16x32_bf16 v[164:167], a[116:119], a[4:7], v[164:167]
    v_mfma_f32_16x16x32_bf16 v[180:183], a[116:119], a[8:11], v[180:183]
    v_mfma_f32_16x16x32_bf16 v[196:199], a[116:119], a[12:15], v[196:199]
    buffer_load_dwordx4 v126, s[64:67], s94 offen offset:2048 lds
    v_mfma_f32_16x16x32_bf16 v[152:155], a[120:123], a[0:3], v[152:155]
    v_mfma_f32_16x16x32_bf16 v[168:171], a[120:123], a[4:7], v[168:171]
    v_mfma_f32_16x16x32_bf16 v[184:187], a[120:123], a[8:11], v[184:187]
    v_mfma_f32_16x16x32_bf16 v[200:203], a[120:123], a[12:15], v[200:203]
    v_mfma_f32_16x16x32_bf16 v[156:159], a[124:127], a[0:3], v[156:159]
    buffer_load_dwordx4 v127, s[64:67], s94 offen offset:3072 lds
    v_mfma_f32_16x16x32_bf16 v[172:175], a[124:127], a[4:7], v[172:175]
    s_add_u32 s94, s94, 114688
    s_sub_u32 s42, s94, 1605632
    s_cselect_b32 s94, s94, s42
    v_mfma_f32_16x16x32_bf16 v[188:191], a[124:127], a[8:11], v[188:191]
    v_mfma_f32_16x16x32_bf16 v[204:207], a[124:127], a[12:15], v[204:207]
    s_waitcnt lgkmcnt(0)
    v_mfma_f32_16x16x32_bf16 v[144:147], a[128:131], a[16:19], v[144:147]
    v_add_u32 v120, s35, v16
    ds_read_b128 a[0:3], v120 offset:0
    v_mfma_f32_16x16x32_bf16 v[160:163], a[128:131], a[20:23], v[160:163]
    ds_read_b128 a[4:7], v120 offset:7168
    ds_read_b128 a[8:11], v120 offset:14336
    v_mfma_f32_16x16x32_bf16 v[176:179], a[128:131], a[24:27], v[176:179]
    ds_read_b128 a[12:15], v120 offset:21504
    buffer_load_dwordx2 v[58:59], off, s[56:59], s91 offset:16 sc1
    v_mfma_f32_16x16x32_bf16 v[192:195], a[128:131], a[28:31], v[192:195]
    s_add_u32 s35, s35, 1024
    s_cmp_eq_u32 s35, 7168
    s_cselect_b32 s35, 86016, s35
    v_mfma_f32_16x16x32_bf16 v[148:151], a[132:135], a[16:19], v[148:151]
    s_cmp_eq_u32 s35, 93184
    s_cselect_b32 s35, 0, s35
    s_add_u32 m0, s16, 147456
    v_mfma_f32_16x16x32_bf16 v[164:167], a[132:135], a[20:23], v[164:167]
    buffer_load_dwordx4 v124, s[64:67], s94 offen offset:0 lds
    v_mfma_f32_16x16x32_bf16 v[180:183], a[132:135], a[24:27], v[180:183]
    v_mfma_f32_16x16x32_bf16 v[196:199], a[132:135], a[28:31], v[196:199]
    buffer_load_dwordx4 v125, s[64:67], s94 offen offset:1024 lds
    v_mfma_f32_16x16x32_bf16 v[152:155], a[136:139], a[16:19], v[152:155]
    v_mfma_f32_16x16x32_bf16 v[168:171], a[136:139], a[20:23], v[168:171]
    v_mfma_f32_16x16x32_bf16 v[184:187], a[136:139], a[24:27], v[184:187]
    v_mfma_f32_16x16x32_bf16 v[200:203], a[136:139], a[28:31], v[200:203]
    v_mfma_f32_16x16x32_bf16 v[156:159], a[140:143], a[16:19], v[156:159]
    buffer_load_dwordx4 v126, s[64:67], s94 offen offset:2048 lds
    v_mfma_f32_16x16x32_bf16 v[172:175], a[140:143], a[20:23], v[172:175]
    v_mfma_f32_16x16x32_bf16 v[188:191], a[140:143], a[24:27], v[188:191]
    v_mfma_f32_16x16x32_bf16 v[204:207], a[140:143], a[28:31], v[204:207]
    s_waitcnt lgkmcnt(0)
    v_mfma_f32_16x16x32_bf16 v[144:147], a[144:147], a[0:3], v[144:147]
    v_add_u32 v120, s35, v16
    ds_read_b128 a[16:19], v120 offset:0
    v_mfma_f32_16x16x32_bf16 v[160:163], a[144:147], a[4:7], v[160:163]
    ds_read_b128 a[20:23], v120 offset:7168
    ds_read_b128 a[24:27], v120 offset:14336
    v_mfma_f32_16x16x32_bf16 v[176:179], a[144:147], a[8:11], v[176:179]
    ds_read_b128 a[28:31], v120 offset:21504
    buffer_load_dwordx4 v127, s[64:67], s94 offen offset:3072 lds
    v_mfma_f32_16x16x32_bf16 v[192:195], a[144:147], a[12:15], v[192:195]
    s_add_u32 s35, s35, 1024
    s_cmp_eq_u32 s35, 7168
    s_cselect_b32 s35, 86016, s35
    v_mfma_f32_16x16x32_bf16 v[148:151], a[148:151], a[0:3], v[148:151]
    s_cmp_eq_u32 s35, 93184
    s_cselect_b32 s35, 0, s35
    v_mfma_f32_16x16x32_bf16 v[164:167], a[148:151], a[4:7], v[164:167]
    v_mfma_f32_16x16x32_bf16 v[180:183], a[148:151], a[8:11], v[180:183]
    v_mfma_f32_16x16x32_bf16 v[196:199], a[148:151], a[12:15], v[196:199]
    v_mfma_f32_16x16x32_bf16 v[152:155], a[152:155], a[0:3], v[152:155]
    v_mfma_f32_16x16x32_bf16 v[168:171], a[152:155], a[4:7], v[168:171]
    v_mfma_f32_16x16x32_bf16 v[184:187], a[152:155], a[8:11], v[184:187]
    v_mfma_f32_16x16x32_bf16 v[200:203], a[152:155], a[12:15], v[200:203]
    v_mfma_f32_16x16x32_bf16 v[156:159], a[156:159], a[0:3], v[156:159]
    v_mfma_f32_16x16x32_bf16 v[172:175], a[156:159], a[4:7], v[172:175]
    v_mfma_f32_16x16x32_bf16 v[188:191], a[156:159], a[8:11], v[188:191]
    v_mfma_f32_16x16x32_bf16 v[204:207], a[156:159], a[12:15], v[204:207]
    s_waitcnt lgkmcnt(0)
    s_waitcnt vmcnt(20)
    v_mfma_f32_16x16x32_bf16 v[144:147], a[160:163], a[16:19], v[144:147]
    v_add_u32 v120, s35, v16
    ds_read_b128 a[0:3], v120 offset:0
    v_mfma_f32_16x16x32_bf16 v[160:163], a[160:163], a[20:23], v[160:163]
    ds_read_b128 a[4:7], v120 offset:7168
    ds_read_b128 a[8:11], v120 offset:14336
    v_mfma_f32_16x16x32_bf16 v[176:179], a[160:163], a[24:27], v[176:179]
    ds_read_b128 a[12:15], v120 offset:21504
    v_cndmask_b32 v210, v210, 0, s[100:101]
    v_mfma_f32_16x16x32_bf16 v[192:195], a[160:163], a[28:31], v[192:195]
    s_add_u32 s35, s35, 1024
    s_cmp_eq_u32 s35, 7168
    s_cselect_b32 s35, 86016, s35
    v_mfma_f32_16x16x32_bf16 v[148:151], a[164:167], a[16:19], v[148:151]
    s_cmp_eq_u32 s35, 93184
    s_cselect_b32 s35, 0, s35
    s_waitcnt vmcnt(39)
    v_mfma_f32_16x16x32_bf16 v[164:167], a[164:167], a[20:23], v[164:167]
    ds_read_b64_tr_b16 v[64:65], v96 offset:16384
    ds_read_b64_tr_b16 v[66:67], v97 offset:16384
    v_mfma_f32_16x16x32_bf16 v[180:183], a[164:167], a[24:27], v[180:183]
    ds_read_b64_tr_b16 v[68:69], v98 offset:16384
    ds_read_b64_tr_b16 v[70:71], v99 offset:16384
    v_mfma_f32_16x16x32_bf16 v[196:199], a[164:167], a[28:31], v[196:199]
    ds_read_b64_tr_b16 v[72:73], v100 offset:16384
    ds_read_b64_tr_b16 v[74:75], v101 offset:16384
    v_mfma_f32_16x16x32_bf16 v[152:155], a[168:171], a[16:19], v[152:155]
    ds_read_b64_tr_b16 v[76:77], v102 offset:16384
    ds_read_b64_tr_b16 v[78:79], v103 offset:16384
    v_mfma_f32_16x16x32_bf16 v[168:171], a[168:171], a[20:23], v[168:171]
    v_cndmask_b32 v218, v218, 0, s[100:101]
    v_cndmask_b32 v226, v226, 0, s[100:101]
    v_mfma_f32_16x16x32_bf16 v[184:187], a[168:171], a[24:27], v[184:187]
    v_cndmask_b32 v234, v234, 0, s[100:101]
    v_cndmask_b32 v211, v211, 0, s[100:101]
    v_mfma_f32_16x16x32_bf16 v[200:203], a[168:171], a[28:31], v[200:203]
    v_cndmask_b32 v219, v219, 0, s[100:101]
    v_cndmask_b32 v227, v227, 0, s[100:101]
    v_mfma_f32_16x16x32_bf16 v[156:159], a[172:175], a[16:19], v[156:159]
    v_cndmask_b32 v235, v235, 0, s[100:101]
    v_add_f32 v208, v208, v210
    v_mfma_f32_16x16x32_bf16 v[172:175], a[172:175], a[20:23], v[172:175]
    v_add_f32 v216, v216, v218
    v_add_f32 v224, v224, v226
    v_mfma_f32_16x16x32_bf16 v[188:191], a[172:175], a[24:27], v[188:191]
    v_add_f32 v232, v232, v234
    v_add_f32 v209, v209, v211
    v_mfma_f32_16x16x32_bf16 v[204:207], a[172:175], a[28:31], v[204:207]
    s_waitcnt lgkmcnt(0)
    s_add_u32 m0, s16, 49152
    s_add_u32 s42, s84, 0
    buffer_load_dwordx4 v17, s[60:63], s42 offen offset:0 lds
    v_mfma_f32_16x16x32_bf16 v[144:147], v[64:67], a[0:3], v[144:147]
    v_add_u32 v120, s35, v16
    ds_read_b128 a[16:19], v120 offset:0
    v_mfma_f32_16x16x32_bf16 v[160:163], v[64:67], a[4:7], v[160:163]
    ds_read_b128 a[20:23], v120 offset:7168
    ds_read_b128 a[24:27], v120 offset:14336
    v_mfma_f32_16x16x32_bf16 v[176:179], v[64:67], a[8:11], v[176:179]
    ds_read_b128 a[28:31], v120 offset:21504
    buffer_load_dwordx4 v18, s[60:63], s42 offen offset:1024 lds
    v_mfma_f32_16x16x32_bf16 v[192:195], v[64:67], a[12:15], v[192:195]
L_hop4:
    s_cbranch_execz L_hop5
    s_add_u32 s35, s35, 1024
    s_cmp_eq_u32 s35, 7168
    s_cselect_b32 s35, 86016, s35
    v_mfma_f32_16x16x32_bf16 v[148:151], v[68:71], a[0:3], v[148:151]
    s_cmp_eq_u32 s35, 93184
    s_cselect_b32 s35, 0, s35
    s_waitcnt vmcnt(19)
    v_mfma_f32_16x16x32_bf16 v[164:167], v[68:71], a[4:7], v[164:167]
    ds_read_b64_tr_b16 v[80:81], v96 offset:32768
    ds_read_b64_tr_b16 v[82:83], v97 offset:32768
    v_mfma_f32_16x16x32_bf16 v[180:183], v[68:71], a[8:11], v[180:183]
    ds_read_b64_tr_b16 v[84:85], v98 offset:32768
    ds_read_b64_tr_b16 v[86:87], v99 offset:32768
    v_mfma_f32_16x16x32_bf16 v[196:199], v[68:71], a[12:15], v[196:199]
    ds_read_b64_tr_b16 v[88:89], v100 offset:32768
    ds_read_b64_tr_b16 v[90:91], v101 offset:32768
    buffer_load_dwordx4 v19, s[60:63], s42 offen offset:2048 lds
    v_mfma_f32_16x16x32_bf16 v[152:155], v[72:75], a[0:3], v[152:155]
    ds_read_b64_tr_b16 v[92:93], v102 offset:32768
    ds_read_b64_tr_b16 v[94:95], v103 offset:32768
    v_mfma_f32_16x16x32_bf16 v[168:171], v[72:75], a[4:7], v[168:171]
    buffer_load_dwordx4 v20, s[60:63], s42 offen offset:3072 lds
    v_add_f32 v217, v217, v219
    v_mfma_f32_16x16x32_bf16 v[184:187], v[72:75], a[8:11], v[184:187]
    v_add_f32 v225, v225, v227
    v_add_f32 v233, v233, v235
    v_mfma_f32_16x16x32_bf16 v[200:203], v[72:75], a[12:15], v[200:203]
    v_permlane32_swap_b32 v208, v209
    v_permlane32_swap_b32 v216, v217
    v_mfma_f32_16x16x32_bf16 v[156:159], v[76:79], a[0:3], v[156:159]
    v_permlane32_swap_b32 v224, v225
    v_permlane32_swap_b32 v232, v233
    v_mfma_f32_16x16x32_bf16 v[172:175], v[76:79], a[4:7], v[172:175]
    v_add_f32 v208, v208, v209
    v_add_f32 v216, v216, v217
    v_mfma_f32_16x16x32_bf16 v[188:191], v[76:79], a[8:11], v[188:191]
    v_add_f32 v224, v224, v225
    v_add_f32 v232, v232, v233
    v_mfma_f32_16x16x32_bf16 v[204:207], v[76:79], a[12:15], v[204:207]
    s_waitcnt lgkmcnt(0)
    s_add_u32 m0, s16, 65536
    s_add_u32 s42, s84, 28672
    v_mfma_f32_16x16x32_bf16 v[144:147], v[80:83], a[16:19], v[144:147]
    v_add_u32 v120, s35, v16
    ds_read_b128 a[0:3], v120 offset:0
    buffer_load_dwordx4 v17, s[60:63], s42 offen offset:0 lds
    v_mfma_f32_16x16x32_bf16 v[160:163], v[80:83], a[20:23], v[160:163]
    ds_read_b128 a[4:7], v120 offset:7168
    ds_read_b128 a[8:11], v120 offset:14336
    v_mfma_f32_16x16x32_bf16 v[176:179], v[80:83], a[24:27], v[176:179]
    ds_read_b128 a[12:15], v120 offset:21504
    buffer_load_dwordx4 v18, s[60:63], s42 offen offset:1024 lds
    v_mfma_f32_16x16x32_bf16 v[192:195], v[80:83], a[28:31], v[192:195]
    s_add_u32 s35, s35, 1024
    s_cmp_eq_u32 s35, 7168
    s_cselect_b32 s35, 86016, s35
    v_mfma_f32_16x16x32_bf16 v[148:151], v[84:87], a[16:19], v[148:151]
    s_cmp_eq_u32 s35, 93184
    s_cselect_b32 s35, 0, s35
    s_waitcnt vmcnt(19)
    v_mfma_f32_16x16x32_bf16 v[164:167], v[84:87], a[20:23], v[164:167]
    ds_read_b64_tr_b16 v[64:65], v104 offset:0
    ds_read_b64_tr_b16 v[66:67], v105 offset:0
    v_mfma_f32_16x16x32_bf16 v[180:183], v[84:87], a[24:27], v[180:183]
    ds_read_b64_tr_b16 v[68:69], v106 offset:0
    ds_read_b64_tr_b16 v[70:71], v107 offset:0
    v_mfma_f32_16x16x32_bf16 v[196:199], v[84:87], a[28:31], v[196:199]
    ds_read_b64_tr_b16 v[72:73], v108 offset:0
    ds_read_b64_tr_b16 v[74:75], v109 offset:0
    v_mfma_f32_16x16x32_bf16 v[152:155], v[88:91], a[16:19], v[152:155]
    ds_read_b64_tr_b16 v[76:77], v110 offset:0
    ds_read_b64_tr_b16 v[78:79], v111 offset:0
    v_mfma_f32_16x16x32_bf16 v[168:171], v[88:91], a[20:23], v[168:171]
    buffer_load_dwordx4 v19, s[60:63], s42 offen offset:2048 lds
    buffer_load_dwordx4 v20, s[60:63], s42 offen offset:3072 lds
    v_mfma_f32_16x16x32_bf16 v[184:187], v[88:91], a[24:27], v[184:187]
    v_mov_b32 v209, v208
    v_mov_b32 v217, v216
    v_mfma_f32_16x16x32_bf16 v[200:203], v[88:91], a[28:31], v[200:203]
    v_mov_b32 v225, v224
    v_mov_b32 v233, v232
    v_mfma_f32_16x16x32_bf16 v[156:159], v[92:95], a[16:19], v[156:159]
    v_permlane16_swap_b32 v208, v209
    v_permlane16_swap_b32 v216, v217
    v_mfma_f32_16x16x32_bf16 v[172:175], v[92:95], a[20:23], v[172:175]
    v_permlane16_swap_b32 v224, v225
    v_permlane16_swap_b32 v232, v233
    v_mfma_f32_16x16x32_bf16 v[188:191], v[92:95], a[24:27], v[188:191]
    v_add_f32 v208, v208, v209
    v_add_f32 v216, v216, v217
    v_mfma_f32_16x16x32_bf16 v[204:207], v[92:95], a[28:31], v[204:207]
    s_waitcnt vmcnt(12)
    v_readfirstlane_b32 s30, v59
    s_cmp_ge_u32 s30, 2
    s_nop 4
    s_cbranch_scc1 L_pw_ko
    s_mov_b32 s9, 0
    s_nop 0
L_pl_ko:
    s_buffer_load_dword s30, s[56:59], s91 offset:0x14 glc
    s_add_u32 s9, s9, 1
    s_waitcnt lgkmcnt(0)
    s_cmp_ge_u32 s30, 2
    s_nop 0
    s_cbranch_scc1 L_pw_ko
    s_cmp_lt_u32 s9, 40000
    s_nop 0
    s_cbranch_scc1 L_pl_ko
    s_nop 0
L_pw_ko:
    s_waitcnt vmcnt(12)
    v_readfirstlane_b32 s29, v58
    s_cmp_ge_u32 s29, 1
    s_nop 3
    s_cbranch_scc1 L_pw_cs
    s_mov_b32 s9, 0
    s_nop 0
L_pl_cs:
    s_buffer_load_dword s29, s[56:59], s91 offset:0x10 glc
    s_add_u32 s9, s9, 1
    s_waitcnt lgkmcnt(0)
    s_cmp_ge_u32 s29, 1
    s_nop 0
    s_cbranch_scc1 L_pw_cs
    s_cmp_lt_u32 s9, 40000
    s_nop 0
    s_cbranch_scc1 L_pl_cs
    s_nop 0
L_pw_cs:
    v_lshlrev_b32 v13, 4, v2
    s_lshl_b32 s42, s74, 12
    s_add_u32 s42, s42, 0x1e2000
    buffer_load_dwordx4 a[224:227], v16, s[56:59], s42 offen offset:0
    s_lshl_b32 s5, s76, 10
    s_lshl_b32 s6, s72, 8
    s_add_u32 s5, s5, s6
    s_add_u32 s5, s5, 0x1f2000
    buffer_load_dwordx4 v[240:243], v13, s[56:59], s5 offen offset:0
    buffer_load_dwordx4 v[244:247], v13, s[56:59], s5 offen offset:64
    buffer_load_dwordx4 v[248:251], v13, s[56:59], s5 offen offset:128
    buffer_load_dwordx4 v[252:255], v13, s[56:59], s5 offen offset:192
    s_waitcnt lgkmcnt(0)
    v_mfma_f32_16x16x32_bf16 v[144:147], v[64:67], a[0:3], v[144:147]
    v_add_u32 v120, s35, v16
    ds_read_b128 a[16:19], v120 offset:0
    v_mfma_f32_16x16x32_bf16 v[160:163], v[64:67], a[4:7], v[160:163]
    ds_read_b128 a[20:23], v120 offset:7168
    ds_read_b128 a[24:27], v120 offset:14336
    v_mfma_f32_16x16x32_bf16 v[176:179], v[64:67], a[8:11], v[176:179]
    ds_read_b128 a[28:31], v120 offset:21504
    s_lshl_b32 s42, s74, 12
    v_mfma_f32_16x16x32_bf16 v[192:195], v[64:67], a[12:15], v[192:195]
    s_add_u32 s35, s35, 1024
    s_cmp_eq_u32 s35, 7168
    s_cselect_b32 s35, 86016, s35
    v_mfma_f32_16x16x32_bf16 v[148:151], v[68:71], a[0:3], v[148:151]
    s_cmp_eq_u32 s35, 93184
    s_cselect_b32 s35, 0, s35
    s_waitcnt vmcnt(22)
    v_mfma_f32_16x16x32_bf16 v[164:167], v[68:71], a[4:7], v[164:167]
    ds_read_b64_tr_b16 v[80:81], v96 offset:0
    ds_read_b64_tr_b16 v[82:83], v97 offset:0
    v_mfma_f32_16x16x32_bf16 v[180:183], v[68:71], a[8:11], v[180:183]
    ds_read_b64_tr_b16 v[84:85], v98 offset:0
    ds_read_b64_tr_b16 v[86:87], v99 offset:0
    s_add_u32 s42, s42, 0x1e2000
    buffer_load_dwordx4 a[228:231], v16, s[56:59], s42 offen offset:1024
    v_mfma_f32_16x16x32_bf16 v[196:199], v[68:71], a[12:15], v[196:199]
    ds_read_b64_tr_b16 v[88:89], v100 offset:0
    ds_read_b64_tr_b16 v[90:91], v101 offset:0
    v_mfma_f32_16x16x32_bf16 v[152:155], v[72:75], a[0:3], v[152:155]
    ds_read_b64_tr_b16 v[92:93], v102 offset:0
    ds_read_b64_tr_b16 v[94:95], v103 offset:0
    v_mfma_f32_16x16x32_bf16 v[168:171], v[72:75], a[4:7], v[168:171]
    s_lshl_b32 s42, s74, 12
    s_add_u32 s42, s42, 0x1e2000
    v_mfma_f32_16x16x32_bf16 v[184:187], v[72:75], a[8:11], v[184:187]
    buffer_load_dwordx4 a[232:235], v16, s[56:59], s42 offen offset:2048
    s_lshl_b32 s42, s74, 12
    v_mfma_f32_16x16x32_bf16 v[200:203], v[72:75], a[12:15], v[200:203]
    s_add_u32 s42, s42, 0x1e2000
    buffer_load_dwordx4 a[236:239], v16, s[56:59], s42 offen offset:3072
    v_mfma_f32_16x16x32_bf16 v[156:159], v[76:79], a[0:3], v[156:159]
    s_lshl_b32 s42, s74, 12
    s_add_u32 s42, s42, 0x1e2000
    v_mfma_f32_16x16x32_bf16 v[172:175], v[76:79], a[4:7], v[172:175]
    v_lshlrev_b32 v6, 8, v2
    buffer_load_dwordx4 v[112:115], v6, s[56:59], s42 offen offset:1216
    v_mfma_f32_16x16x32_bf16 v[188:191], v[76:79], a[8:11], v[188:191]
    s_lshl_b32 s42, s74, 12
    s_add_u32 s42, s42, 0x1e2000
    v_mfma_f32_16x16x32_bf16 v[204:207], v[76:79], a[12:15], v[204:207]
    s_waitcnt lgkmcnt(0)
    v_lshlrev_b32 v6, 8, v2
    v_mfma_f32_16x16x32_bf16 v[144:147], v[80:83], a[16:19], v[144:147]
    v_add_u32 v120, s35, v16
    ds_read_b128 a[0:3], v120 offset:0
    v_mfma_f32_16x16x32_bf16 v[160:163], v[80:83], a[20:23], v[160:163]
    ds_read_b128 a[4:7], v120 offset:7168
    ds_read_b128 a[8:11], v120 offset:14336
    v_mfma_f32_16x16x32_bf16 v[176:179], v[80:83], a[24:27], v[176:179]
    ds_read_b128 a[12:15], v120 offset:21504
    buffer_load_dwordx4 v[116:119], v6, s[56:59], s42 offen offset:3264
    v_mfma_f32_16x16x32_bf16 v[192:195], v[80:83], a[28:31], v[192:195]
    s_add_u32 s35, s35, 1024
    s_cmp_eq_u32 s35, 7168
    s_cselect_b32 s35, 86016, s35
    v_mfma_f32_16x16x32_bf16 v[148:151], v[84:87], a[16:19], v[148:151]
    s_cmp_eq_u32 s35, 93184
    s_cselect_b32 s35, 0, s35
    s_waitcnt vmcnt(23)
    v_mfma_f32_16x16x32_bf16 v[164:167], v[84:87], a[20:23], v[164:167]
    ds_read_b64_tr_b16 v[64:65], v104 offset:16384
    ds_read_b64_tr_b16 v[66:67], v105 offset:16384
    v_mfma_f32_16x16x32_bf16 v[180:183], v[84:87], a[24:27], v[180:183]
    ds_read_b64_tr_b16 v[68:69], v106 offset:16384
    ds_read_b64_tr_b16 v[70:71], v107 offset:16384
    v_mfma_f32_16x16x32_bf16 v[196:199], v[84:87], a[28:31], v[196:199]
    ds_read_b64_tr_b16 v[72:73], v108 offset:16384
    ds_read_b64_tr_b16 v[74:75], v109 offset:16384
    v_mfma_f32_16x16x32_bf16 v[152:155], v[88:91], a[16:19], v[152:155]
    ds_read_b64_tr_b16 v[76:77], v110 offset:16384
    ds_read_b64_tr_b16 v[78:79], v111 offset:16384
    v_mfma_f32_16x16x32_bf16 v[168:171], v[88:91], a[20:23], v[168:171]
    s_add_u32 m0, s16, 114688
    s_add_u32 s42, s85, 0
    v_mfma_f32_16x16x32_bf16 v[184:187], v[88:91], a[24:27], v[184:187]
    buffer_load_dwordx4 v17, s[60:63], s42 offen offset:0 lds
    buffer_load_dwordx4 v18, s[60:63], s42 offen offset:1024 lds
    v_mfma_f32_16x16x32_bf16 v[200:203], v[88:91], a[28:31], v[200:203]
    buffer_load_dwordx4 v19, s[60:63], s42 offen offset:2048 lds
    v_add_f32 v224, v224, v225
    v_mfma_f32_16x16x32_bf16 v[156:159], v[92:95], a[16:19], v[156:159]
    v_add_f32 v232, v232, v233
    v_mov_b32 v209, v208
    v_mfma_f32_16x16x32_bf16 v[172:175], v[92:95], a[20:23], v[172:175]
    v_mov_b32 v217, v216
    v_mov_b32 v225, v224
    v_mfma_f32_16x16x32_bf16 v[188:191], v[92:95], a[24:27], v[188:191]
    v_mov_b32 v233, v232
    v_permlane32_swap_b32 v208, v209
    v_mfma_f32_16x16x32_bf16 v[204:207], v[92:95], a[28:31], v[204:207]
    s_waitcnt lgkmcnt(0)
    v_permlane32_swap_b32 v216, v217
    v_mfma_f32_16x16x32_bf16 v[144:147], v[64:67], a[0:3], v[144:147]
    v_add_u32 v120, s35, v16
    ds_read_b128 a[16:19], v120 offset:0
    v_mfma_f32_16x16x32_bf16 v[160:163], v[64:67], a[4:7], v[160:163]
    ds_read_b128 a[20:23], v120 offset:7168
    ds_read_b128 a[24:27], v120 offset:14336
    v_mfma_f32_16x16x32_bf16 v[176:179], v[64:67], a[8:11], v[176:179]
    ds_read_b128 a[28:31], v120 offset:21504
    s_waitcnt vmcnt(21)
    v_mfma_f32_16x16x32_bf16 v[192:195], v[64:67], a[12:15], v[192:195]
    ds_read_b64_tr_b16 v[80:81], v104 offset:32768
    ds_read_b64_tr_b16 v[82:83], v105 offset:32768
    v_mfma_f32_16x16x32_bf16 v[148:151], v[68:71], a[0:3], v[148:151]
    ds_read_b64_tr_b16 v[84:85], v106 offset:32768
    ds_read_b64_tr_b16 v[86:87], v107 offset:32768
    v_mfma_f32_16x16x32_bf16 v[164:167], v[68:71], a[4:7], v[164:167]
    ds_read_b64_tr_b16 v[88:89], v108 offset:32768
    ds_read_b64_tr_b16 v[90:91], v109 offset:32768
    v_mfma_f32_16x16x32_bf16 v[180:183], v[68:71], a[8:11], v[180:183]
    ds_read_b64_tr_b16 v[92:93], v110 offset:32768
    ds_read_b64_tr_b16 v[94:95], v111 offset:32768
    v_mfma_f32_16x16x32_bf16 v[196:199], v[68:71], a[12:15], v[196:199]
    buffer_load_dwordx4 v20, s[60:63], s42 offen offset:3072 lds
    s_add_u32 m0, s16, 32768
    v_mfma_f32_16x16x32_bf16 v[152:155], v[72:75], a[0:3], v[152:155]
    s_add_u32 s42, s85, 28672
    buffer_load_dwordx4 v17, s[60:63], s42 offen offset:0 lds
    v_mfma_f32_16x16x32_bf16 v[168:171], v[72:75], a[4:7], v[168:171]
    buffer_load_dwordx4 v18, s[60:63], s42 offen offset:1024 lds
    v_permlane32_swap_b32 v224, v225
    v_mfma_f32_16x16x32_bf16 v[184:187], v[72:75], a[8:11], v[184:187]
    v_permlane32_swap_b32 v232, v233
    v_mul_f32 v208, 0xbb124925, v208
    v_mfma_f32_16x16x32_bf16 v[200:203], v[72:75], a[12:15], v[200:203]
    v_mul_f32 v216, 0xbb124925, v216
    v_mul_f32 v224, 0xbb124925, v224
    v_mfma_f32_16x16x32_bf16 v[156:159], v[76:79], a[0:3], v[156:159]
    v_mul_f32 v232, 0xbb124925, v232
    v_mul_f32 v209, 0x3b124925, v209
    v_mfma_f32_16x16x32_bf16 v[172:175], v[76:79], a[4:7], v[172:175]
    buffer_load_dwordx4 v19, s[60:63], s42 offen offset:2048 lds
    v_mul_f32 v217, 0x3b124925, v217
    v_mfma_f32_16x16x32_bf16 v[188:191], v[76:79], a[8:11], v[188:191]
    v_mul_f32 v225, 0x3b124925, v225
    v_mul_f32 v233, 0x3b124925, v233
    v_mfma_f32_16x16x32_bf16 v[204:207], v[76:79], a[12:15], v[204:207]
    s_waitcnt lgkmcnt(0)
    s_barrier
    v_mfma_f32_16x16x32_bf16 v[144:147], v[80:83], a[16:19], v[144:147]
    buffer_load_dwordx4 v20, s[60:63], s42 offen offset:3072 lds
    v_fma_f32 v209, -v208, v208, v209
    v_mfma_f32_16x16x32_bf16 v[160:163], v[80:83], a[20:23], v[160:163]
    v_fma_f32 v217, -v216, v216, v217
    v_fma_f32 v225, -v224, v224, v225
    v_mfma_f32_16x16x32_bf16 v[176:179], v[80:83], a[24:27], v[176:179]
    v_fma_f32 v233, -v232, v232, v233
    v_add_f32 v209, 0x3727c5ac, v209
    v_mfma_f32_16x16x32_bf16 v[192:195], v[80:83], a[28:31], v[192:195]
    s_add_u32 m0, s16, 131072
    s_add_u32 s42, s86, 0
    v_mfma_f32_16x16x32_bf16 v[148:151], v[84:87], a[16:19], v[148:151]
    buffer_load_dwordx4 v17, s[60:63], s42 offen offset:0 lds
    v_add_f32 v217, 0x3727c5ac, v217
    v_mfma_f32_16x16x32_bf16 v[164:167], v[84:87], a[20:23], v[164:167]
    v_add_f32 v225, 0x3727c5ac, v225
    v_add_f32 v233, 0x3727c5ac, v233
    v_mfma_f32_16x16x32_bf16 v[180:183], v[84:87], a[24:27], v[180:183]
    v_rsq_f32 v210, v209
    v_rsq_f32 v218, v217
    v_mfma_f32_16x16x32_bf16 v[196:199], v[84:87], a[28:31], v[196:199]
    buffer_load_dwordx4 v18, s[60:63], s42 offen offset:1024 lds
    v_rsq_f32 v226, v225
    v_mfma_f32_16x16x32_bf16 v[152:155], v[88:91], a[16:19], v[152:155]
    v_rsq_f32 v234, v233
    v_mul_f32 v212, 0xc0135761, v210
    v_mfma_f32_16x16x32_bf16 v[168:171], v[88:91], a[20:23], v[168:171]
    v_mul_f32 v220, 0xc0135761, v218
    v_mul_f32 v228, 0xc0135761, v226
    v_mfma_f32_16x16x32_bf16 v[184:187], v[88:91], a[24:27], v[184:187]
    v_mul_f32 v236, 0xc0135761, v234
    v_mul_f32 v211, v210, v210
    v_mfma_f32_16x16x32_bf16 v[200:203], v[88:91], a[28:31], v[200:203]
    buffer_load_dwordx4 v19, s[60:63], s42 offen offset:2048 lds
    v_mul_f32 v219, v218, v218
    v_mfma_f32_16x16x32_bf16 v[156:159], v[92:95], a[16:19], v[156:159]
    v_mul_f32 v227, v226, v226
    v_mul_f32 v235, v234, v234
    v_mfma_f32_16x16x32_bf16 v[172:175], v[92:95], a[20:23], v[172:175]
    v_mul_f32 v214, v210, v209
    v_mul_f32 v222, v218, v217
    v_mfma_f32_16x16x32_bf16 v[188:191], v[92:95], a[24:27], v[188:191]
    v_mul_f32 v230, v226, v225
    v_mul_f32 v238, v234, v233
    v_mfma_f32_16x16x32_bf16 v[204:207], v[92:95], a[28:31], v[204:207]
    v_mul_f32 v211, 0xbdd2d3e8, v211
    v_mul_f32 v219, 0xbdd2d3e8, v219
    v_mul_f32 v227, 0xbdd2d3e8, v227
    v_mul_f32 v235, 0xbdd2d3e8, v235
    buffer_load_dwordx4 v20, s[60:63], s42 offen offset:3072 lds
    v_mul_f32 v210, v211, v210
    v_mul_f32 v218, v219, v218
    v_mul_f32 v226, v227, v226
    v_mul_f32 v234, v235, v234
    s_lshr_b32 s12, s72, 1
    s_lshl_b32 s12, s12, 6
    s_and_b32 s13, s72, 1
    s_lshl_b32 s13, s13, 3
    s_or_b32 s12, s12, s13
    v_xor_b32 v96, s12, v32
    v_xor_b32 v97, s12, v33
    v_xor_b32 v98, s12, v40
    s_add_u32 m0, s16, 147456
    s_add_u32 s42, s86, 28672
    buffer_load_dwordx4 v17, s[60:63], s42 offen offset:0 lds
    v_xor_b32 v99, s12, v41
    v_xor_b32 v100, s12, v48
    v_xor_b32 v101, s12, v49
    v_lshrrev_b32 v12, 1, v2
    v_lshlrev_b32 v12, 8, v12
    v_lshl_add_u32 v12, v3, 4, v12
    v_and_b32 v13, 1, v2
    v_lshl_add_u32 v12, v13, 3, v12
    s_lshl_b32 s13, s72, 9
    s_add_u32 s12, s72, 0
    s_and_b32 s12, s12, 3
    s_lshl_b32 s12, s12, 14
    s_add_u32 s12, s12, s13
    v_add_u32 v102, s12, v12
    buffer_load_dwordx4 v18, s[60:63], s42 offen offset:1024 lds
    s_add_u32 s12, s72, 1
    s_and_b32 s12, s12, 3
    s_lshl_b32 s12, s12, 14
    s_add_u32 s12, s12, s13
    v_add_u32 v103, s12, v12
    s_add_u32 s12, s72, 2
    s_and_b32 s12, s12, 3
    s_lshl_b32 s12, s12, 14
    s_add_u32 s12, s12, s13
    v_add_u32 v104, s12, v12
    s_add_u32 s12, s72, 3
    s_and_b32 s12, s12, 3
    s_lshl_b32 s12, s12, 14
    s_add_u32 s12, s12, s13
    v_add_u32 v105, s12, v12
    s_lshl_b32 s96, s75, 19
    s_add_u32 s96, s96, 0xa00000
    v_readfirstlane_b32 s12, v27
    buffer_load_dwordx4 v19, s[60:63], s42 offen offset:2048 lds
    s_lshl_b32 s13, s72, 7
    s_sub_u32 s12, s12, s13
    v_lshl_add_u32 v27, v1, 7, s12
    v_cmp_u_f32 vcc, v210, v218
    v_cmp_u_f32 s[10:11], v226, v234
    s_or_b64 vcc, vcc, s[10:11]
    s_nop 3
    s_cbranch_vccnz L_stredo
    s_nop 0
L_stok:
    s_waitcnt vmcnt(20)
    s_waitcnt vmcnt(15)
    s_lshl_b32 s10, s77, 4
    s_add_u32 s10, s10, s74
    s_lshl_b32 s10, s10, 10
    s_add_u32 s10, s10, 0x700000
    s_add_u32 s11, s10, 16384
    v_mfma_f32_16x16x32_bf16 v[72:75], v[112:115], a[240:243], 0
    v_mfma_f32_16x16x32_bf16 v[64:67], a[224:227], a[240:243], 0
    s_add_u32 m0, s16, 147456
    s_add_u32 s42, s86, 28672
    v_mfma_f32_16x16x32_bf16 v[68:71], a[228:231], a[240:243], 0
    buffer_load_dwordx4 v20, s[60:63], s42 offen offset:3072 lds
    v_mfma_f32_16x16x32_bf16 v[88:91], v[112:115], a[248:251], 0
    v_mfma_f32_16x16x32_bf16 v[80:83], a[224:227], a[248:251], 0
    v_mfma_f32_16x16x32_bf16 v[84:87], a[228:231], a[248:251], 0
    v_mfma_f32_16x16x32_bf16 v[72:75], v[116:119], a[244:247], v[72:75]
    s_add_u32 m0, s16, 81920
    s_add_u32 s42, s87, 0
    v_mfma_f32_16x16x32_bf16 v[64:67], a[232:235], a[244:247], v[64:67]
    buffer_load_dwordx4 v17, s[60:63], s42 offen offset:0 lds
    v_mfma_f32_16x16x32_bf16 v[68:71], a[236:239], a[244:247], v[68:71]
    v_mfma_f32_16x16x32_bf16 v[88:91], v[116:119], a[252:255], v[88:91]
    v_mfma_f32_16x16x32_bf16 v[80:83], a[232:235], a[252:255], v[80:83]
    buffer_load_dwordx4 v18, s[60:63], s42 offen offset:1024 lds
    v_mfma_f32_16x16x32_bf16 v[84:87], a[236:239], a[252:255], v[84:87]
    v_add_f32 v72, 0x358637bd, v72
    s_nop 3
    v_add_f32 v88, 0x358637bd, v88
    v_rcp_f32 v72, v72
    v_rcp_f32 v88, v88
    v_pk_mul_f32 v[64:65], v[64:65], v[72:73] op_sel_hi:[1,0]
    v_pk_mul_f32 v[80:81], v[80:81], v[88:89] op_sel_hi:[1,0]
    v_pk_mul_f32 v[66:67], v[66:67], v[72:73] op_sel_hi:[1,0]
    v_pk_mul_f32 v[82:83], v[82:83], v[88:89] op_sel_hi:[1,0]
    v_pk_mul_f32 v[68:69], v[68:69], v[72:73] op_sel_hi:[1,0]
    buffer_load_dwordx4 v19, s[60:63], s42 offen offset:2048 lds
    v_pk_mul_f32 v[84:85], v[84:85], v[88:89] op_sel_hi:[1,0]
    v_pk_mul_f32 v[70:71], v[70:71], v[72:73] op_sel_hi:[1,0]
    v_pk_mul_f32 v[86:87], v[86:87], v[88:89] op_sel_hi:[1,0]
    v_cvt_pk_bf16_f32 v76, v64, v65
    v_cvt_pk_bf16_f32 v92, v80, v81
    v_cvt_pk_bf16_f32 v77, v66, v67
    v_cvt_pk_bf16_f32 v93, v82, v83
    v_cvt_pk_bf16_f32 v78, v68, v69
    v_cvt_pk_bf16_f32 v94, v84, v85
    v_cvt_pk_bf16_f32 v79, v70, v71
    v_cvt_pk_bf16_f32 v95, v86, v87
    buffer_store_dwordx4 v[76:79], v16, s[56:59], s10 offen sc1
    buffer_store_dwordx4 v[92:95], v16, s[56:59], s11 offen sc1
    v_pk_fma_f32 v[144:145], v[240:241], v[208:209], v[144:145] op_sel_hi:[1,0,1]
    v_pk_fma_f32 v[160:161], v[240:241], v[216:217], v[160:161] op_sel_hi:[1,0,1]
    v_pk_fma_f32 v[146:147], v[242:243], v[208:209], v[146:147] op_sel_hi:[1,0,1]
    v_pk_fma_f32 v[162:163], v[242:243], v[216:217], v[162:163] op_sel_hi:[1,0,1]
    v_pk_fma_f32 v[148:149], v[244:245], v[208:209], v[148:149] op_sel_hi:[1,0,1]
    v_pk_fma_f32 v[164:165], v[244:245], v[216:217], v[164:165] op_sel_hi:[1,0,1]
    v_pk_fma_f32 v[150:151], v[246:247], v[208:209], v[150:151] op_sel_hi:[1,0,1]
    v_pk_fma_f32 v[166:167], v[246:247], v[216:217], v[166:167] op_sel_hi:[1,0,1]
    v_pk_mul_f32 v[64:65], v[144:145], v[144:145]
    v_pk_mul_f32 v[72:73], v[160:161], v[160:161]
    v_pk_mul_f32 v[66:67], v[146:147], v[146:147]
    v_pk_mul_f32 v[74:75], v[162:163], v[162:163]
    v_pk_mul_f32 v[68:69], v[148:149], v[148:149]
    v_pk_mul_f32 v[76:77], v[164:165], v[164:165]
    v_pk_mul_f32 v[70:71], v[150:151], v[150:151]
    v_pk_mul_f32 v[78:79], v[166:167], v[166:167]
    v_pk_fma_f32 v[64:65], v[64:65], v[210:211], v[212:213] op_sel_hi:[1,0,0]
    v_pk_fma_f32 v[72:73], v[72:73], v[218:219], v[220:221] op_sel_hi:[1,0,0]
    v_pk_fma_f32 v[66:67], v[66:67], v[210:211], v[212:213] op_sel_hi:[1,0,0]
    v_pk_fma_f32 v[74:75], v[74:75], v[218:219], v[220:221] op_sel_hi:[1,0,0]
    v_pk_fma_f32 v[68:69], v[68:69], v[210:211], v[212:213] op_sel_hi:[1,0,0]
    v_pk_fma_f32 v[76:77], v[76:77], v[218:219], v[220:221] op_sel_hi:[1,0,0]
    v_pk_fma_f32 v[70:71], v[70:71], v[210:211], v[212:213] op_sel_hi:[1,0,0]
    v_pk_fma_f32 v[78:79], v[78:79], v[218:219], v[220:221] op_sel_hi:[1,0,0]
    v_pk_mul_f32 v[64:65], v[64:65], v[144:145]
    v_pk_mul_f32 v[72:73], v[72:73], v[160:161]
    v_pk_mul_f32 v[66:67], v[66:67], v[146:147]
    v_pk_mul_f32 v[74:75], v[74:75], v[162:163]
    v_pk_mul_f32 v[68:69], v[68:69], v[148:149]
    v_pk_mul_f32 v[76:77], v[76:77], v[164:165]
    buffer_load_dwordx4 v20, s[60:63], s42 offen offset:3072 lds
    v_pk_mul_f32 v[70:71], v[70:71], v[150:151]
    v_pk_mul_f32 v[78:79], v[78:79], v[166:167]
    v_exp_f32 v64, v64
    v_exp_f32 v72, v72
    v_exp_f32 v65, v65
    v_exp_f32 v73, v73
    v_exp_f32 v66, v66
    v_exp_f32 v74, v74
    v_exp_f32 v67, v67
    s_add_u32 m0, s16, 98304
    s_add_u32 s42, s87, 28672
    buffer_load_dwordx4 v17, s[60:63], s42 offen offset:0 lds
    v_exp_f32 v75, v75
    v_exp_f32 v68, v68
    v_exp_f32 v76, v76
    v_exp_f32 v69, v69
    v_exp_f32 v77, v77
    v_exp_f32 v70, v70
    v_exp_f32 v78, v78
    v_exp_f32 v71, v71
    buffer_load_dwordx4 v18, s[60:63], s42 offen offset:1024 lds
    v_exp_f32 v79, v79
    v_pk_fma_f32 v[64:65], v[64:65], v[214:215], v[214:215] op_sel_hi:[1,0,0]
    v_pk_fma_f32 v[72:73], v[72:73], v[222:223], v[222:223] op_sel_hi:[1,0,0]
    v_pk_fma_f32 v[66:67], v[66:67], v[214:215], v[214:215] op_sel_hi:[1,0,0]
    v_pk_fma_f32 v[74:75], v[74:75], v[222:223], v[222:223] op_sel_hi:[1,0,0]
    v_pk_fma_f32 v[68:69], v[68:69], v[214:215], v[214:215] op_sel_hi:[1,0,0]
    v_pk_fma_f32 v[76:77], v[76:77], v[222:223], v[222:223] op_sel_hi:[1,0,0]
    v_pk_fma_f32 v[70:71], v[70:71], v[214:215], v[214:215] op_sel_hi:[1,0,0]
    v_pk_fma_f32 v[78:79], v[78:79], v[222:223], v[222:223] op_sel_hi:[1,0,0]
    v_rcp_f32 v64, v64
    v_rcp_f32 v72, v72
    v_rcp_f32 v65, v65
    buffer_load_dwordx4 v19, s[60:63], s42 offen offset:2048 lds
    v_rcp_f32 v73, v73
    v_rcp_f32 v66, v66
    v_rcp_f32 v74, v74
    v_rcp_f32 v67, v67
    v_rcp_f32 v75, v75
    v_rcp_f32 v68, v68
    v_rcp_f32 v76, v76
    v_rcp_f32 v69, v69
    buffer_load_dwordx4 v20, s[60:63], s42 offen offset:3072 lds
    v_rcp_f32 v77, v77
    v_rcp_f32 v70, v70
    v_rcp_f32 v78, v78
    v_rcp_f32 v71, v71
    v_rcp_f32 v79, v79
    v_pk_mul_f32 v[64:65], v[64:65], v[144:145]
    v_pk_mul_f32 v[72:73], v[72:73], v[160:161]
    v_pk_mul_f32 v[66:67], v[66:67], v[146:147]
    v_pk_mul_f32 v[74:75], v[74:75], v[162:163]
    v_pk_mul_f32 v[68:69], v[68:69], v[148:149]
    v_pk_mul_f32 v[76:77], v[76:77], v[164:165]
    v_pk_mul_f32 v[70:71], v[70:71], v[150:151]
    v_pk_mul_f32 v[78:79], v[78:79], v[166:167]
    v_cvt_pk_bf16_f32 v144, v64, v65
    v_cvt_pk_bf16_f32 v160, v72, v73
    v_cvt_pk_bf16_f32 v145, v66, v67
    v_cvt_pk_bf16_f32 v161, v74, v75
    v_cvt_pk_bf16_f32 v146, v68, v69
    v_cvt_pk_bf16_f32 v162, v76, v77
    v_cvt_pk_bf16_f32 v147, v70, v71
    v_cvt_pk_bf16_f32 v163, v78, v79
    v_pk_fma_f32 v[176:177], v[240:241], v[224:225], v[176:177] op_sel_hi:[1,0,1]
    ds_write_b128 v28, v[160:163] offset:1024
    v_pk_fma_f32 v[192:193], v[240:241], v[232:233], v[192:193] op_sel_hi:[1,0,1]
    v_pk_fma_f32 v[178:179], v[242:243], v[224:225], v[178:179] op_sel_hi:[1,0,1]
    v_pk_fma_f32 v[194:195], v[242:243], v[232:233], v[194:195] op_sel_hi:[1,0,1]
    v_pk_fma_f32 v[180:181], v[244:245], v[224:225], v[180:181] op_sel_hi:[1,0,1]
    v_pk_fma_f32 v[196:197], v[244:245], v[232:233], v[196:197] op_sel_hi:[1,0,1]
    v_pk_fma_f32 v[182:183], v[246:247], v[224:225], v[182:183] op_sel_hi:[1,0,1]
    v_pk_fma_f32 v[198:199], v[246:247], v[232:233], v[198:199] op_sel_hi:[1,0,1]
    v_pk_mul_f32 v[80:81], v[176:177], v[176:177]
    v_pk_mul_f32 v[88:89], v[192:193], v[192:193]
    v_pk_mul_f32 v[82:83], v[178:179], v[178:179]
    v_pk_mul_f32 v[90:91], v[194:195], v[194:195]
    v_pk_mul_f32 v[84:85], v[180:181], v[180:181]
    v_pk_mul_f32 v[92:93], v[196:197], v[196:197]
    v_pk_mul_f32 v[86:87], v[182:183], v[182:183]
    v_pk_mul_f32 v[94:95], v[198:199], v[198:199]
    v_pk_fma_f32 v[80:81], v[80:81], v[226:227], v[228:229] op_sel_hi:[1,0,0]
    v_pk_fma_f32 v[88:89], v[88:89], v[234:235], v[236:237] op_sel_hi:[1,0,0]
    v_pk_fma_f32 v[82:83], v[82:83], v[226:227], v[228:229] op_sel_hi:[1,0,0]
    v_pk_fma_f32 v[90:91], v[90:91], v[234:235], v[236:237] op_sel_hi:[1,0,0]
    v_pk_fma_f32 v[84:85], v[84:85], v[226:227], v[228:229] op_sel_hi:[1,0,0]
    v_pk_fma_f32 v[92:93], v[92:93], v[234:235], v[236:237] op_sel_hi:[1,0,0]
    v_pk_fma_f32 v[86:87], v[86:87], v[226:227], v[228:229] op_sel_hi:[1,0,0]
    v_pk_fma_f32 v[94:95], v[94:95], v[234:235], v[236:237] op_sel_hi:[1,0,0]
    v_pk_mul_f32 v[80:81], v[80:81], v[176:177]
    v_pk_mul_f32 v[88:89], v[88:89], v[192:193]
    v_pk_mul_f32 v[82:83], v[82:83], v[178:179]
    v_pk_mul_f32 v[90:91], v[90:91], v[194:195]
    v_pk_mul_f32 v[84:85], v[84:85], v[180:181]
    v_pk_mul_f32 v[92:93], v[92:93], v[196:197]
    v_pk_mul_f32 v[86:87], v[86:87], v[182:183]
    v_pk_mul_f32 v[94:95], v[94:95], v[198:199]
    v_exp_f32 v80, v80
    v_exp_f32 v88, v88
    v_exp_f32 v81, v81
    v_exp_f32 v89, v89
    ds_write_b128 v28, v[144:147] offset:0
    v_exp_f32 v82, v82
    v_exp_f32 v90, v90
    v_exp_f32 v83, v83
    v_exp_f32 v91, v91
    v_exp_f32 v84, v84
    v_exp_f32 v92, v92
    v_exp_f32 v85, v85
    v_exp_f32 v93, v93
    v_exp_f32 v86, v86
    v_exp_f32 v94, v94
    v_exp_f32 v87, v87
    v_exp_f32 v95, v95
    v_pk_fma_f32 v[80:81], v[80:81], v[230:231], v[230:231] op_sel_hi:[1,0,0]
    v_pk_fma_f32 v[88:89], v[88:89], v[238:239], v[238:239] op_sel_hi:[1,0,0]
    v_pk_fma_f32 v[82:83], v[82:83], v[230:231], v[230:231] op_sel_hi:[1,0,0]
    v_pk_fma_f32 v[90:91], v[90:91], v[238:239], v[238:239] op_sel_hi:[1,0,0]
    v_pk_fma_f32 v[84:85], v[84:85], v[230:231], v[230:231] op_sel_hi:[1,0,0]
    v_pk_fma_f32 v[92:93], v[92:93], v[238:239], v[238:239] op_sel_hi:[1,0,0]
    v_pk_fma_f32 v[86:87], v[86:87], v[230:231], v[230:231] op_sel_hi:[1,0,0]
    v_pk_fma_f32 v[94:95], v[94:95], v[238:239], v[238:239] op_sel_hi:[1,0,0]
    v_rcp_f32 v80, v80
    v_rcp_f32 v88, v88
    v_rcp_f32 v81, v81
    v_rcp_f32 v89, v89
    v_rcp_f32 v82, v82
    v_rcp_f32 v90, v90
    v_rcp_f32 v83, v83
    v_rcp_f32 v91, v91
    v_rcp_f32 v84, v84
    v_rcp_f32 v92, v92
    v_rcp_f32 v85, v85
    v_rcp_f32 v93, v93
    v_rcp_f32 v86, v86
    v_rcp_f32 v94, v94
    v_rcp_f32 v87, v87
    v_rcp_f32 v95, v95
    v_pk_mul_f32 v[80:81], v[80:81], v[176:177]
    v_pk_mul_f32 v[88:89], v[88:89], v[192:193]
    v_pk_mul_f32 v[82:83], v[82:83], v[178:179]
    v_pk_mul_f32 v[90:91], v[90:91], v[194:195]
    v_pk_mul_f32 v[84:85], v[84:85], v[180:181]
    v_pk_mul_f32 v[92:93], v[92:93], v[196:197]
    v_pk_mul_f32 v[86:87], v[86:87], v[182:183]
    v_pk_mul_f32 v[94:95], v[94:95], v[198:199]
    v_cvt_pk_bf16_f32 v176, v80, v81
L_hop5:
    s_cbranch_execz L_hret2
    v_cvt_pk_bf16_f32 v192, v88, v89
    v_cvt_pk_bf16_f32 v177, v82, v83
    v_cvt_pk_bf16_f32 v193, v90, v91
    v_cvt_pk_bf16_f32 v178, v84, v85
    v_cvt_pk_bf16_f32 v194, v92, v93
    v_cvt_pk_bf16_f32 v179, v86, v87
    v_cvt_pk_bf16_f32 v195, v94, v95
    s_waitcnt vmcnt(10)
    s_barrier
    s_waitcnt vmcnt(5)
    s_mov_b64 exec, 0x7f7f00
    buffer_atomic_add v63, v26, s[56:59], 0 offen offset:24 sc1
    s_mov_b64 exec, -1
    v_pk_fma_f32 v[152:153], v[248:249], v[208:209], v[152:153] op_sel_hi:[1,0,1]
    ds_write_b128 v28, v[192:195] offset:3072
    v_pk_fma_f32 v[168:169], v[248:249], v[216:217], v[168:169] op_sel_hi:[1,0,1]
    ds_write_b128 v28, v[176:179] offset:2048
    v_pk_fma_f32 v[154:155], v[250:251], v[208:209], v[154:155] op_sel_hi:[1,0,1]
    ds_read_b64_tr_b16 a[32:33], v96 offset:49152
    v_pk_fma_f32 v[170:171], v[250:251], v[216:217], v[170:171] op_sel_hi:[1,0,1]
    v_pk_fma_f32 v[156:157], v[252:253], v[208:209], v[156:157] op_sel_hi:[1,0,1]
    ds_read_b64_tr_b16 a[34:35], v97 offset:49152
    v_pk_fma_f32 v[172:173], v[252:253], v[216:217], v[172:173] op_sel_hi:[1,0,1]
    ds_read_b64_tr_b16 a[36:37], v98 offset:0
    v_pk_fma_f32 v[158:159], v[254:255], v[208:209], v[158:159] op_sel_hi:[1,0,1]
    v_pk_fma_f32 v[174:175], v[254:255], v[216:217], v[174:175] op_sel_hi:[1,0,1]
    ds_read_b64_tr_b16 a[38:39], v99 offset:0
    v_pk_mul_f32 v[64:65], v[152:153], v[152:153]
    ds_read_b64_tr_b16 a[40:41], v96 offset:53248
    v_pk_mul_f32 v[72:73], v[168:169], v[168:169]
    ds_read_b64_tr_b16 a[42:43], v97 offset:53248
    v_pk_mul_f32 v[66:67], v[154:155], v[154:155]
    v_pk_mul_f32 v[74:75], v[170:171], v[170:171]
    ds_read_b64_tr_b16 a[44:45], v98 offset:4096
    v_pk_mul_f32 v[68:69], v[156:157], v[156:157]
    ds_read_b64_tr_b16 a[46:47], v99 offset:4096
    v_pk_mul_f32 v[76:77], v[172:173], v[172:173]
    v_pk_mul_f32 v[70:71], v[158:159], v[158:159]
    ds_read_b64_tr_b16 a[48:49], v96 offset:57344
    v_pk_mul_f32 v[78:79], v[174:175], v[174:175]
    ds_read_b64_tr_b16 a[50:51], v97 offset:57344
    v_pk_fma_f32 v[64:65], v[64:65], v[210:211], v[212:213] op_sel_hi:[1,0,0]
    ds_read_b64_tr_b16 a[52:53], v98 offset:8192
    v_pk_fma_f32 v[72:73], v[72:73], v[218:219], v[220:221] op_sel_hi:[1,0,0]
    v_pk_fma_f32 v[66:67], v[66:67], v[210:211], v[212:213] op_sel_hi:[1,0,0]
    ds_read_b64_tr_b16 a[54:55], v99 offset:8192
    v_pk_fma_f32 v[74:75], v[74:75], v[218:219], v[220:221] op_sel_hi:[1,0,0]
    ds_read_b64_tr_b16 a[56:57], v96 offset:61440
    v_pk_fma_f32 v[68:69], v[68:69], v[210:211], v[212:213] op_sel_hi:[1,0,0]
    v_pk_fma_f32 v[76:77], v[76:77], v[218:219], v[220:221] op_sel_hi:[1,0,0]
    ds_read_b64_tr_b16 a[58:59], v97 offset:61440
    v_pk_fma_f32 v[70:71], v[70:71], v[210:211], v[212:213] op_sel_hi:[1,0,0]
    ds_read_b64_tr_b16 a[60:61], v98 offset:12288
    v_pk_fma_f32 v[78:79], v[78:79], v[218:219], v[220:221] op_sel_hi:[1,0,0]
    ds_read_b64_tr_b16 a[62:63], v99 offset:12288
    v_pk_mul_f32 v[64:65], v[64:65], v[152:153]
    v_pk_mul_f32 v[72:73], v[72:73], v[168:169]
    ds_read_b64_tr_b16 a[64:65], v98 offset:49152
    v_pk_mul_f32 v[66:67], v[66:67], v[154:155]
    ds_read_b64_tr_b16 a[66:67], v99 offset:49152
    v_pk_mul_f32 v[74:75], v[74:75], v[170:171]
    v_pk_mul_f32 v[68:69], v[68:69], v[156:157]
    ds_read_b64_tr_b16 a[68:69], v96 offset:32768
    v_pk_mul_f32 v[76:77], v[76:77], v[172:173]
    ds_read_b64_tr_b16 a[70:71], v97 offset:32768
    v_pk_mul_f32 v[70:71], v[70:71], v[158:159]
    ds_read_b64_tr_b16 a[72:73], v98 offset:53248
    v_pk_mul_f32 v[78:79], v[78:79], v[174:175]
    v_exp_f32 v64, v64
    ds_read_b64_tr_b16 a[74:75], v99 offset:53248
    v_exp_f32 v72, v72
    ds_read_b64_tr_b16 a[76:77], v96 offset:36864
    v_exp_f32 v65, v65
    v_exp_f32 v73, v73
    ds_read_b64_tr_b16 a[78:79], v97 offset:36864
    v_exp_f32 v66, v66
    ds_read_b64_tr_b16 a[80:81], v98 offset:57344
    v_exp_f32 v74, v74
    ds_read_b64_tr_b16 a[82:83], v99 offset:57344
    v_exp_f32 v67, v67
    v_exp_f32 v75, v75
    ds_read_b64_tr_b16 a[84:85], v96 offset:40960
    v_exp_f32 v68, v68
    ds_read_b64_tr_b16 a[86:87], v97 offset:40960
    v_exp_f32 v76, v76
    v_exp_f32 v69, v69
    ds_read_b64_tr_b16 a[88:89], v98 offset:61440
    v_exp_f32 v77, v77
    ds_read_b64_tr_b16 a[90:91], v99 offset:61440
    v_exp_f32 v70, v70
    ds_read_b64_tr_b16 a[92:93], v96 offset:45056
    v_exp_f32 v78, v78
    v_exp_f32 v71, v71
    ds_read_b64_tr_b16 a[94:95], v97 offset:45056
    v_exp_f32 v79, v79
    ds_read_b64_tr_b16 a[96:97], v100 offset:0
    v_pk_fma_f32 v[64:65], v[64:65], v[214:215], v[214:215] op_sel_hi:[1,0,0]
    v_pk_fma_f32 v[72:73], v[72:73], v[222:223], v[222:223] op_sel_hi:[1,0,0]
    ds_read_b64_tr_b16 a[98:99], v101 offset:0
    v_pk_fma_f32 v[66:67], v[66:67], v[214:215], v[214:215] op_sel_hi:[1,0,0]
    ds_read_b64_tr_b16 a[100:101], v100 offset:16384
    v_pk_fma_f32 v[74:75], v[74:75], v[222:223], v[222:223] op_sel_hi:[1,0,0]
    ds_read_b64_tr_b16 a[102:103], v101 offset:16384
    v_pk_fma_f32 v[68:69], v[68:69], v[214:215], v[214:215] op_sel_hi:[1,0,0]
    v_pk_fma_f32 v[76:77], v[76:77], v[222:223], v[222:223] op_sel_hi:[1,0,0]
    ds_read_b64_tr_b16 a[104:105], v100 offset:4096
    v_pk_fma_f32 v[70:71], v[70:71], v[214:215], v[214:215] op_sel_hi:[1,0,0]
    ds_read_b64_tr_b16 a[106:107], v101 offset:4096
    v_pk_fma_f32 v[78:79], v[78:79], v[222:223], v[222:223] op_sel_hi:[1,0,0]
    v_rcp_f32 v64, v64
    ds_read_b64_tr_b16 a[108:109], v100 offset:20480
    v_rcp_f32 v72, v72
    ds_read_b64_tr_b16 a[110:111], v101 offset:20480
    v_rcp_f32 v65, v65
    ds_read_b64_tr_b16 a[112:113], v100 offset:8192
    v_rcp_f32 v73, v73
    v_rcp_f32 v66, v66
    ds_read_b64_tr_b16 a[114:115], v101 offset:8192
    v_rcp_f32 v74, v74
    ds_read_b64_tr_b16 a[116:117], v100 offset:24576
    v_rcp_f32 v67, v67
    v_rcp_f32 v75, v75
    ds_read_b64_tr_b16 a[118:119], v101 offset:24576
    v_rcp_f32 v68, v68
    ds_read_b64_tr_b16 a[120:121], v100 offset:12288
    v_rcp_f32 v76, v76
    ds_read_b64_tr_b16 a[122:123], v101 offset:12288
    v_rcp_f32 v69, v69
    v_rcp_f32 v77, v77
    ds_read_b64_tr_b16 a[124:125], v100 offset:28672
    v_rcp_f32 v70, v70
    ds_read_b64_tr_b16 a[126:127], v101 offset:28672
    v_rcp_f32 v78, v78
    v_rcp_f32 v71, v71
    v_rcp_f32 v79, v79
    v_pk_mul_f32 v[64:65], v[64:65], v[152:153]
    v_pk_mul_f32 v[72:73], v[72:73], v[168:169]
    v_pk_mul_f32 v[66:67], v[66:67], v[154:155]
    v_pk_mul_f32 v[74:75], v[74:75], v[170:171]
    v_pk_mul_f32 v[68:69], v[68:69], v[156:157]
    v_pk_mul_f32 v[76:77], v[76:77], v[172:173]
    v_pk_mul_f32 v[70:71], v[70:71], v[158:159]
    v_pk_mul_f32 v[78:79], v[78:79], v[174:175]
    v_cvt_pk_bf16_f32 v152, v64, v65
    v_cvt_pk_bf16_f32 v168, v72, v73
    v_cvt_pk_bf16_f32 v153, v66, v67
    v_cvt_pk_bf16_f32 v169, v74, v75
    v_cvt_pk_bf16_f32 v154, v68, v69
    v_cvt_pk_bf16_f32 v170, v76, v77
    v_cvt_pk_bf16_f32 v155, v70, v71
    v_cvt_pk_bf16_f32 v171, v78, v79
    ds_write_b128 v28, v[168:171] offset:5120
    ds_write_b128 v28, v[152:155] offset:4096
    s_waitcnt lgkmcnt(0)
    s_barrier
    v_pk_fma_f32 v[184:185], v[248:249], v[224:225], v[184:185] op_sel_hi:[1,0,1]
    s_add_u32 m0, s16, 49152
    s_add_u32 s42, s88, 0
    buffer_load_dwordx4 v17, s[60:63], s42 offen offset:0 lds
    v_pk_fma_f32 v[200:201], v[248:249], v[232:233], v[200:201] op_sel_hi:[1,0,1]
    buffer_load_dwordx4 v18, s[60:63], s42 offen offset:1024 lds
    v_pk_fma_f32 v[186:187], v[250:251], v[224:225], v[186:187] op_sel_hi:[1,0,1]
    buffer_load_dwordx4 v19, s[60:63], s42 offen offset:2048 lds
    v_pk_fma_f32 v[202:203], v[250:251], v[232:233], v[202:203] op_sel_hi:[1,0,1]
    v_pk_fma_f32 v[188:189], v[252:253], v[224:225], v[188:189] op_sel_hi:[1,0,1]
    v_pk_fma_f32 v[204:205], v[252:253], v[232:233], v[204:205] op_sel_hi:[1,0,1]
    buffer_load_dwordx4 v20, s[60:63], s42 offen offset:3072 lds
    v_pk_fma_f32 v[190:191], v[254:255], v[224:225], v[190:191] op_sel_hi:[1,0,1]
    v_pk_fma_f32 v[206:207], v[254:255], v[232:233], v[206:207] op_sel_hi:[1,0,1]
    v_pk_mul_f32 v[80:81], v[184:185], v[184:185]
    v_pk_mul_f32 v[88:89], v[200:201], v[200:201]
    v_pk_mul_f32 v[82:83], v[186:187], v[186:187]
    v_pk_mul_f32 v[90:91], v[202:203], v[202:203]
    v_pk_mul_f32 v[84:85], v[188:189], v[188:189]
    v_pk_mul_f32 v[92:93], v[204:205], v[204:205]
    v_pk_mul_f32 v[86:87], v[190:191], v[190:191]
    v_pk_mul_f32 v[94:95], v[206:207], v[206:207]
    v_pk_fma_f32 v[80:81], v[80:81], v[226:227], v[228:229] op_sel_hi:[1,0,0]
    v_pk_fma_f32 v[88:89], v[88:89], v[234:235], v[236:237] op_sel_hi:[1,0,0]
    v_pk_fma_f32 v[82:83], v[82:83], v[226:227], v[228:229] op_sel_hi:[1,0,0]
    v_pk_fma_f32 v[90:91], v[90:91], v[234:235], v[236:237] op_sel_hi:[1,0,0]
    v_pk_fma_f32 v[84:85], v[84:85], v[226:227], v[228:229] op_sel_hi:[1,0,0]
    s_add_u32 m0, s16, 65536
    s_add_u32 s42, s88, 28672
    buffer_load_dwordx4 v17, s[60:63], s42 offen offset:0 lds
    v_pk_fma_f32 v[92:93], v[92:93], v[234:235], v[236:237] op_sel_hi:[1,0,0]
    v_pk_fma_f32 v[86:87], v[86:87], v[226:227], v[228:229] op_sel_hi:[1,0,0]
    v_pk_fma_f32 v[94:95], v[94:95], v[234:235], v[236:237] op_sel_hi:[1,0,0]
    v_pk_mul_f32 v[80:81], v[80:81], v[184:185]
    v_pk_mul_f32 v[88:89], v[88:89], v[200:201]
    v_pk_mul_f32 v[82:83], v[82:83], v[186:187]
    v_pk_mul_f32 v[90:91], v[90:91], v[202:203]
    v_pk_mul_f32 v[84:85], v[84:85], v[188:189]
    v_pk_mul_f32 v[92:93], v[92:93], v[204:205]
    v_pk_mul_f32 v[86:87], v[86:87], v[190:191]
    v_pk_mul_f32 v[94:95], v[94:95], v[206:207]
    v_exp_f32 v80, v80
    v_exp_f32 v88, v88
    buffer_load_dwordx4 v18, s[60:63], s42 offen offset:1024 lds
    v_exp_f32 v81, v81
    v_exp_f32 v89, v89
    v_exp_f32 v82, v82
    v_exp_f32 v90, v90
    v_exp_f32 v83, v83
    v_exp_f32 v91, v91
    v_exp_f32 v84, v84
    v_exp_f32 v92, v92
    buffer_load_dwordx4 v19, s[60:63], s42 offen offset:2048 lds
    v_exp_f32 v85, v85
    v_exp_f32 v93, v93
    v_exp_f32 v86, v86
    v_exp_f32 v94, v94
    v_exp_f32 v87, v87
    v_exp_f32 v95, v95
    v_pk_fma_f32 v[80:81], v[80:81], v[230:231], v[230:231] op_sel_hi:[1,0,0]
    v_pk_fma_f32 v[88:89], v[88:89], v[238:239], v[238:239] op_sel_hi:[1,0,0]
    v_pk_fma_f32 v[82:83], v[82:83], v[230:231], v[230:231] op_sel_hi:[1,0,0]
    v_pk_fma_f32 v[90:91], v[90:91], v[238:239], v[238:239] op_sel_hi:[1,0,0]
    buffer_load_dwordx4 v20, s[60:63], s42 offen offset:3072 lds
    v_pk_fma_f32 v[84:85], v[84:85], v[230:231], v[230:231] op_sel_hi:[1,0,0]
    v_pk_fma_f32 v[92:93], v[92:93], v[238:239], v[238:239] op_sel_hi:[1,0,0]
    v_pk_fma_f32 v[86:87], v[86:87], v[230:231], v[230:231] op_sel_hi:[1,0,0]
    v_pk_fma_f32 v[94:95], v[94:95], v[238:239], v[238:239] op_sel_hi:[1,0,0]
    v_rcp_f32 v80, v80
    v_rcp_f32 v88, v88
    v_rcp_f32 v81, v81
    v_rcp_f32 v89, v89
    v_rcp_f32 v82, v82
    v_rcp_f32 v90, v90
    s_add_u32 m0, s16, 114688
    s_add_u32 s42, s89, 0
    buffer_load_dwordx4 v17, s[60:63], s42 offen offset:0 lds
    v_rcp_f32 v83, v83
    v_rcp_f32 v91, v91
    v_rcp_f32 v84, v84
    v_rcp_f32 v92, v92
    v_rcp_f32 v85, v85
    v_rcp_f32 v93, v93
    v_rcp_f32 v86, v86
    buffer_load_dwordx4 v18, s[60:63], s42 offen offset:1024 lds
    v_rcp_f32 v94, v94
    v_rcp_f32 v87, v87
    v_rcp_f32 v95, v95
    v_pk_mul_f32 v[80:81], v[80:81], v[184:185]
    v_pk_mul_f32 v[88:89], v[88:89], v[200:201]
    v_pk_mul_f32 v[82:83], v[82:83], v[186:187]
    v_pk_mul_f32 v[90:91], v[90:91], v[202:203]
    v_pk_mul_f32 v[84:85], v[84:85], v[188:189]
    v_pk_mul_f32 v[92:93], v[92:93], v[204:205]
    v_pk_mul_f32 v[86:87], v[86:87], v[190:191]
    v_pk_mul_f32 v[94:95], v[94:95], v[206:207]
    v_cvt_pk_bf16_f32 v184, v80, v81
    v_cvt_pk_bf16_f32 v200, v88, v89
    buffer_load_dwordx4 v19, s[60:63], s42 offen offset:2048 lds
    v_cvt_pk_bf16_f32 v185, v82, v83
    v_cvt_pk_bf16_f32 v201, v90, v91
    v_cvt_pk_bf16_f32 v186, v84, v85
    v_cvt_pk_bf16_f32 v202, v92, v93
    v_cvt_pk_bf16_f32 v187, v86, v87
    v_cvt_pk_bf16_f32 v203, v94, v95
    ds_write_b128 v28, v[200:203] offset:7168
    ds_write_b128 v28, v[184:187] offset:6144
    s_waitcnt lgkmcnt(0)
    s_barrier
    ds_read_b128 a[128:131], v22 offset:0
    buffer_load_dwordx4 v20, s[60:63], s42 offen offset:3072 lds
    ds_read_b128 a[132:135], v23 offset:0
    ds_read_b128 a[136:139], v24 offset:0
    ds_read_b128 a[140:143], v25 offset:0
    ds_read_b128 a[144:147], v22 offset:4096
    ds_read_b128 a[148:151], v23 offset:4096
    ds_read_b128 a[152:155], v24 offset:4096
    ds_read_b128 a[156:159], v25 offset:4096
    ds_read_b128 a[160:163], v22 offset:8192
    ds_read_b128 a[164:167], v23 offset:8192
    s_add_u32 m0, s16, 32768
    s_add_u32 s42, s89, 28672
    buffer_load_dwordx4 v17, s[60:63], s42 offen offset:0 lds
    ds_read_b128 a[168:171], v24 offset:8192
    ds_read_b128 a[172:175], v25 offset:8192
    s_waitcnt lgkmcnt(8)
    v_mfma_f32_16x16x32_bf16 v[144:147], a[32:35], a[128:131], 0
    ds_read_b128 a[176:179], v22 offset:12288
    ds_read_b128 a[180:183], v23 offset:12288
    v_mfma_f32_16x16x32_bf16 v[148:151], a[32:35], a[132:135], 0
    ds_read_b128 a[184:187], v24 offset:12288
    ds_read_b128 a[188:191], v25 offset:12288
    v_mfma_f32_16x16x32_bf16 v[152:155], a[32:35], a[136:139], 0
    v_mfma_f32_16x16x32_bf16 v[156:159], a[32:35], a[140:143], 0
    s_waitcnt lgkmcnt(8)
    buffer_load_dwordx4 v18, s[60:63], s42 offen offset:1024 lds
    v_mfma_f32_16x16x32_bf16 v[144:147], a[36:39], a[144:147], v[144:147]
    ds_read_b128 a[192:195], v22 offset:16384
    ds_read_b128 a[196:199], v23 offset:16384
    v_mfma_f32_16x16x32_bf16 v[148:151], a[36:39], a[148:151], v[148:151]
    ds_read_b128 a[200:203], v24 offset:16384
    ds_read_b128 a[204:207], v25 offset:16384
    v_mfma_f32_16x16x32_bf16 v[152:155], a[36:39], a[152:155], v[152:155]
    v_mfma_f32_16x16x32_bf16 v[156:159], a[36:39], a[156:159], v[156:159]
    s_waitcnt lgkmcnt(8)
    buffer_load_dwordx4 v19, s[60:63], s42 offen offset:2048 lds
    v_mfma_f32_16x16x32_bf16 v[144:147], a[40:43], a[160:163], v[144:147]
    ds_read_b128 a[208:211], v22 offset:20480
    ds_read_b128 a[212:215], v23 offset:20480
    v_mfma_f32_16x16x32_bf16 v[148:151], a[40:43], a[164:167], v[148:151]
    ds_read_b128 a[216:219], v24 offset:20480
    ds_read_b128 a[220:223], v25 offset:20480
    v_mfma_f32_16x16x32_bf16 v[152:155], a[40:43], a[168:171], v[152:155]
    v_mfma_f32_16x16x32_bf16 v[156:159], a[40:43], a[172:175], v[156:159]
    s_waitcnt lgkmcnt(8)
    v_mfma_f32_16x16x32_bf16 v[144:147], a[44:47], a[176:179], v[144:147]
    ds_read_b128 a[224:227], v22 offset:24576
    ds_read_b128 a[228:231], v23 offset:24576
    v_mfma_f32_16x16x32_bf16 v[148:151], a[44:47], a[180:183], v[148:151]
    ds_read_b128 a[232:235], v24 offset:24576
    ds_read_b128 a[236:239], v25 offset:24576
    v_mfma_f32_16x16x32_bf16 v[152:155], a[44:47], a[184:187], v[152:155]
    buffer_load_dwordx4 v20, s[60:63], s42 offen offset:3072 lds
    v_mfma_f32_16x16x32_bf16 v[156:159], a[44:47], a[188:191], v[156:159]
    s_waitcnt lgkmcnt(8)
    v_mfma_f32_16x16x32_bf16 v[144:147], a[48:51], a[192:195], v[144:147]
    ds_read_b128 a[240:243], v22 offset:28672
    ds_read_b128 a[244:247], v23 offset:28672
    v_mfma_f32_16x16x32_bf16 v[148:151], a[48:51], a[196:199], v[148:151]
    ds_read_b128 a[248:251], v24 offset:28672
    ds_read_b128 a[252:255], v25 offset:28672
    v_mfma_f32_16x16x32_bf16 v[152:155], a[48:51], a[200:203], v[152:155]
    s_add_u32 m0, s16, 131072
    s_add_u32 s42, s43, 0
    v_mfma_f32_16x16x32_bf16 v[156:159], a[48:51], a[204:207], v[156:159]
    s_waitcnt lgkmcnt(8)
    buffer_load_dwordx4 v17, s[60:63], s42 offen offset:0 lds
    v_mfma_f32_16x16x32_bf16 v[144:147], a[52:55], a[208:211], v[144:147]
    v_mfma_f32_16x16x32_bf16 v[148:151], a[52:55], a[212:215], v[148:151]
    buffer_load_dwordx4 v18, s[60:63], s42 offen offset:1024 lds
    v_mfma_f32_16x16x32_bf16 v[152:155], a[52:55], a[216:219], v[152:155]
    v_mfma_f32_16x16x32_bf16 v[156:159], a[52:55], a[220:223], v[156:159]
    s_waitcnt lgkmcnt(4)
    v_mfma_f32_16x16x32_bf16 v[144:147], a[56:59], a[224:227], v[144:147]
    v_mfma_f32_16x16x32_bf16 v[148:151], a[56:59], a[228:231], v[148:151]
    v_mfma_f32_16x16x32_bf16 v[152:155], a[56:59], a[232:235], v[152:155]
    buffer_load_dwordx4 v19, s[60:63], s42 offen offset:2048 lds
    v_mfma_f32_16x16x32_bf16 v[156:159], a[56:59], a[236:239], v[156:159]
    s_waitcnt lgkmcnt(0)
    v_mfma_f32_16x16x32_bf16 v[144:147], a[60:63], a[240:243], v[144:147]
    v_mfma_f32_16x16x32_bf16 v[148:151], a[60:63], a[244:247], v[148:151]
    v_mfma_f32_16x16x32_bf16 v[152:155], a[60:63], a[248:251], v[152:155]
    v_mfma_f32_16x16x32_bf16 v[156:159], a[60:63], a[252:255], v[156:159]
    buffer_load_dwordx4 v20, s[60:63], s42 offen offset:3072 lds
    v_mfma_f32_16x16x32_bf16 v[160:163], a[64:67], a[128:131], 0
    v_mfma_f32_16x16x32_bf16 v[164:167], a[64:67], a[132:135], 0
    v_mfma_f32_16x16x32_bf16 v[168:171], a[64:67], a[136:139], 0
    v_mfma_f32_16x16x32_bf16 v[172:175], a[64:67], a[140:143], 0
    s_waitcnt vmcnt(21)
    s_barrier
    s_add_u32 m0, s16, 147456
    v_mfma_f32_16x16x32_bf16 v[160:163], a[68:71], a[144:147], v[160:163]
    s_add_u32 s42, s43, 28672
    buffer_load_dwordx4 v17, s[60:63], s42 offen offset:0 lds
    v_mfma_f32_16x16x32_bf16 v[164:167], a[68:71], a[148:151], v[164:167]
    buffer_load_dwordx4 v18, s[60:63], s42 offen offset:1024 lds
    s_and_b32 s97, s84, 0x380
    v_mfma_f32_16x16x32_bf16 v[168:171], a[68:71], a[152:155], v[168:171]
    s_lshl_b32 s97, s97, 9
    s_add_u32 s97, s97, s96
    s_add_u32 s96, s96, 2048
    v_mfma_f32_16x16x32_bf16 v[172:175], a[68:71], a[156:159], v[172:175]
    v_cvt_pk_bf16_f32 v176, v144, v145
    v_cvt_pk_bf16_f32 v177, v146, v147
    v_mfma_f32_16x16x32_bf16 v[160:163], a[72:75], a[160:163], v[160:163]
    buffer_store_dwordx2 v[176:177], v102, s[56:59], s97 offen sc1
    v_cvt_pk_bf16_f32 v178, v148, v149
    v_mfma_f32_16x16x32_bf16 v[164:167], a[72:75], a[164:167], v[164:167]
    v_cvt_pk_bf16_f32 v179, v150, v151
    buffer_store_dwordx2 v[178:179], v103, s[56:59], s97 offen sc1
    v_mfma_f32_16x16x32_bf16 v[168:171], a[72:75], a[168:171], v[168:171]
    v_cvt_pk_bf16_f32 v180, v152, v153
    v_cvt_pk_bf16_f32 v181, v154, v155
    v_mfma_f32_16x16x32_bf16 v[172:175], a[72:75], a[172:175], v[172:175]
    buffer_store_dwordx2 v[180:181], v104, s[56:59], s97 offen sc1
    v_cvt_pk_bf16_f32 v182, v156, v157
    v_mfma_f32_16x16x32_bf16 v[160:163], a[76:79], a[176:179], v[160:163]
    v_cvt_pk_bf16_f32 v183, v158, v159
    buffer_store_dwordx2 v[182:183], v105, s[56:59], s97 offen sc1
    v_mfma_f32_16x16x32_bf16 v[164:167], a[76:79], a[180:183], v[164:167]
    ds_read_b64_tr_b16 v[208:209], v98 offset:16384
    ds_read_b64_tr_b16 v[210:211], v99 offset:16384
    v_mfma_f32_16x16x32_bf16 v[168:171], a[76:79], a[184:187], v[168:171]
    ds_read_b64_tr_b16 v[212:213], v98 offset:32768
    ds_read_b64_tr_b16 v[214:215], v99 offset:32768
    v_mfma_f32_16x16x32_bf16 v[172:175], a[76:79], a[188:191], v[172:175]
    ds_read_b64_tr_b16 v[216:217], v98 offset:20480
    ds_read_b64_tr_b16 v[218:219], v99 offset:20480
    v_mfma_f32_16x16x32_bf16 v[160:163], a[80:83], a[192:195], v[160:163]
    ds_read_b64_tr_b16 v[220:221], v98 offset:36864
    buffer_load_dwordx4 v19, s[60:63], s42 offen offset:2048 lds
    v_mfma_f32_16x16x32_bf16 v[164:167], a[80:83], a[196:199], v[164:167]
    ds_read_b64_tr_b16 v[222:223], v99 offset:36864
    ds_read_b64_tr_b16 v[224:225], v98 offset:24576
    v_mfma_f32_16x16x32_bf16 v[168:171], a[80:83], a[200:203], v[168:171]
    ds_read_b64_tr_b16 v[226:227], v99 offset:24576
    ds_read_b64_tr_b16 v[228:229], v98 offset:40960
    v_mfma_f32_16x16x32_bf16 v[172:175], a[80:83], a[204:207], v[172:175]
    ds_read_b64_tr_b16 v[230:231], v99 offset:40960
    ds_read_b64_tr_b16 v[232:233], v98 offset:28672
    v_mfma_f32_16x16x32_bf16 v[160:163], a[84:87], a[208:211], v[160:163]
    ds_read_b64_tr_b16 v[234:235], v99 offset:28672
    ds_read_b64_tr_b16 v[236:237], v98 offset:45056
    v_mfma_f32_16x16x32_bf16 v[164:167], a[84:87], a[212:215], v[164:167]
    buffer_load_dwordx4 v20, s[60:63], s42 offen offset:3072 lds
    ds_read_b64_tr_b16 v[238:239], v99 offset:45056
    v_mfma_f32_16x16x32_bf16 v[168:171], a[84:87], a[216:219], v[168:171]
    v_mfma_f32_16x16x32_bf16 v[172:175], a[84:87], a[220:223], v[172:175]
    v_lshrrev_b32 v12, 3, v3
    v_sub_u32 v12, v2, v12
    v_mfma_f32_16x16x32_bf16 v[160:163], a[88:91], a[224:227], v[160:163]
    v_bfe_u32 v13, v3, 1, 2
    v_lshl_add_u32 v12, v12, 2, v13
    v_mfma_f32_16x16x32_bf16 v[164:167], a[88:91], a[228:231], v[164:167]
    v_and_b32 v13, 1, v3
    s_add_u32 m0, s16, 0
    v_mfma_f32_16x16x32_bf16 v[168:171], a[88:91], a[232:235], v[168:171]
    s_add_u32 s42, s93, 0
    buffer_load_dwordx4 v17, s[52:55], s42 offen offset:0 lds
    v_mfma_f32_16x16x32_bf16 v[172:175], a[88:91], a[236:239], v[172:175]
    v_lshlrev_b32 v13, 4, v13
    v_lshlrev_b32 v13, v13, v63
    v_mfma_f32_16x16x32_bf16 v[160:163], a[92:95], a[240:243], v[160:163]
    v_mul_u32_u24 v13, 0x3f80, v13
    v_cmp_eq_u32 vcc, 0, v12
    v_mfma_f32_16x16x32_bf16 v[164:167], a[92:95], a[244:247], v[164:167]
    s_nop 0
    v_cndmask_b32 v106, 0, v13, vcc
    v_mfma_f32_16x16x32_bf16 v[168:171], a[92:95], a[248:251], v[168:171]
    buffer_load_dwordx4 v18, s[52:55], s42 offen offset:1024 lds
    v_cmp_eq_u32 vcc, 1, v12
    v_mfma_f32_16x16x32_bf16 v[172:175], a[92:95], a[252:255], v[172:175]
    s_nop 0
    v_cndmask_b32 v107, 0, v13, vcc
    v_mfma_f32_16x16x32_bf16 v[144:147], a[96:99], a[128:131], 0
    v_cmp_eq_u32 vcc, 2, v12
    s_nop 1
    v_cndmask_b32 v108, 0, v13, vcc
    v_mfma_f32_16x16x32_bf16 v[148:151], a[96:99], a[132:135], 0
    v_cmp_eq_u32 vcc, 3, v12
    s_nop 1
    v_cndmask_b32 v109, 0, v13, vcc
    v_mfma_f32_16x16x32_bf16 v[152:155], a[96:99], a[136:139], 0
    buffer_load_dwordx4 v19, s[52:55], s42 offen offset:2048 lds
    v_cmp_eq_u32 vcc, 8, v12
    v_mfma_f32_16x16x32_bf16 v[156:159], a[96:99], a[140:143], 0
    s_and_b32 s97, s85, 0x380
    s_lshl_b32 s97, s97, 9
    s_add_u32 s97, s97, s96
    v_mfma_f32_16x16x32_bf16 v[144:147], a[100:103], a[144:147], v[144:147]
    s_add_u32 s96, s96, 2048
    v_cvt_pk_bf16_f32 v184, v160, v161
    v_mfma_f32_16x16x32_bf16 v[148:151], a[100:103], a[148:151], v[148:151]
    v_cvt_pk_bf16_f32 v185, v162, v163
    buffer_store_dwordx2 v[184:185], v102, s[56:59], s97 offen sc1
    v_mfma_f32_16x16x32_bf16 v[152:155], a[100:103], a[152:155], v[152:155]
    v_cvt_pk_bf16_f32 v186, v164, v165
    v_cvt_pk_bf16_f32 v187, v166, v167
    v_mfma_f32_16x16x32_bf16 v[156:159], a[100:103], a[156:159], v[156:159]
    buffer_store_dwordx2 v[186:187], v103, s[56:59], s97 offen sc1
    v_cvt_pk_bf16_f32 v188, v168, v169
    v_mfma_f32_16x16x32_bf16 v[144:147], a[104:107], a[160:163], v[144:147]
    v_cvt_pk_bf16_f32 v189, v170, v171
    buffer_store_dwordx2 v[188:189], v104, s[56:59], s97 offen sc1
    v_mfma_f32_16x16x32_bf16 v[148:151], a[104:107], a[164:167], v[148:151]
    v_cvt_pk_bf16_f32 v190, v172, v173
    v_cvt_pk_bf16_f32 v191, v174, v175
    v_mfma_f32_16x16x32_bf16 v[152:155], a[104:107], a[168:171], v[152:155]
    buffer_store_dwordx2 v[190:191], v105, s[56:59], s97 offen sc1
    v_cndmask_b32 v110, 0, v13, vcc
    v_mfma_f32_16x16x32_bf16 v[156:159], a[104:107], a[172:175], v[156:159]
    v_cmp_eq_u32 vcc, 9, v12
    s_nop 1
    v_cndmask_b32 v111, 0, v13, vcc
    v_mfma_f32_16x16x32_bf16 v[144:147], a[108:111], a[176:179], v[144:147]
    v_cmp_eq_u32 vcc, 10, v12
    s_nop 1
    v_cndmask_b32 v112, 0, v13, vcc
    v_mfma_f32_16x16x32_bf16 v[148:151], a[108:111], a[180:183], v[148:151]
    v_cmp_eq_u32 vcc, 11, v12
    buffer_load_dwordx4 v21, s[52:55], s42 offen offset:3072 lds
    v_mfma_f32_16x16x32_bf16 v[152:155], a[108:111], a[184:187], v[152:155]
    v_cndmask_b32 v113, 0, v13, vcc
    v_mfma_f32_16x16x32_bf16 v[156:159], a[108:111], a[188:191], v[156:159]
    s_waitcnt lgkmcnt(0)
    s_buffer_load_dword s31, s[56:59], s91 offset:0x18 glc
    s_buffer_load_dword s79, s[56:59], s91 offset:0x8 glc
    v_mfma_f32_16x16x32_bf16 v[144:147], a[112:115], a[192:195], v[144:147]
    v_mfma_f32_16x16x32_bf16 v[148:151], a[112:115], a[196:199], v[148:151]
    v_mfma_f32_16x16x32_bf16 v[152:155], a[112:115], a[200:203], v[152:155]
    s_add_u32 m0, s16, 16384
    s_add_u32 s42, s93, 25088
    v_mfma_f32_16x16x32_bf16 v[156:159], a[112:115], a[204:207], v[156:159]
    buffer_load_dwordx4 v17, s[52:55], s42 offen offset:0 lds
    v_mfma_f32_16x16x32_bf16 v[144:147], a[116:119], a[208:211], v[144:147]
    v_mfma_f32_16x16x32_bf16 v[148:151], a[116:119], a[212:215], v[148:151]
    v_mfma_f32_16x16x32_bf16 v[152:155], a[116:119], a[216:219], v[152:155]
    v_mfma_f32_16x16x32_bf16 v[156:159], a[116:119], a[220:223], v[156:159]
    buffer_load_dwordx4 v18, s[52:55], s42 offen offset:1024 lds
    v_mfma_f32_16x16x32_bf16 v[144:147], a[120:123], a[224:227], v[144:147]
    v_mfma_f32_16x16x32_bf16 v[148:151], a[120:123], a[228:231], v[148:151]
    v_mfma_f32_16x16x32_bf16 v[152:155], a[120:123], a[232:235], v[152:155]
    v_mfma_f32_16x16x32_bf16 v[156:159], a[120:123], a[236:239], v[156:159]
    v_mfma_f32_16x16x32_bf16 v[144:147], a[124:127], a[240:243], v[144:147]
    buffer_load_dwordx4 v19, s[52:55], s42 offen offset:2048 lds
    v_mfma_f32_16x16x32_bf16 v[148:151], a[124:127], a[244:247], v[148:151]
    v_mfma_f32_16x16x32_bf16 v[152:155], a[124:127], a[248:251], v[152:155]
    v_mfma_f32_16x16x32_bf16 v[156:159], a[124:127], a[252:255], v[156:159]
    v_mfma_f32_16x16x32_bf16 v[160:163], v[208:211], a[128:131], 0
    buffer_load_dwordx4 v21, s[52:55], s42 offen offset:3072 lds
    v_mfma_f32_16x16x32_bf16 v[164:167], v[208:211], a[132:135], 0
    v_mfma_f32_16x16x32_bf16 v[168:171], v[208:211], a[136:139], 0
    v_mfma_f32_16x16x32_bf16 v[172:175], v[208:211], a[140:143], 0
    s_and_b32 s97, s86, 0x380
    s_lshl_b32 s97, s97, 9
    s_add_u32 s97, s97, s96
    v_mfma_f32_16x16x32_bf16 v[160:163], v[212:215], a[144:147], v[160:163]
    s_add_u32 s96, s96, 2048
    v_cvt_pk_bf16_f32 v176, v144, v145
    v_mfma_f32_16x16x32_bf16 v[164:167], v[212:215], a[148:151], v[164:167]
    v_cvt_pk_bf16_f32 v177, v146, v147
    buffer_store_dwordx2 v[176:177], v102, s[56:59], s97 offen sc1
    v_mfma_f32_16x16x32_bf16 v[168:171], v[212:215], a[152:155], v[168:171]
    v_cvt_pk_bf16_f32 v178, v148, v149
    v_cvt_pk_bf16_f32 v179, v150, v151
    v_mfma_f32_16x16x32_bf16 v[172:175], v[212:215], a[156:159], v[172:175]
    buffer_store_dwordx2 v[178:179], v103, s[56:59], s97 offen sc1
    v_cvt_pk_bf16_f32 v180, v152, v153
    v_mfma_f32_16x16x32_bf16 v[160:163], v[216:219], a[160:163], v[160:163]
    v_cvt_pk_bf16_f32 v181, v154, v155
    buffer_store_dwordx2 v[180:181], v104, s[56:59], s97 offen sc1
    v_mfma_f32_16x16x32_bf16 v[164:167], v[216:219], a[164:167], v[164:167]
    v_cvt_pk_bf16_f32 v182, v156, v157
    v_cvt_pk_bf16_f32 v183, v158, v159
    v_mfma_f32_16x16x32_bf16 v[168:171], v[216:219], a[168:171], v[168:171]
    buffer_store_dwordx2 v[182:183], v105, s[56:59], s97 offen sc1
    v_mfma_f32_16x16x32_bf16 v[172:175], v[216:219], a[172:175], v[172:175]
    s_waitcnt vmcnt(16)
    s_waitcnt lgkmcnt(0)
    s_barrier
    s_waitcnt lgkmcnt(0)
    s_cmp_ge_u32 s79, 4
    s_nop 2
    s_cbranch_scc1 L_pw_ff
    s_mov_b32 s9, 0
    s_nop 0
L_pl_ff:
    s_buffer_load_dword s79, s[56:59], s91 offset:0x8 glc
    s_add_u32 s9, s9, 1
    s_waitcnt lgkmcnt(0)
    s_cmp_ge_u32 s79, 4
    s_nop 0
    s_cbranch_scc1 L_pw_ff
    s_cmp_lt_u32 s9, 40000
    s_nop 0
    s_cbranch_scc1 L_pl_ff
    s_nop 0
L_pw_ff:
    s_waitcnt lgkmcnt(0)
    s_cmp_ge_u32 s31, 16
    s_nop 0
    s_cbranch_scc1 L_pw_fo
    s_mov_b32 s9, 0
    s_nop 0
L_pl_fo:
    s_buffer_load_dword s31, s[56:59], s91 offset:0x18 glc
    s_add_u32 s9, s9, 1
    s_waitcnt lgkmcnt(0)
    s_cmp_ge_u32 s31, 16
    s_nop 0
    s_cbranch_scc1 L_pw_fo
    s_cmp_lt_u32 s9, 40000
    s_nop 0
    s_cbranch_scc1 L_pl_fo
    s_nop 0
L_pw_fo:
    v_mfma_f32_16x16x32_bf16 v[160:163], v[220:223], a[176:179], v[160:163]
    s_add_u32 m0, s16, 81920
    s_add_u32 s42, s93, 200704
    v_mfma_f32_16x16x32_bf16 v[164:167], v[220:223], a[180:183], v[164:167]
    buffer_load_dwordx4 v17, s[52:55], s42 offen offset:0 lds
    buffer_load_dwordx4 v18, s[52:55], s42 offen offset:1024 lds
    v_mfma_f32_16x16x32_bf16 v[168:171], v[220:223], a[184:187], v[168:171]
    buffer_load_dwordx4 v19, s[52:55], s42 offen offset:2048 lds
    v_mfma_f32_16x16x32_bf16 v[172:175], v[220:223], a[188:191], v[172:175]
    v_mfma_f32_16x16x32_bf16 v[160:163], v[224:227], a[192:195], v[160:163]
L_hop6:
    s_cbranch_execz L_hop7
    v_mfma_f32_16x16x32_bf16 v[164:167], v[224:227], a[196:199], v[164:167]
    v_mfma_f32_16x16x32_bf16 v[168:171], v[224:227], a[200:203], v[168:171]
    buffer_load_dwordx4 v21, s[52:55], s42 offen offset:3072 lds
    v_mfma_f32_16x16x32_bf16 v[172:175], v[224:227], a[204:207], v[172:175]
    v_mfma_f32_16x16x32_bf16 v[160:163], v[228:231], a[208:211], v[160:163]
    ds_read_b64_tr_b16 v[64:65], v96 offset:49152
    ds_read_b64_tr_b16 v[66:67], v97 offset:49152
    v_mfma_f32_16x16x32_bf16 v[164:167], v[228:231], a[212:215], v[164:167]
    v_mfma_f32_16x16x32_bf16 v[168:171], v[228:231], a[216:219], v[168:171]
    v_mfma_f32_16x16x32_bf16 v[172:175], v[228:231], a[220:223], v[172:175]
    s_add_u32 m0, s16, 98304
    s_add_u32 s42, s93, 225792
    v_mfma_f32_16x16x32_bf16 v[160:163], v[232:235], a[224:227], v[160:163]
    ds_read_b64_tr_b16 v[68:69], v98 offset:0
    ds_read_b64_tr_b16 v[70:71], v99 offset:0
    v_mfma_f32_16x16x32_bf16 v[164:167], v[232:235], a[228:231], v[164:167]
    buffer_load_dwordx4 v17, s[52:55], s42 offen offset:0 lds
    v_mfma_f32_16x16x32_bf16 v[168:171], v[232:235], a[232:235], v[168:171]
    v_mfma_f32_16x16x32_bf16 v[172:175], v[232:235], a[236:239], v[172:175]
    buffer_load_dwordx4 v18, s[52:55], s42 offen offset:1024 lds
    v_mfma_f32_16x16x32_bf16 v[160:163], v[236:239], a[240:243], v[160:163]
    ds_read_b64_tr_b16 v[72:73], v96 offset:53248
    ds_read_b64_tr_b16 v[74:75], v97 offset:53248
    v_mfma_f32_16x16x32_bf16 v[164:167], v[236:239], a[244:247], v[164:167]
    v_mfma_f32_16x16x32_bf16 v[168:171], v[236:239], a[248:251], v[168:171]
    v_mfma_f32_16x16x32_bf16 v[172:175], v[236:239], a[252:255], v[172:175]
    s_waitcnt lgkmcnt(4)
    v_mfma_f32_16x16x32_bf16 v[144:147], v[64:67], a[128:131], 0
    ds_read_b64_tr_b16 v[76:77], v98 offset:4096
    ds_read_b64_tr_b16 v[78:79], v99 offset:4096
    v_mfma_f32_16x16x32_bf16 v[148:151], v[64:67], a[132:135], 0
    buffer_load_dwordx4 v19, s[52:55], s42 offen offset:2048 lds
    v_mfma_f32_16x16x32_bf16 v[152:155], v[64:67], a[136:139], 0
    v_mfma_f32_16x16x32_bf16 v[156:159], v[64:67], a[140:143], 0
    s_waitcnt lgkmcnt(4)
    s_and_b32 s97, s87, 0x380
    s_lshl_b32 s97, s97, 9
    v_mfma_f32_16x16x32_bf16 v[144:147], v[68:71], a[144:147], v[144:147]
    ds_read_b64_tr_b16 v[64:65], v96 offset:57344
    ds_read_b64_tr_b16 v[66:67], v97 offset:57344
    v_mfma_f32_16x16x32_bf16 v[148:151], v[68:71], a[148:151], v[148:151]
    buffer_load_dwordx4 v21, s[52:55], s42 offen offset:3072 lds
    s_add_u32 s97, s97, s96
    v_mfma_f32_16x16x32_bf16 v[152:155], v[68:71], a[152:155], v[152:155]
    s_add_u32 s96, s96, 2048
    v_cvt_pk_bf16_f32 v184, v160, v161
    v_mfma_f32_16x16x32_bf16 v[156:159], v[68:71], a[156:159], v[156:159]
    s_waitcnt lgkmcnt(4)
    v_cvt_pk_bf16_f32 v185, v162, v163
    v_mfma_f32_16x16x32_bf16 v[144:147], v[72:75], a[160:163], v[144:147]
    ds_read_b64_tr_b16 v[68:69], v98 offset:8192
    ds_read_b64_tr_b16 v[70:71], v99 offset:8192
    v_mfma_f32_16x16x32_bf16 v[148:151], v[72:75], a[164:167], v[148:151]
    s_add_u32 s42, s21, 0
    buffer_load_dwordx4 a[0:3], v16, s[56:59], s42 offen offset:0
    v_mfma_f32_16x16x32_bf16 v[152:155], v[72:75], a[168:171], v[152:155]
    buffer_store_dwordx2 v[184:185], v102, s[56:59], s97 offen sc1
    v_cvt_pk_bf16_f32 v186, v164, v165
    v_mfma_f32_16x16x32_bf16 v[156:159], v[72:75], a[172:175], v[156:159]
    s_waitcnt lgkmcnt(4)
    v_cvt_pk_bf16_f32 v187, v166, v167
    v_mfma_f32_16x16x32_bf16 v[144:147], v[76:79], a[176:179], v[144:147]
    ds_read_b64_tr_b16 v[72:73], v96 offset:61440
    ds_read_b64_tr_b16 v[74:75], v97 offset:61440
    v_mfma_f32_16x16x32_bf16 v[148:151], v[76:79], a[180:183], v[148:151]
    buffer_store_dwordx2 v[186:187], v103, s[56:59], s97 offen sc1
    v_cvt_pk_bf16_f32 v188, v168, v169
    v_mfma_f32_16x16x32_bf16 v[152:155], v[76:79], a[184:187], v[152:155]
    v_cvt_pk_bf16_f32 v189, v170, v171
    buffer_store_dwordx2 v[188:189], v104, s[56:59], s97 offen sc1
    v_mfma_f32_16x16x32_bf16 v[156:159], v[76:79], a[188:191], v[156:159]
    s_waitcnt lgkmcnt(4)
    v_cvt_pk_bf16_f32 v190, v172, v173
    v_mfma_f32_16x16x32_bf16 v[144:147], v[64:67], a[192:195], v[144:147]
    ds_read_b64_tr_b16 v[76:77], v98 offset:12288
    ds_read_b64_tr_b16 v[78:79], v99 offset:12288
    v_mfma_f32_16x16x32_bf16 v[148:151], v[64:67], a[196:199], v[148:151]
    v_cvt_pk_bf16_f32 v191, v174, v175
    buffer_store_dwordx2 v[190:191], v105, s[56:59], s97 offen sc1
    v_mfma_f32_16x16x32_bf16 v[152:155], v[64:67], a[200:203], v[152:155]
    v_mfma_f32_16x16x32_bf16 v[156:159], v[64:67], a[204:207], v[156:159]
    s_waitcnt lgkmcnt(4)
    v_mfma_f32_16x16x32_bf16 v[144:147], v[68:71], a[208:211], v[144:147]
    ds_read_b64_tr_b16 v[64:65], v98 offset:49152
    ds_read_b64_tr_b16 v[66:67], v99 offset:49152
    v_mfma_f32_16x16x32_bf16 v[148:151], v[68:71], a[212:215], v[148:151]
    buffer_load_dwordx4 a[4:7], v16, s[56:59], s42 offen offset:1024
    v_mfma_f32_16x16x32_bf16 v[152:155], v[68:71], a[216:219], v[152:155]
    v_mfma_f32_16x16x32_bf16 v[156:159], v[68:71], a[220:223], v[156:159]
    s_waitcnt lgkmcnt(4)
    v_mfma_f32_16x16x32_bf16 v[144:147], v[72:75], a[224:227], v[144:147]
    ds_read_b64_tr_b16 v[68:69], v96 offset:32768
    ds_read_b64_tr_b16 v[70:71], v97 offset:32768
    v_mfma_f32_16x16x32_bf16 v[148:151], v[72:75], a[228:231], v[148:151]
    v_mfma_f32_16x16x32_bf16 v[152:155], v[72:75], a[232:235], v[152:155]
    buffer_load_dwordx4 a[8:11], v16, s[56:59], s42 offen offset:2048
    v_mfma_f32_16x16x32_bf16 v[156:159], v[72:75], a[236:239], v[156:159]
    s_waitcnt lgkmcnt(4)
    v_mfma_f32_16x16x32_bf16 v[144:147], v[76:79], a[240:243], v[144:147]
    ds_read_b64_tr_b16 v[72:73], v98 offset:53248
    ds_read_b64_tr_b16 v[74:75], v99 offset:53248
    v_mfma_f32_16x16x32_bf16 v[148:151], v[76:79], a[244:247], v[148:151]
    v_mfma_f32_16x16x32_bf16 v[152:155], v[76:79], a[248:251], v[152:155]
    v_mfma_f32_16x16x32_bf16 v[156:159], v[76:79], a[252:255], v[156:159]
    s_waitcnt lgkmcnt(4)
    buffer_load_dwordx4 a[12:15], v16, s[56:59], s42 offen offset:3072
    v_mfma_f32_16x16x32_bf16 v[160:163], v[64:67], a[128:131], 0
    ds_read_b64_tr_b16 v[76:77], v96 offset:36864
    ds_read_b64_tr_b16 v[78:79], v97 offset:36864
    v_mfma_f32_16x16x32_bf16 v[164:167], v[64:67], a[132:135], 0
    v_mfma_f32_16x16x32_bf16 v[168:171], v[64:67], a[136:139], 0
    v_mfma_f32_16x16x32_bf16 v[172:175], v[64:67], a[140:143], 0
    s_waitcnt lgkmcnt(4)
    s_add_u32 s42, s21, 4096
    s_and_b32 s97, s88, 0x380
    v_mfma_f32_16x16x32_bf16 v[160:163], v[68:71], a[144:147], v[160:163]
    ds_read_b64_tr_b16 v[64:65], v98 offset:57344
    ds_read_b64_tr_b16 v[66:67], v99 offset:57344
    v_mfma_f32_16x16x32_bf16 v[164:167], v[68:71], a[148:151], v[164:167]
    buffer_load_dwordx4 a[16:19], v16, s[56:59], s42 offen offset:0
    s_lshl_b32 s97, s97, 9
    v_mfma_f32_16x16x32_bf16 v[168:171], v[68:71], a[152:155], v[168:171]
    s_add_u32 s97, s97, s96
    s_add_u32 s96, s96, 2048
    v_mfma_f32_16x16x32_bf16 v[172:175], v[68:71], a[156:159], v[172:175]
    s_waitcnt vmcnt(17)
    s_and_b32 s12, s84, 0x380
    s_lshl_b32 s12, s12, 7
    s_and_b32 s13, s85, 0x380
    s_lshl_b32 s13, s13, 7
    s_and_b32 s14, s86, 0x380
    s_lshl_b32 s14, s14, 7
    s_mov_b64 exec, 15
    buffer_atomic_add v63, v27, s[56:59], s12 offen offset:8 sc1
    buffer_atomic_add v63, v27, s[56:59], s13 offen offset:8 sc1
    buffer_atomic_add v63, v27, s[56:59], s14 offen offset:8 sc1
    s_mov_b64 exec, -1
    s_waitcnt lgkmcnt(4)
    v_mfma_f32_16x16x32_bf16 v[160:163], v[72:75], a[160:163], v[160:163]
    ds_read_b64_tr_b16 v[68:69], v96 offset:40960
    ds_read_b64_tr_b16 v[70:71], v97 offset:40960
    v_mfma_f32_16x16x32_bf16 v[164:167], v[72:75], a[164:167], v[164:167]
    buffer_load_dwordx4 a[20:23], v16, s[56:59], s42 offen offset:1024
    v_cvt_pk_bf16_f32 v176, v144, v145
    v_mfma_f32_16x16x32_bf16 v[168:171], v[72:75], a[168:171], v[168:171]
    v_cvt_pk_bf16_f32 v177, v146, v147
    buffer_store_dwordx2 v[176:177], v102, s[56:59], s97 offen sc1
    v_mfma_f32_16x16x32_bf16 v[172:175], v[72:75], a[172:175], v[172:175]
    s_waitcnt lgkmcnt(4)
    v_cvt_pk_bf16_f32 v178, v148, v149
    v_mfma_f32_16x16x32_bf16 v[160:163], v[76:79], a[176:179], v[160:163]
    ds_read_b64_tr_b16 v[72:73], v98 offset:61440
    ds_read_b64_tr_b16 v[74:75], v99 offset:61440
    v_mfma_f32_16x16x32_bf16 v[164:167], v[76:79], a[180:183], v[164:167]
    v_cvt_pk_bf16_f32 v179, v150, v151
    buffer_store_dwordx2 v[178:179], v103, s[56:59], s97 offen sc1
    v_mfma_f32_16x16x32_bf16 v[168:171], v[76:79], a[184:187], v[168:171]
    v_cvt_pk_bf16_f32 v180, v152, v153
    v_cvt_pk_bf16_f32 v181, v154, v155
    v_mfma_f32_16x16x32_bf16 v[172:175], v[76:79], a[188:191], v[172:175]
    s_waitcnt lgkmcnt(4)
    buffer_store_dwordx2 v[180:181], v104, s[56:59], s97 offen sc1
    v_mfma_f32_16x16x32_bf16 v[160:163], v[64:67], a[192:195], v[160:163]
    ds_read_b64_tr_b16 v[76:77], v96 offset:45056
    ds_read_b64_tr_b16 v[78:79], v97 offset:45056
    v_mfma_f32_16x16x32_bf16 v[164:167], v[64:67], a[196:199], v[164:167]
    v_cvt_pk_bf16_f32 v182, v156, v157
    v_cvt_pk_bf16_f32 v183, v158, v159
    v_mfma_f32_16x16x32_bf16 v[168:171], v[64:67], a[200:203], v[168:171]
    buffer_load_dwordx4 a[24:27], v16, s[56:59], s42 offen offset:2048
    buffer_store_dwordx2 v[182:183], v105, s[56:59], s97 offen sc1
    v_mfma_f32_16x16x32_bf16 v[172:175], v[64:67], a[204:207], v[172:175]
    s_waitcnt lgkmcnt(4)
    v_mfma_f32_16x16x32_bf16 v[160:163], v[68:71], a[208:211], v[160:163]
    v_mfma_f32_16x16x32_bf16 v[164:167], v[68:71], a[212:215], v[164:167]
    v_mfma_f32_16x16x32_bf16 v[168:171], v[68:71], a[216:219], v[168:171]
    v_mfma_f32_16x16x32_bf16 v[172:175], v[68:71], a[220:223], v[172:175]
    s_waitcnt lgkmcnt(2)
    v_mfma_f32_16x16x32_bf16 v[160:163], v[72:75], a[224:227], v[160:163]
    ds_read_b64_tr_b16 v[208:209], v48 offset:0
    ds_read_b64_tr_b16 v[210:211], v49 offset:0
    v_mfma_f32_16x16x32_bf16 v[164:167], v[72:75], a[228:231], v[164:167]
    ds_read_b64_tr_b16 v[212:213], v50 offset:0
    ds_read_b64_tr_b16 v[214:215], v51 offset:0
    v_mfma_f32_16x16x32_bf16 v[168:171], v[72:75], a[232:235], v[168:171]
    ds_read_b64_tr_b16 v[216:217], v52 offset:0
    ds_read_b64_tr_b16 v[218:219], v53 offset:0
    v_mfma_f32_16x16x32_bf16 v[172:175], v[72:75], a[236:239], v[172:175]
    ds_read_b64_tr_b16 v[220:221], v54 offset:0
    ds_read_b64_tr_b16 v[222:223], v55 offset:0
    s_waitcnt lgkmcnt(8)
    v_mfma_f32_16x16x32_bf16 v[160:163], v[76:79], a[240:243], v[160:163]
    ds_read_b64_tr_b16 v[224:225], v48 offset:16384
    ds_read_b64_tr_b16 v[226:227], v49 offset:16384
    v_mfma_f32_16x16x32_bf16 v[164:167], v[76:79], a[244:247], v[164:167]
    ds_read_b64_tr_b16 v[228:229], v50 offset:16384
    ds_read_b64_tr_b16 v[230:231], v51 offset:16384
    v_mfma_f32_16x16x32_bf16 v[168:171], v[76:79], a[248:251], v[168:171]
    ds_read_b64_tr_b16 v[232:233], v52 offset:16384
    ds_read_b64_tr_b16 v[234:235], v53 offset:16384
    v_mfma_f32_16x16x32_bf16 v[172:175], v[76:79], a[252:255], v[172:175]
    ds_read_b64_tr_b16 v[236:237], v54 offset:16384
    ds_read_b64_tr_b16 v[238:239], v55 offset:16384
    s_waitcnt lgkmcnt(8)
    v_mfma_f32_16x16x32_bf16 v[128:131], v[208:211], a[128:131], v[128:131]
    ds_read_b64_tr_b16 v[240:241], v48 offset:4096
    ds_read_b64_tr_b16 v[242:243], v49 offset:4096
    v_mfma_f32_16x16x32_bf16 v[132:135], v[212:215], a[128:131], v[132:135]
    ds_read_b64_tr_b16 v[244:245], v50 offset:4096
    ds_read_b64_tr_b16 v[246:247], v51 offset:4096
    v_mfma_f32_16x16x32_bf16 v[136:139], v[216:219], a[128:131], v[136:139]
    ds_read_b64_tr_b16 v[248:249], v52 offset:4096
    ds_read_b64_tr_b16 v[250:251], v53 offset:4096
    buffer_load_dwordx4 a[28:31], v16, s[56:59], s42 offen offset:3072
    v_mfma_f32_16x16x32_bf16 v[140:143], v[220:223], a[128:131], v[140:143]
    ds_read_b64_tr_b16 v[252:253], v54 offset:4096
    ds_read_b64_tr_b16 v[254:255], v55 offset:4096
    s_waitcnt lgkmcnt(8)
    v_mfma_f32_16x16x32_bf16 v[128:131], v[224:227], a[144:147], v[128:131]
    ds_read_b64_tr_b16 v[208:209], v48 offset:20480
    ds_read_b64_tr_b16 v[210:211], v49 offset:20480
    s_and_b32 s97, s89, 0x380
    s_lshl_b32 s97, s97, 9
    s_add_u32 s97, s97, s96
    s_add_u32 s96, s96, 2048
    v_cvt_pk_bf16_f32 v184, v160, v161
    s_add_u32 s42, s21, 8192
    buffer_load_dwordx4 a[32:35], v16, s[56:59], s42 offen offset:0
    v_cvt_pk_bf16_f32 v185, v162, v163
    buffer_load_dwordx4 a[36:39], v16, s[56:59], s42 offen offset:1024
    buffer_store_dwordx2 v[184:185], v102, s[56:59], s97 offen sc1
    v_cvt_pk_bf16_f32 v186, v164, v165
    buffer_load_dwordx4 a[40:43], v16, s[56:59], s42 offen offset:2048
    v_cvt_pk_bf16_f32 v187, v166, v167
    buffer_store_dwordx2 v[186:187], v103, s[56:59], s97 offen sc1
    v_cvt_pk_bf16_f32 v188, v168, v169
    v_cvt_pk_bf16_f32 v189, v170, v171
    buffer_store_dwordx2 v[188:189], v104, s[56:59], s97 offen sc1
    v_cvt_pk_bf16_f32 v190, v172, v173
    v_cvt_pk_bf16_f32 v191, v174, v175
    buffer_store_dwordx2 v[190:191], v105, s[56:59], s97 offen sc1
    v_mfma_f32_16x16x32_bf16 v[132:135], v[228:231], a[144:147], v[132:135]
    ds_read_b64_tr_b16 v[212:213], v50 offset:20480
    ds_read_b64_tr_b16 v[214:215], v51 offset:20480
    v_mfma_f32_16x16x32_bf16 v[136:139], v[232:235], a[144:147], v[136:139]
    ds_read_b64_tr_b16 v[216:217], v52 offset:20480
    ds_read_b64_tr_b16 v[218:219], v53 offset:20480
    v_mfma_f32_16x16x32_bf16 v[140:143], v[236:239], a[144:147], v[140:143]
    ds_read_b64_tr_b16 v[220:221], v54 offset:20480
    ds_read_b64_tr_b16 v[222:223], v55 offset:20480
    s_buffer_load_dword s30, s[56:59], s91 offset:0xc glc
    s_waitcnt lgkmcnt(8)
    v_mfma_f32_16x16x32_bf16 v[128:131], v[240:243], a[160:163], v[128:131]
    ds_read_b64_tr_b16 v[224:225], v48 offset:8192
    ds_read_b64_tr_b16 v[226:227], v49 offset:8192
    v_mfma_f32_16x16x32_bf16 v[132:135], v[244:247], a[160:163], v[132:135]
    ds_read_b64_tr_b16 v[228:229], v50 offset:8192
    ds_read_b64_tr_b16 v[230:231], v51 offset:8192
    v_mfma_f32_16x16x32_bf16 v[136:139], v[248:251], a[160:163], v[136:139]
    ds_read_b64_tr_b16 v[232:233], v52 offset:8192
    ds_read_b64_tr_b16 v[234:235], v53 offset:8192
    v_mfma_f32_16x16x32_bf16 v[140:143], v[252:255], a[160:163], v[140:143]
    ds_read_b64_tr_b16 v[236:237], v54 offset:8192
    ds_read_b64_tr_b16 v[238:239], v55 offset:8192
    s_waitcnt lgkmcnt(8)
    v_mfma_f32_16x16x32_bf16 v[128:131], v[208:211], a[176:179], v[128:131]
    ds_read_b64_tr_b16 v[240:241], v48 offset:24576
    ds_read_b64_tr_b16 v[242:243], v49 offset:24576
    v_mfma_f32_16x16x32_bf16 v[132:135], v[212:215], a[176:179], v[132:135]
    ds_read_b64_tr_b16 v[244:245], v50 offset:24576
    ds_read_b64_tr_b16 v[246:247], v51 offset:24576
    v_mfma_f32_16x16x32_bf16 v[136:139], v[216:219], a[176:179], v[136:139]
    ds_read_b64_tr_b16 v[248:249], v52 offset:24576
    ds_read_b64_tr_b16 v[250:251], v53 offset:24576
    v_mfma_f32_16x16x32_bf16 v[140:143], v[220:223], a[176:179], v[140:143]
    ds_read_b64_tr_b16 v[252:253], v54 offset:24576
    ds_read_b64_tr_b16 v[254:255], v55 offset:24576
    s_waitcnt lgkmcnt(8)
    v_mfma_f32_16x16x32_bf16 v[128:131], v[224:227], a[192:195], v[128:131]
    ds_read_b64_tr_b16 v[208:209], v48 offset:12288
    ds_read_b64_tr_b16 v[210:211], v49 offset:12288
    v_mfma_f32_16x16x32_bf16 v[132:135], v[228:231], a[192:195], v[132:135]
    ds_read_b64_tr_b16 v[212:213], v50 offset:12288
    ds_read_b64_tr_b16 v[214:215], v51 offset:12288
    v_mfma_f32_16x16x32_bf16 v[136:139], v[232:235], a[192:195], v[136:139]
    ds_read_b64_tr_b16 v[216:217], v52 offset:12288
    ds_read_b64_tr_b16 v[218:219], v53 offset:12288
    v_mfma_f32_16x16x32_bf16 v[140:143], v[236:239], a[192:195], v[140:143]
    ds_read_b64_tr_b16 v[220:221], v54 offset:12288
    ds_read_b64_tr_b16 v[222:223], v55 offset:12288
    s_waitcnt vmcnt(26)
    s_barrier
    s_waitcnt lgkmcnt(8)
    v_mfma_f32_16x16x32_bf16 v[128:131], v[240:243], a[208:211], v[128:131]
    ds_read_b64_tr_b16 v[224:225], v48 offset:28672
    ds_read_b64_tr_b16 v[226:227], v49 offset:28672
    buffer_load_dwordx4 a[44:47], v16, s[56:59], s42 offen offset:3072
    v_mfma_f32_16x16x32_bf16 v[132:135], v[244:247], a[208:211], v[132:135]
    ds_read_b64_tr_b16 v[228:229], v50 offset:28672
    ds_read_b64_tr_b16 v[230:231], v51 offset:28672
    v_mfma_f32_16x16x32_bf16 v[136:139], v[248:251], a[208:211], v[136:139]
    ds_read_b64_tr_b16 v[232:233], v52 offset:28672
    ds_read_b64_tr_b16 v[234:235], v53 offset:28672
    v_mfma_f32_16x16x32_bf16 v[140:143], v[252:255], a[208:211], v[140:143]
    ds_read_b64_tr_b16 v[236:237], v54 offset:28672
    ds_read_b64_tr_b16 v[238:239], v55 offset:28672
    s_add_u32 s42, s21, 12288
    buffer_load_dwordx4 a[48:51], v16, s[56:59], s42 offen offset:0
    s_waitcnt lgkmcnt(0)
    s_cmp_ge_u32 s30, 12
    s_nop 1
    s_cbranch_scc1 L_pw_fp
    s_mov_b32 s9, 0
    s_nop 0
L_pl_fp:
    s_buffer_load_dword s30, s[56:59], s91 offset:0xc glc
    s_add_u32 s9, s9, 1
    s_waitcnt lgkmcnt(0)
    s_cmp_ge_u32 s30, 12
    s_nop 0
    s_cbranch_scc1 L_pw_fp
    s_cmp_lt_u32 s9, 40000
    s_nop 0
    s_cbranch_scc1 L_pl_fp
    s_nop 0
L_pw_fp:
    s_waitcnt lgkmcnt(8)
    v_mfma_f32_16x16x32_bf16 v[128:131], v[208:211], a[224:227], v[128:131]
    ds_read_b64_tr_b16 v[240:241], v32 offset:0
    ds_read_b64_tr_b16 v[242:243], v33 offset:0
    v_mfma_f32_16x16x32_bf16 v[132:135], v[212:215], a[224:227], v[132:135]
    ds_read_b64_tr_b16 v[244:245], v34 offset:0
    ds_read_b64_tr_b16 v[246:247], v35 offset:0
    s_add_u32 s42, s21, 12288
    buffer_load_dwordx4 a[52:55], v16, s[56:59], s42 offen offset:1024
    v_mfma_f32_16x16x32_bf16 v[136:139], v[216:219], a[224:227], v[136:139]
    ds_read_b64_tr_b16 v[248:249], v36 offset:0
    ds_read_b64_tr_b16 v[250:251], v37 offset:0
    v_mfma_f32_16x16x32_bf16 v[140:143], v[220:223], a[224:227], v[140:143]
    ds_read_b64_tr_b16 v[252:253], v38 offset:0
    ds_read_b64_tr_b16 v[254:255], v39 offset:0
    s_waitcnt lgkmcnt(8)
    v_mfma_f32_16x16x32_bf16 v[128:131], v[224:227], a[240:243], v[128:131]
    ds_read_b64_tr_b16 v[208:209], v32 offset:16384
    ds_read_b64_tr_b16 v[210:211], v33 offset:16384
    v_mfma_f32_16x16x32_bf16 v[132:135], v[228:231], a[240:243], v[132:135]
    ds_read_b64_tr_b16 v[212:213], v34 offset:16384
    ds_read_b64_tr_b16 v[214:215], v35 offset:16384
    buffer_load_dwordx4 a[56:59], v16, s[56:59], s42 offen offset:2048
    v_mfma_f32_16x16x32_bf16 v[136:139], v[232:235], a[240:243], v[136:139]
    ds_read_b64_tr_b16 v[216:217], v36 offset:16384
    ds_read_b64_tr_b16 v[218:219], v37 offset:16384
    v_mfma_f32_16x16x32_bf16 v[140:143], v[236:239], a[240:243], v[140:143]
    ds_read_b64_tr_b16 v[220:221], v38 offset:16384
    ds_read_b64_tr_b16 v[222:223], v39 offset:16384
    s_waitcnt vmcnt(29)
    s_waitcnt lgkmcnt(8)
    v_mfma_f32_16x16x32_bf16 v[144:147], v[240:243], a[0:3], 0
    ds_read_b64_tr_b16 v[224:225], v32 offset:4096
    ds_read_b64_tr_b16 v[226:227], v33 offset:4096
    v_mfma_f32_16x16x32_bf16 v[148:151], v[244:247], a[0:3], 0
    ds_read_b64_tr_b16 v[228:229], v34 offset:4096
    ds_read_b64_tr_b16 v[230:231], v35 offset:4096
    buffer_load_dwordx4 a[60:63], v16, s[56:59], s42 offen offset:3072
    v_mfma_f32_16x16x32_bf16 v[152:155], v[248:251], a[0:3], 0
    ds_read_b64_tr_b16 v[232:233], v36 offset:4096
    ds_read_b64_tr_b16 v[234:235], v37 offset:4096
    v_mfma_f32_16x16x32_bf16 v[156:159], v[252:255], a[0:3], 0
    ds_read_b64_tr_b16 v[236:237], v38 offset:4096
    ds_read_b64_tr_b16 v[238:239], v39 offset:4096
    s_waitcnt vmcnt(25)
    s_waitcnt lgkmcnt(8)
    v_mfma_f32_16x16x32_bf16 v[144:147], v[208:211], a[4:7], v[144:147]
    ds_read_b64_tr_b16 v[240:241], v32 offset:20480
    ds_read_b64_tr_b16 v[242:243], v33 offset:20480
    v_lshlrev_b32 v114, 2, v3
    s_lshl_b32 s42, s17, 6
    v_mfma_f32_16x16x32_bf16 v[148:151], v[212:215], a[4:7], v[148:151]
    ds_read_b64_tr_b16 v[244:245], v34 offset:20480
    ds_read_b64_tr_b16 v[246:247], v35 offset:20480
    s_add_u32 s42, s42, 0x1e0000
    buffer_load_dword v114, v114, s[56:59], s42 offen
    v_mfma_f32_16x16x32_bf16 v[152:155], v[216:219], a[4:7], v[152:155]
    ds_read_b64_tr_b16 v[248:249], v36 offset:20480
    ds_read_b64_tr_b16 v[250:251], v37 offset:20480
    s_add_u32 s42, s34, 0
    buffer_load_dwordx4 v[80:83], v16, s[56:59], s42 offen offset:0 sc1
    v_mfma_f32_16x16x32_bf16 v[156:159], v[220:223], a[4:7], v[156:159]
    ds_read_b64_tr_b16 v[252:253], v38 offset:20480
    ds_read_b64_tr_b16 v[254:255], v39 offset:20480
    s_waitcnt vmcnt(26)
    s_waitcnt lgkmcnt(8)
    v_mfma_f32_16x16x32_bf16 v[144:147], v[224:227], a[8:11], v[144:147]
    ds_read_b64_tr_b16 v[208:209], v32 offset:8192
    ds_read_b64_tr_b16 v[210:211], v33 offset:8192
    v_mfma_f32_16x16x32_bf16 v[148:151], v[228:231], a[8:11], v[148:151]
    ds_read_b64_tr_b16 v[212:213], v34 offset:8192
    ds_read_b64_tr_b16 v[214:215], v35 offset:8192
    buffer_load_dwordx4 v[84:87], v16, s[56:59], s42 offen offset:1024 sc1
    v_mfma_f32_16x16x32_bf16 v[152:155], v[232:235], a[8:11], v[152:155]
    ds_read_b64_tr_b16 v[216:217], v36 offset:8192
    ds_read_b64_tr_b16 v[218:219], v37 offset:8192
    v_mfma_f32_16x16x32_bf16 v[156:159], v[236:239], a[8:11], v[156:159]
    ds_read_b64_tr_b16 v[220:221], v38 offset:8192
    ds_read_b64_tr_b16 v[222:223], v39 offset:8192
    s_waitcnt vmcnt(26)
    s_waitcnt lgkmcnt(8)
    v_mfma_f32_16x16x32_bf16 v[144:147], v[240:243], a[12:15], v[144:147]
    ds_read_b64_tr_b16 v[224:225], v32 offset:24576
    ds_read_b64_tr_b16 v[226:227], v33 offset:24576
    v_mfma_f32_16x16x32_bf16 v[148:151], v[244:247], a[12:15], v[148:151]
    ds_read_b64_tr_b16 v[228:229], v34 offset:24576
    ds_read_b64_tr_b16 v[230:231], v35 offset:24576
    buffer_load_dwordx4 v[88:91], v16, s[56:59], s42 offen offset:2048 sc1
    v_mfma_f32_16x16x32_bf16 v[152:155], v[248:251], a[12:15], v[152:155]
    ds_read_b64_tr_b16 v[232:233], v36 offset:24576
    ds_read_b64_tr_b16 v[234:235], v37 offset:24576
    v_mfma_f32_16x16x32_bf16 v[156:159], v[252:255], a[12:15], v[156:159]
    ds_read_b64_tr_b16 v[236:237], v38 offset:24576
    ds_read_b64_tr_b16 v[238:239], v39 offset:24576
    s_waitcnt vmcnt(26)
    s_waitcnt lgkmcnt(8)
    v_mfma_f32_16x16x32_bf16 v[144:147], v[208:211], a[16:19], v[144:147]
    ds_read_b64_tr_b16 v[240:241], v32 offset:12288
    ds_read_b64_tr_b16 v[242:243], v33 offset:12288
    v_mfma_f32_16x16x32_bf16 v[148:151], v[212:215], a[16:19], v[148:151]
    ds_read_b64_tr_b16 v[244:245], v34 offset:12288
    ds_read_b64_tr_b16 v[246:247], v35 offset:12288
    buffer_load_dwordx4 v[92:95], v16, s[56:59], s42 offen offset:3072 sc1
    v_mfma_f32_16x16x32_bf16 v[152:155], v[216:219], a[16:19], v[152:155]
    ds_read_b64_tr_b16 v[248:249], v36 offset:12288
    ds_read_b64_tr_b16 v[250:251], v37 offset:12288
    v_mfma_f32_16x16x32_bf16 v[156:159], v[220:223], a[16:19], v[156:159]
    ds_read_b64_tr_b16 v[252:253], v38 offset:12288
    ds_read_b64_tr_b16 v[254:255], v39 offset:12288
    s_waitcnt vmcnt(23)
    s_waitcnt lgkmcnt(8)
    v_mfma_f32_16x16x32_bf16 v[144:147], v[224:227], a[20:23], v[144:147]
    ds_read_b64_tr_b16 v[208:209], v32 offset:28672
    ds_read_b64_tr_b16 v[210:211], v33 offset:28672
    v_mfma_f32_16x16x32_bf16 v[148:151], v[228:231], a[20:23], v[148:151]
    ds_read_b64_tr_b16 v[212:213], v34 offset:28672
    ds_read_b64_tr_b16 v[214:215], v35 offset:28672
    s_add_u32 s42, s34, 4096
    buffer_load_dwordx4 v[192:195], v16, s[56:59], s42 offen offset:0 sc1
    v_mfma_f32_16x16x32_bf16 v[152:155], v[232:235], a[20:23], v[152:155]
    ds_read_b64_tr_b16 v[216:217], v36 offset:28672
    ds_read_b64_tr_b16 v[218:219], v37 offset:28672
    v_mfma_f32_16x16x32_bf16 v[156:159], v[236:239], a[20:23], v[156:159]
    ds_read_b64_tr_b16 v[220:221], v38 offset:28672
    ds_read_b64_tr_b16 v[222:223], v39 offset:28672
    s_waitcnt vmcnt(20)
    s_waitcnt lgkmcnt(8)
    v_mfma_f32_16x16x32_bf16 v[144:147], v[240:243], a[24:27], v[144:147]
    ds_read_b64_tr_b16 v[224:225], v40 offset:16384
    ds_read_b64_tr_b16 v[226:227], v41 offset:16384
    buffer_load_dwordx4 v[196:199], v16, s[56:59], s42 offen offset:1024 sc1
    v_mfma_f32_16x16x32_bf16 v[148:151], v[244:247], a[24:27], v[148:151]
    ds_read_b64_tr_b16 v[228:229], v42 offset:16384
    ds_read_b64_tr_b16 v[230:231], v43 offset:16384
    v_mfma_f32_16x16x32_bf16 v[152:155], v[248:251], a[24:27], v[152:155]
    ds_read_b64_tr_b16 v[232:233], v44 offset:16384
    ds_read_b64_tr_b16 v[234:235], v45 offset:16384
    v_mfma_f32_16x16x32_bf16 v[156:159], v[252:255], a[24:27], v[156:159]
    ds_read_b64_tr_b16 v[236:237], v46 offset:16384
    ds_read_b64_tr_b16 v[238:239], v47 offset:16384
    s_waitcnt vmcnt(19)
    s_waitcnt lgkmcnt(8)
    v_mfma_f32_16x16x32_bf16 v[144:147], v[208:211], a[28:31], v[144:147]
    ds_read_b64_tr_b16 v[240:241], v40 offset:32768
    ds_read_b64_tr_b16 v[242:243], v41 offset:32768
    v_mfma_f32_16x16x32_bf16 v[148:151], v[212:215], a[28:31], v[148:151]
    ds_read_b64_tr_b16 v[244:245], v42 offset:32768
    ds_read_b64_tr_b16 v[246:247], v43 offset:32768
    v_mfma_f32_16x16x32_bf16 v[152:155], v[216:219], a[28:31], v[152:155]
    ds_read_b64_tr_b16 v[248:249], v44 offset:32768
    ds_read_b64_tr_b16 v[250:251], v45 offset:32768
    v_mfma_f32_16x16x32_bf16 v[156:159], v[220:223], a[28:31], v[156:159]
    ds_read_b64_tr_b16 v[252:253], v46 offset:32768
    ds_read_b64_tr_b16 v[254:255], v47 offset:32768
    s_waitcnt vmcnt(18)
    s_waitcnt lgkmcnt(8)
    v_mfma_f32_16x16x32_bf16 v[144:147], v[224:227], a[32:35], v[144:147]
    ds_read_b64_tr_b16 v[208:209], v40 offset:20480
    ds_read_b64_tr_b16 v[210:211], v41 offset:20480
    v_mfma_f32_16x16x32_bf16 v[148:151], v[228:231], a[32:35], v[148:151]
    ds_read_b64_tr_b16 v[212:213], v42 offset:20480
    ds_read_b64_tr_b16 v[214:215], v43 offset:20480
    v_mfma_f32_16x16x32_bf16 v[152:155], v[232:235], a[32:35], v[152:155]
    ds_read_b64_tr_b16 v[216:217], v44 offset:20480
    ds_read_b64_tr_b16 v[218:219], v45 offset:20480
    v_mfma_f32_16x16x32_bf16 v[156:159], v[236:239], a[32:35], v[156:159]
    ds_read_b64_tr_b16 v[220:221], v46 offset:20480
    ds_read_b64_tr_b16 v[222:223], v47 offset:20480
    s_waitcnt vmcnt(17)
    s_waitcnt lgkmcnt(8)
    v_mfma_f32_16x16x32_bf16 v[144:147], v[240:243], a[36:39], v[144:147]
    ds_read_b64_tr_b16 v[224:225], v40 offset:36864
    ds_read_b64_tr_b16 v[226:227], v41 offset:36864
    v_mfma_f32_16x16x32_bf16 v[148:151], v[244:247], a[36:39], v[148:151]
    ds_read_b64_tr_b16 v[228:229], v42 offset:36864
    ds_read_b64_tr_b16 v[230:231], v43 offset:36864
    v_mfma_f32_16x16x32_bf16 v[152:155], v[248:251], a[36:39], v[152:155]
    ds_read_b64_tr_b16 v[232:233], v44 offset:36864
    ds_read_b64_tr_b16 v[234:235], v45 offset:36864
    v_mfma_f32_16x16x32_bf16 v[156:159], v[252:255], a[36:39], v[156:159]
    ds_read_b64_tr_b16 v[236:237], v46 offset:36864
    ds_read_b64_tr_b16 v[238:239], v47 offset:36864
    s_waitcnt vmcnt(15)
    s_waitcnt lgkmcnt(8)
    v_mfma_f32_16x16x32_bf16 v[144:147], v[208:211], a[40:43], v[144:147]
    ds_read_b64_tr_b16 v[240:241], v40 offset:24576
    ds_read_b64_tr_b16 v[242:243], v41 offset:24576
    buffer_load_dwordx4 v[200:203], v16, s[56:59], s42 offen offset:2048 sc1
    v_mfma_f32_16x16x32_bf16 v[148:151], v[212:215], a[40:43], v[148:151]
    ds_read_b64_tr_b16 v[244:245], v42 offset:24576
    ds_read_b64_tr_b16 v[246:247], v43 offset:24576
    v_mfma_f32_16x16x32_bf16 v[152:155], v[216:219], a[40:43], v[152:155]
    ds_read_b64_tr_b16 v[248:249], v44 offset:24576
    ds_read_b64_tr_b16 v[250:251], v45 offset:24576
    v_mfma_f32_16x16x32_bf16 v[156:159], v[220:223], a[40:43], v[156:159]
    ds_read_b64_tr_b16 v[252:253], v46 offset:24576
    ds_read_b64_tr_b16 v[254:255], v47 offset:24576
    s_waitcnt vmcnt(12)
    s_waitcnt lgkmcnt(8)
    v_mfma_f32_16x16x32_bf16 v[144:147], v[224:227], a[44:47], v[144:147]
    ds_read_b64_tr_b16 v[208:209], v40 offset:40960
    ds_read_b64_tr_b16 v[210:211], v41 offset:40960
    buffer_load_dwordx4 v[204:207], v16, s[56:59], s42 offen offset:3072 sc1
    v_mfma_f32_16x16x32_bf16 v[148:151], v[228:231], a[44:47], v[148:151]
    ds_read_b64_tr_b16 v[212:213], v42 offset:40960
    ds_read_b64_tr_b16 v[214:215], v43 offset:40960
    v_mfma_f32_16x16x32_bf16 v[152:155], v[232:235], a[44:47], v[152:155]
    ds_read_b64_tr_b16 v[216:217], v44 offset:40960
    ds_read_b64_tr_b16 v[218:219], v45 offset:40960
    v_mfma_f32_16x16x32_bf16 v[156:159], v[236:239], a[44:47], v[156:159]
    ds_read_b64_tr_b16 v[220:221], v46 offset:40960
    ds_read_b64_tr_b16 v[222:223], v47 offset:40960
    s_waitcnt vmcnt(12)
    s_waitcnt lgkmcnt(8)
    v_mfma_f32_16x16x32_bf16 v[144:147], v[240:243], a[48:51], v[144:147]
    ds_read_b64_tr_b16 v[224:225], v40 offset:28672
    ds_read_b64_tr_b16 v[226:227], v41 offset:28672
    s_add_u32 s42, s34, 8192
    buffer_load_dwordx4 v[64:67], v16, s[56:59], s42 offen offset:0 sc1
    v_mfma_f32_16x16x32_bf16 v[148:151], v[244:247], a[48:51], v[148:151]
    ds_read_b64_tr_b16 v[228:229], v42 offset:28672
    ds_read_b64_tr_b16 v[230:231], v43 offset:28672
    v_mfma_f32_16x16x32_bf16 v[152:155], v[248:251], a[48:51], v[152:155]
    ds_read_b64_tr_b16 v[232:233], v44 offset:28672
    ds_read_b64_tr_b16 v[234:235], v45 offset:28672
    v_mfma_f32_16x16x32_bf16 v[156:159], v[252:255], a[48:51], v[156:159]
    ds_read_b64_tr_b16 v[236:237], v46 offset:28672
    ds_read_b64_tr_b16 v[238:239], v47 offset:28672
    s_waitcnt vmcnt(12)
    s_waitcnt lgkmcnt(8)
    v_mfma_f32_16x16x32_bf16 v[144:147], v[208:211], a[52:55], v[144:147]
L_hop7:
    s_cbranch_execz L_hret3
    ds_read_b64_tr_b16 v[240:241], v40 offset:45056
    ds_read_b64_tr_b16 v[242:243], v41 offset:45056
    buffer_load_dwordx4 v[68:71], v16, s[56:59], s42 offen offset:1024 sc1
    v_mfma_f32_16x16x32_bf16 v[148:151], v[212:215], a[52:55], v[148:151]
    ds_read_b64_tr_b16 v[244:245], v42 offset:45056
    ds_read_b64_tr_b16 v[246:247], v43 offset:45056
    v_mfma_f32_16x16x32_bf16 v[152:155], v[216:219], a[52:55], v[152:155]
    ds_read_b64_tr_b16 v[248:249], v44 offset:45056
    ds_read_b64_tr_b16 v[250:251], v45 offset:45056
    v_mfma_f32_16x16x32_bf16 v[156:159], v[220:223], a[52:55], v[156:159]
    ds_read_b64_tr_b16 v[252:253], v46 offset:45056
    ds_read_b64_tr_b16 v[254:255], v47 offset:45056
    s_waitcnt vmcnt(12)
    s_waitcnt lgkmcnt(8)
    v_mfma_f32_16x16x32_bf16 v[144:147], v[224:227], a[56:59], v[144:147]
    buffer_load_dwordx4 v[72:75], v16, s[56:59], s42 offen offset:2048 sc1
    buffer_load_dwordx4 v[76:79], v16, s[56:59], s42 offen offset:3072 sc1
    v_mfma_f32_16x16x32_bf16 v[148:151], v[228:231], a[56:59], v[148:151]
    v_mfma_f32_16x16x32_bf16 v[152:155], v[232:235], a[56:59], v[152:155]
    v_mfma_f32_16x16x32_bf16 v[156:159], v[236:239], a[56:59], v[156:159]
    s_waitcnt vmcnt(13)
    s_waitcnt lgkmcnt(0)
    v_mfma_f32_16x16x32_bf16 v[144:147], v[240:243], a[60:63], v[144:147]
    v_mfma_f32_16x16x32_bf16 v[148:151], v[244:247], a[60:63], v[148:151]
    v_mfma_f32_16x16x32_bf16 v[152:155], v[248:251], a[60:63], v[152:155]
    v_mfma_f32_16x16x32_bf16 v[156:159], v[252:255], a[60:63], v[156:159]
    s_mov_b32 s44, s36
    s_and_b32 s45, s37, 0xffff
    s_mov_b32 s46, 0x1c0000
    s_mov_b32 s47, 0x00020000
    v_mul_u32_u24 v12, 896, v3
    v_lshl_add_u32 v12, v2, 4, v12
    v_and_b32 v13, 1, v2
    v_lshl_add_u32 v12, v13, 3, v12
    v_xor_b32 v13, 8, v12
    s_waitcnt vmcnt(6)
    v_mfma_f32_16x16x32_bf16 v[128:131], v[106:109], v[80:83], v[128:131]
    v_mfma_f32_16x16x32_bf16 v[132:135], v[110:113], v[80:83], v[132:135]
    v_mfma_f32_16x16x32_bf16 v[136:139], v[106:109], v[84:87], v[136:139]
    v_mfma_f32_16x16x32_bf16 v[140:143], v[110:113], v[84:87], v[140:143]
    v_mfma_f32_16x16x32_bf16 v[128:131], v[106:109], v[88:91], v[128:131]
    v_mfma_f32_16x16x32_bf16 v[132:135], v[110:113], v[88:91], v[132:135]
    v_mfma_f32_16x16x32_bf16 v[136:139], v[106:109], v[92:95], v[136:139]
    v_mfma_f32_16x16x32_bf16 v[140:143], v[110:113], v[92:95], v[140:143]
    v_mfma_f32_16x16x32_bf16 v[128:131], v[106:109], v[192:195], v[128:131]
    v_mfma_f32_16x16x32_bf16 v[132:135], v[110:113], v[192:195], v[132:135]
    v_mfma_f32_16x16x32_bf16 v[136:139], v[106:109], v[196:199], v[136:139]
    v_mfma_f32_16x16x32_bf16 v[140:143], v[110:113], v[196:199], v[140:143]
    s_waitcnt vmcnt(0)
    s_mov_b32 s9, 0
    s_nop 5
L_ck_b:
    v_max3_u32 v8, v200, v201, v202
    v_max3_u32 v9, v206, v207, v64
    v_max3_u32 v10, v68, v69, v70
    v_max3_u32 v11, v74, v75, v76
    v_max3_u32 v8, v8, v203, v204
    v_max3_u32 v9, v9, v65, v66
    v_max3_u32 v10, v10, v71, v72
    v_max3_u32 v11, v11, v77, v78
    v_max_u32 v8, v8, v205
    v_max_u32 v9, v9, v67
    v_max_u32 v10, v10, v73
    v_max_u32 v11, v11, v79
    v_max3_u32 v8, v8, v9, v10
    v_max_u32 v8, v8, v11
    v_cmp_eq_u32 vcc, -1, v8
    s_nop 4
    s_cbranch_vccz L_ok_b
    s_add_u32 s42, s34, 4096
    buffer_load_dwordx4 v[200:203], v16, s[56:59], s42 offen offset:2048 sc1
    s_add_u32 s42, s34, 4096
    buffer_load_dwordx4 v[204:207], v16, s[56:59], s42 offen offset:3072 sc1
    s_add_u32 s42, s34, 8192
    buffer_load_dwordx4 v[64:67], v16, s[56:59], s42 offen offset:0 sc1
    s_add_u32 s42, s34, 8192
    buffer_load_dwordx4 v[68:71], v16, s[56:59], s42 offen offset:1024 sc1
    s_add_u32 s42, s34, 8192
    buffer_load_dwordx4 v[72:75], v16, s[56:59], s42 offen offset:2048 sc1
    s_add_u32 s42, s34, 8192
    buffer_load_dwordx4 v[76:79], v16, s[56:59], s42 offen offset:3072 sc1
    s_add_u32 s9, s9, 1
    s_waitcnt vmcnt(0)
    s_cmp_lt_u32 s9, 20000
    s_nop 0
    s_cbranch_scc1 L_ck_b
    s_nop 0
L_ok_b:
    v_mfma_f32_16x16x32_bf16 v[128:131], v[106:109], v[200:203], v[128:131]
    v_mfma_f32_16x16x32_bf16 v[132:135], v[110:113], v[200:203], v[132:135]
    v_mfma_f32_16x16x32_bf16 v[136:139], v[106:109], v[204:207], v[136:139]
    v_mfma_f32_16x16x32_bf16 v[140:143], v[110:113], v[204:207], v[140:143]
    v_mfma_f32_16x16x32_bf16 v[128:131], v[106:109], v[64:67], v[128:131]
    v_mfma_f32_16x16x32_bf16 v[132:135], v[110:113], v[64:67], v[132:135]
    v_mfma_f32_16x16x32_bf16 v[136:139], v[106:109], v[68:71], v[136:139]
    v_mfma_f32_16x16x32_bf16 v[140:143], v[110:113], v[68:71], v[140:143]
    v_mfma_f32_16x16x32_bf16 v[128:131], v[106:109], v[72:75], v[128:131]
    v_mfma_f32_16x16x32_bf16 v[132:135], v[110:113], v[72:75], v[132:135]
    v_mfma_f32_16x16x32_bf16 v[136:139], v[106:109], v[76:79], v[136:139]
    v_mfma_f32_16x16x32_bf16 v[140:143], v[110:113], v[76:79], v[140:143]
    s_nop 4
    v_pk_add_f32 v[144:145], v[144:145], v[128:129] neg_lo:[0,1] neg_hi:[0,1]
    v_pk_add_f32 v[146:147], v[146:147], v[130:131] neg_lo:[0,1] neg_hi:[0,1]
    v_pk_add_f32 v[148:149], v[148:149], v[132:133] neg_lo:[0,1] neg_hi:[0,1]
    v_pk_add_f32 v[150:151], v[150:151], v[134:135] neg_lo:[0,1] neg_hi:[0,1]
    v_pk_add_f32 v[152:153], v[152:153], v[136:137] neg_lo:[0,1] neg_hi:[0,1]
    v_pk_add_f32 v[154:155], v[154:155], v[138:139] neg_lo:[0,1] neg_hi:[0,1]
    v_pk_add_f32 v[156:157], v[156:157], v[140:141] neg_lo:[0,1] neg_hi:[0,1]
    v_pk_add_f32 v[158:159], v[158:159], v[142:143] neg_lo:[0,1] neg_hi:[0,1]
    v_pk_fma_f32 v[144:145], v[144:145], v[114:115], v[128:129] op_sel_hi:[1,0,1]
    v_pk_fma_f32 v[146:147], v[146:147], v[114:115], v[130:131] op_sel_hi:[1,0,1]
    v_pk_fma_f32 v[148:149], v[148:149], v[114:115], v[132:133] op_sel_hi:[1,0,1]
    v_pk_fma_f32 v[150:151], v[150:151], v[114:115], v[134:135] op_sel_hi:[1,0,1]
    v_pk_fma_f32 v[152:153], v[152:153], v[114:115], v[136:137] op_sel_hi:[1,0,1]
    v_pk_fma_f32 v[154:155], v[154:155], v[114:115], v[138:139] op_sel_hi:[1,0,1]
    v_pk_fma_f32 v[156:157], v[156:157], v[114:115], v[140:141] op_sel_hi:[1,0,1]
    v_pk_fma_f32 v[158:159], v[158:159], v[114:115], v[142:143] op_sel_hi:[1,0,1]
    v_cvt_pk_bf16_f32 v64, v144, v145
    v_cvt_pk_bf16_f32 v65, v146, v147
    buffer_store_dwordx2 v[64:65], v12, s[44:47], s95 offen offset:0
    v_cvt_pk_bf16_f32 v66, v148, v149
    v_cvt_pk_bf16_f32 v67, v150, v151
    buffer_store_dwordx2 v[66:67], v13, s[44:47], s95 offen offset:0
    v_cvt_pk_bf16_f32 v68, v152, v153
    v_cvt_pk_bf16_f32 v69, v154, v155
    buffer_store_dwordx2 v[68:69], v12, s[44:47], s95 offen offset:64
    v_cvt_pk_bf16_f32 v70, v156, v157
    v_cvt_pk_bf16_f32 v71, v158, v159
    buffer_store_dwordx2 v[70:71], v13, s[44:47], s95 offen offset:64
    s_nop 3
    s_branch L_end
    s_nop 0
L_p2redo:
    s_mov_b32 s9, 0
    s_nop 0
L_p2redo1:
    s_mul_i32 s6, s17, 14336
    v_lshl_add_u32 v10, v2, 8, s6
    v_cmp_le_u32 vcc, 2, v2
    v_add_u32 v5, -1, v3
    v_ashrrev_i32 v6, 4, v5
    v_and_b32 v5, 15, v5
    v_mul_i32_i24 v6, 14336, v6
    v_lshl_add_u32 v5, v5, 4, v6
    v_add_u32 v5, v5, v10
    v_add_u32 v128, 0, v5
    v_add_u32 v129, 1024, v5
    v_add_u32 v130, 2048, v5
    v_cndmask_b32 v5, -1, 1, vcc
    v_add_u32 v5, v5, v3
    v_ashrrev_i32 v6, 4, v5
    v_and_b32 v5, 15, v5
    v_mul_i32_i24 v6, 14336, v6
    v_lshl_add_u32 v5, v5, 4, v6
    v_add_u32 v5, v5, v10
    v_add_u32 v131, 3072, v5
    v_add_u32 v5, 1, v3
    v_ashrrev_i32 v6, 4, v5
    v_and_b32 v5, 15, v5
    v_mul_i32_i24 v6, 14336, v6
    v_lshl_add_u32 v5, v5, 4, v6
    v_add_u32 v5, v5, v10
    v_add_u32 v132, 4096, v5
    v_add_u32 v133, 5120, v5
    v_add_u32 v134, 6144, v5
    v_add_u32 v5, -2, v3
    v_ashrrev_i32 v6, 4, v5
    v_and_b32 v5, 15, v5
    v_mul_i32_i24 v6, 14336, v6
    v_lshl_add_u32 v5, v5, 4, v6
    v_add_u32 v5, v5, v10
    v_add_u32 v135, 7168, v5
    v_add_u32 v136, 8192, v5
    v_add_u32 v137, 9216, v5
    v_cndmask_b32 v5, -2, 2, vcc
    v_add_u32 v5, v5, v3
    v_ashrrev_i32 v6, 4, v5
    v_and_b32 v5, 15, v5
    v_mul_i32_i24 v6, 14336, v6
    v_lshl_add_u32 v5, v5, 4, v6
    v_add_u32 v5, v5, v10
    v_add_u32 v138, 10240, v5
    v_add_u32 v5, 2, v3
    v_ashrrev_i32 v6, 4, v5
    v_and_b32 v5, 15, v5
    v_mul_i32_i24 v6, 14336, v6
    v_lshl_add_u32 v5, v5, 4, v6
    v_add_u32 v5, v5, v10
    v_add_u32 v139, 11264, v5
    v_add_u32 v140, 12288, v5
    v_add_u32 v141, 13312, v5
    buffer_load_dwordx4 a[112:115], v128, s[48:51], 0 offen sc1
    buffer_load_dwordx4 a[116:119], v129, s[48:51], 0 offen sc1
    buffer_load_dwordx4 a[120:123], v130, s[48:51], 0 offen sc1
    buffer_load_dwordx4 a[124:127], v131, s[48:51], 0 offen sc1
    buffer_load_dwordx4 a[128:131], v132, s[48:51], 0 offen sc1
    buffer_load_dwordx4 a[132:135], v133, s[48:51], 0 offen sc1
    buffer_load_dwordx4 a[136:139], v134, s[48:51], 0 offen sc1
    buffer_load_dwordx4 a[140:143], v135, s[48:51], 0 offen sc1
    buffer_load_dwordx4 a[144:147], v136, s[48:51], 0 offen sc1
    buffer_load_dwordx4 a[148:151], v137, s[48:51], 0 offen sc1
    buffer_load_dwordx4 a[152:155], v138, s[48:51], 0 offen sc1
    buffer_load_dwordx4 a[156:159], v139, s[48:51], 0 offen sc1
    buffer_load_dwordx4 a[160:163], v140, s[48:51], 0 offen sc1
    buffer_load_dwordx4 a[164:167], v141, s[48:51], 0 offen sc1
    s_add_u32 s9, s9, 1
    s_waitcnt vmcnt(0)
    ds_read_b64_tr_b16 v[64:65], v32 offset:0
    ds_read_b64_tr_b16 v[66:67], v33 offset:0
    ds_read_b64_tr_b16 v[68:69], v34 offset:0
    ds_read_b64_tr_b16 v[70:71], v35 offset:0
    ds_read_b64_tr_b16 v[72:73], v36 offset:0
    ds_read_b64_tr_b16 v[74:75], v37 offset:0
    ds_read_b64_tr_b16 v[76:77], v38 offset:0
    ds_read_b64_tr_b16 v[78:79], v39 offset:0
    s_waitcnt lgkmcnt(0)
    v_mfma_f32_16x16x32_bf16 v[128:131], v[64:67], a[112:115], 0
    v_mfma_f32_16x16x32_bf16 v[132:135], v[68:71], a[112:115], 0
    v_mfma_f32_16x16x32_bf16 v[136:139], v[72:75], a[112:115], 0
    v_mfma_f32_16x16x32_bf16 v[140:143], v[76:79], a[112:115], 0
    ds_read_b64_tr_b16 v[80:81], v32 offset:4096
    ds_read_b64_tr_b16 v[82:83], v33 offset:4096
    ds_read_b64_tr_b16 v[84:85], v34 offset:4096
    ds_read_b64_tr_b16 v[86:87], v35 offset:4096
    ds_read_b64_tr_b16 v[88:89], v36 offset:4096
    ds_read_b64_tr_b16 v[90:91], v37 offset:4096
    ds_read_b64_tr_b16 v[92:93], v38 offset:4096
    ds_read_b64_tr_b16 v[94:95], v39 offset:4096
    s_waitcnt lgkmcnt(0)
    v_mfma_f32_16x16x32_bf16 v[128:131], v[80:83], a[116:119], v[128:131]
    v_mfma_f32_16x16x32_bf16 v[132:135], v[84:87], a[116:119], v[132:135]
    v_mfma_f32_16x16x32_bf16 v[136:139], v[88:91], a[116:119], v[136:139]
    v_mfma_f32_16x16x32_bf16 v[140:143], v[92:95], a[116:119], v[140:143]
    ds_read_b64_tr_b16 v[64:65], v32 offset:8192
    ds_read_b64_tr_b16 v[66:67], v33 offset:8192
    ds_read_b64_tr_b16 v[68:69], v34 offset:8192
    ds_read_b64_tr_b16 v[70:71], v35 offset:8192
    ds_read_b64_tr_b16 v[72:73], v36 offset:8192
    ds_read_b64_tr_b16 v[74:75], v37 offset:8192
    ds_read_b64_tr_b16 v[76:77], v38 offset:8192
    ds_read_b64_tr_b16 v[78:79], v39 offset:8192
    s_waitcnt lgkmcnt(0)
    v_mfma_f32_16x16x32_bf16 v[128:131], v[64:67], a[120:123], v[128:131]
    v_mfma_f32_16x16x32_bf16 v[132:135], v[68:71], a[120:123], v[132:135]
    v_mfma_f32_16x16x32_bf16 v[136:139], v[72:75], a[120:123], v[136:139]
    v_mfma_f32_16x16x32_bf16 v[140:143], v[76:79], a[120:123], v[140:143]
    ds_read_b64_tr_b16 v[80:81], v32 offset:12288
    ds_read_b64_tr_b16 v[82:83], v33 offset:12288
    ds_read_b64_tr_b16 v[84:85], v34 offset:12288
    ds_read_b64_tr_b16 v[86:87], v35 offset:12288
    ds_read_b64_tr_b16 v[88:89], v36 offset:12288
    ds_read_b64_tr_b16 v[90:91], v37 offset:12288
    ds_read_b64_tr_b16 v[92:93], v38 offset:12288
    ds_read_b64_tr_b16 v[94:95], v39 offset:12288
    s_waitcnt lgkmcnt(0)
    v_mfma_f32_16x16x32_bf16 v[128:131], v[80:83], a[124:127], v[128:131]
    v_mfma_f32_16x16x32_bf16 v[132:135], v[84:87], a[124:127], v[132:135]
    v_mfma_f32_16x16x32_bf16 v[136:139], v[88:91], a[124:127], v[136:139]
    v_mfma_f32_16x16x32_bf16 v[140:143], v[92:95], a[124:127], v[140:143]
    ds_read_b64_tr_b16 v[64:65], v32 offset:16384
    ds_read_b64_tr_b16 v[66:67], v33 offset:16384
    ds_read_b64_tr_b16 v[68:69], v34 offset:16384
    ds_read_b64_tr_b16 v[70:71], v35 offset:16384
    ds_read_b64_tr_b16 v[72:73], v36 offset:16384
    ds_read_b64_tr_b16 v[74:75], v37 offset:16384
    ds_read_b64_tr_b16 v[76:77], v38 offset:16384
    ds_read_b64_tr_b16 v[78:79], v39 offset:16384
    s_waitcnt lgkmcnt(0)
    v_mfma_f32_16x16x32_bf16 v[128:131], v[64:67], a[128:131], v[128:131]
    v_mfma_f32_16x16x32_bf16 v[132:135], v[68:71], a[128:131], v[132:135]
    v_mfma_f32_16x16x32_bf16 v[136:139], v[72:75], a[128:131], v[136:139]
    v_mfma_f32_16x16x32_bf16 v[140:143], v[76:79], a[128:131], v[140:143]
    ds_read_b64_tr_b16 v[80:81], v32 offset:20480
    ds_read_b64_tr_b16 v[82:83], v33 offset:20480
    ds_read_b64_tr_b16 v[84:85], v34 offset:20480
    ds_read_b64_tr_b16 v[86:87], v35 offset:20480
    ds_read_b64_tr_b16 v[88:89], v36 offset:20480
    ds_read_b64_tr_b16 v[90:91], v37 offset:20480
    ds_read_b64_tr_b16 v[92:93], v38 offset:20480
    ds_read_b64_tr_b16 v[94:95], v39 offset:20480
    s_waitcnt lgkmcnt(0)
    v_mfma_f32_16x16x32_bf16 v[128:131], v[80:83], a[132:135], v[128:131]
    v_mfma_f32_16x16x32_bf16 v[132:135], v[84:87], a[132:135], v[132:135]
    v_mfma_f32_16x16x32_bf16 v[136:139], v[88:91], a[132:135], v[136:139]
    v_mfma_f32_16x16x32_bf16 v[140:143], v[92:95], a[132:135], v[140:143]
    ds_read_b64_tr_b16 v[64:65], v32 offset:24576
    ds_read_b64_tr_b16 v[66:67], v33 offset:24576
    ds_read_b64_tr_b16 v[68:69], v34 offset:24576
    ds_read_b64_tr_b16 v[70:71], v35 offset:24576
    ds_read_b64_tr_b16 v[72:73], v36 offset:24576
    ds_read_b64_tr_b16 v[74:75], v37 offset:24576
    ds_read_b64_tr_b16 v[76:77], v38 offset:24576
    ds_read_b64_tr_b16 v[78:79], v39 offset:24576
    s_waitcnt lgkmcnt(0)
    v_mfma_f32_16x16x32_bf16 v[128:131], v[64:67], a[136:139], v[128:131]
    v_mfma_f32_16x16x32_bf16 v[132:135], v[68:71], a[136:139], v[132:135]
    v_mfma_f32_16x16x32_bf16 v[136:139], v[72:75], a[136:139], v[136:139]
    v_mfma_f32_16x16x32_bf16 v[140:143], v[76:79], a[136:139], v[140:143]
    ds_read_b64_tr_b16 v[80:81], v40 offset:20480
    ds_read_b64_tr_b16 v[82:83], v41 offset:20480
    ds_read_b64_tr_b16 v[84:85], v42 offset:20480
    ds_read_b64_tr_b16 v[86:87], v43 offset:20480
    ds_read_b64_tr_b16 v[88:89], v44 offset:20480
    ds_read_b64_tr_b16 v[90:91], v45 offset:20480
    ds_read_b64_tr_b16 v[92:93], v46 offset:20480
    ds_read_b64_tr_b16 v[94:95], v47 offset:20480
    s_waitcnt lgkmcnt(0)
    v_mfma_f32_16x16x32_bf16 v[128:131], v[80:83], a[140:143], v[128:131]
    v_mfma_f32_16x16x32_bf16 v[132:135], v[84:87], a[140:143], v[132:135]
    v_mfma_f32_16x16x32_bf16 v[136:139], v[88:91], a[140:143], v[136:139]
    v_mfma_f32_16x16x32_bf16 v[140:143], v[92:95], a[140:143], v[140:143]
    ds_read_b64_tr_b16 v[64:65], v40 offset:24576
    ds_read_b64_tr_b16 v[66:67], v41 offset:24576
    ds_read_b64_tr_b16 v[68:69], v42 offset:24576
    ds_read_b64_tr_b16 v[70:71], v43 offset:24576
    ds_read_b64_tr_b16 v[72:73], v44 offset:24576
    ds_read_b64_tr_b16 v[74:75], v45 offset:24576
    ds_read_b64_tr_b16 v[76:77], v46 offset:24576
    ds_read_b64_tr_b16 v[78:79], v47 offset:24576
    s_waitcnt lgkmcnt(0)
    v_mfma_f32_16x16x32_bf16 v[128:131], v[64:67], a[144:147], v[128:131]
    v_mfma_f32_16x16x32_bf16 v[132:135], v[68:71], a[144:147], v[132:135]
    v_mfma_f32_16x16x32_bf16 v[136:139], v[72:75], a[144:147], v[136:139]
    v_mfma_f32_16x16x32_bf16 v[140:143], v[76:79], a[144:147], v[140:143]
    ds_read_b64_tr_b16 v[80:81], v40 offset:28672
    ds_read_b64_tr_b16 v[82:83], v41 offset:28672
    ds_read_b64_tr_b16 v[84:85], v42 offset:28672
    ds_read_b64_tr_b16 v[86:87], v43 offset:28672
    ds_read_b64_tr_b16 v[88:89], v44 offset:28672
    ds_read_b64_tr_b16 v[90:91], v45 offset:28672
    ds_read_b64_tr_b16 v[92:93], v46 offset:28672
    ds_read_b64_tr_b16 v[94:95], v47 offset:28672
    s_waitcnt lgkmcnt(0)
    v_mfma_f32_16x16x32_bf16 v[128:131], v[80:83], a[148:151], v[128:131]
    v_mfma_f32_16x16x32_bf16 v[132:135], v[84:87], a[148:151], v[132:135]
    v_mfma_f32_16x16x32_bf16 v[136:139], v[88:91], a[148:151], v[136:139]
    v_mfma_f32_16x16x32_bf16 v[140:143], v[92:95], a[148:151], v[140:143]
    ds_read_b64_tr_b16 v[64:65], v40 offset:32768
    ds_read_b64_tr_b16 v[66:67], v41 offset:32768
    ds_read_b64_tr_b16 v[68:69], v42 offset:32768
    ds_read_b64_tr_b16 v[70:71], v43 offset:32768
    ds_read_b64_tr_b16 v[72:73], v44 offset:32768
    ds_read_b64_tr_b16 v[74:75], v45 offset:32768
    ds_read_b64_tr_b16 v[76:77], v46 offset:32768
    ds_read_b64_tr_b16 v[78:79], v47 offset:32768
    s_waitcnt lgkmcnt(0)
    v_mfma_f32_16x16x32_bf16 v[128:131], v[64:67], a[152:155], v[128:131]
    v_mfma_f32_16x16x32_bf16 v[132:135], v[68:71], a[152:155], v[132:135]
    v_mfma_f32_16x16x32_bf16 v[136:139], v[72:75], a[152:155], v[136:139]
    v_mfma_f32_16x16x32_bf16 v[140:143], v[76:79], a[152:155], v[140:143]
    ds_read_b64_tr_b16 v[80:81], v40 offset:36864
    ds_read_b64_tr_b16 v[82:83], v41 offset:36864
    ds_read_b64_tr_b16 v[84:85], v42 offset:36864
    ds_read_b64_tr_b16 v[86:87], v43 offset:36864
    ds_read_b64_tr_b16 v[88:89], v44 offset:36864
    ds_read_b64_tr_b16 v[90:91], v45 offset:36864
    ds_read_b64_tr_b16 v[92:93], v46 offset:36864
    ds_read_b64_tr_b16 v[94:95], v47 offset:36864
    s_waitcnt lgkmcnt(0)
    v_mfma_f32_16x16x32_bf16 v[128:131], v[80:83], a[156:159], v[128:131]
    v_mfma_f32_16x16x32_bf16 v[132:135], v[84:87], a[156:159], v[132:135]
    v_mfma_f32_16x16x32_bf16 v[136:139], v[88:91], a[156:159], v[136:139]
    v_mfma_f32_16x16x32_bf16 v[140:143], v[92:95], a[156:159], v[140:143]
    ds_read_b64_tr_b16 v[64:65], v40 offset:40960
    ds_read_b64_tr_b16 v[66:67], v41 offset:40960
    ds_read_b64_tr_b16 v[68:69], v42 offset:40960
    ds_read_b64_tr_b16 v[70:71], v43 offset:40960
    ds_read_b64_tr_b16 v[72:73], v44 offset:40960
    ds_read_b64_tr_b16 v[74:75], v45 offset:40960
    ds_read_b64_tr_b16 v[76:77], v46 offset:40960
    ds_read_b64_tr_b16 v[78:79], v47 offset:40960
    s_waitcnt lgkmcnt(0)
    v_mfma_f32_16x16x32_bf16 v[128:131], v[64:67], a[160:163], v[128:131]
    v_mfma_f32_16x16x32_bf16 v[132:135], v[68:71], a[160:163], v[132:135]
    v_mfma_f32_16x16x32_bf16 v[136:139], v[72:75], a[160:163], v[136:139]
    v_mfma_f32_16x16x32_bf16 v[140:143], v[76:79], a[160:163], v[140:143]
    ds_read_b64_tr_b16 v[80:81], v40 offset:45056
    ds_read_b64_tr_b16 v[82:83], v41 offset:45056
    ds_read_b64_tr_b16 v[84:85], v42 offset:45056
    ds_read_b64_tr_b16 v[86:87], v43 offset:45056
    ds_read_b64_tr_b16 v[88:89], v44 offset:45056
    ds_read_b64_tr_b16 v[90:91], v45 offset:45056
    ds_read_b64_tr_b16 v[92:93], v46 offset:45056
    ds_read_b64_tr_b16 v[94:95], v47 offset:45056
    s_waitcnt lgkmcnt(0)
    v_mfma_f32_16x16x32_bf16 v[128:131], v[80:83], a[164:167], v[128:131]
    v_mfma_f32_16x16x32_bf16 v[132:135], v[84:87], a[164:167], v[132:135]
    v_mfma_f32_16x16x32_bf16 v[136:139], v[88:91], a[164:167], v[136:139]
    v_mfma_f32_16x16x32_bf16 v[140:143], v[92:95], a[164:167], v[140:143]
    s_nop 4
    v_cmp_u_f32 vcc, v128, v128
    s_nop 4
    s_cbranch_vccz L_p2ok
    s_cmp_lt_u32 s9, 300
    s_nop 0
    s_cbranch_scc1 L_p2redo1
    s_nop 0
    s_branch L_p2ok
    s_nop 0
L_x1redo:
    s_mov_b32 s9, 0
    s_nop 0
L_x1redo1:
    s_add_u32 m0, s19, 0
    s_add_u32 s42, s18, 0
    buffer_load_dwordx4 v16, s[56:59], s42 offen offset:0 sc1 lds
    s_add_u32 m0, s19, 0
    s_add_u32 s42, s18, 0
    buffer_load_dwordx4 v16, s[56:59], s42 offen offset:1024 sc1 lds
    s_add_u32 m0, s19, 0
    s_add_u32 s42, s18, 0
    buffer_load_dwordx4 v16, s[56:59], s42 offen offset:2048 sc1 lds
    s_add_u32 m0, s19, 0
    s_add_u32 s42, s18, 0
    buffer_load_dwordx4 v16, s[56:59], s42 offen offset:3072 sc1 lds
    s_add_u32 m0, s19, 4096
    s_add_u32 s42, s18, 4096
    buffer_load_dwordx4 v16, s[56:59], s42 offen offset:0 sc1 lds
    s_add_u32 m0, s19, 4096
    s_add_u32 s42, s18, 4096
    buffer_load_dwordx4 v16, s[56:59], s42 offen offset:1024 sc1 lds
    s_add_u32 m0, s19, 4096
    s_add_u32 s42, s18, 4096
    buffer_load_dwordx4 v16, s[56:59], s42 offen offset:2048 sc1 lds
    s_add_u32 m0, s19, 86016
    s_add_u32 s42, s18, 7168
    buffer_load_dwordx4 v16, s[56:59], s42 offen offset:0 sc1 lds
    s_add_u32 m0, s19, 86016
    s_add_u32 s42, s18, 7168
    buffer_load_dwordx4 v16, s[56:59], s42 offen offset:1024 sc1 lds
    s_add_u32 m0, s19, 86016
    s_add_u32 s42, s18, 7168
    buffer_load_dwordx4 v16, s[56:59], s42 offen offset:2048 sc1 lds
    s_add_u32 m0, s19, 86016
    s_add_u32 s42, s18, 7168
    buffer_load_dwordx4 v16, s[56:59], s42 offen offset:3072 sc1 lds
    s_add_u32 m0, s19, 90112
    s_add_u32 s42, s18, 11264
    buffer_load_dwordx4 v16, s[56:59], s42 offen offset:0 sc1 lds
    s_add_u32 m0, s19, 90112
    s_add_u32 s42, s18, 11264
    buffer_load_dwordx4 v16, s[56:59], s42 offen offset:1024 sc1 lds
    s_add_u32 m0, s19, 90112
    s_add_u32 s42, s18, 11264
    buffer_load_dwordx4 v16, s[56:59], s42 offen offset:2048 sc1 lds
    s_add_u32 s9, s9, 1
    s_waitcnt vmcnt(0)
    ds_read2st64_b32 v[64:65], v4 offset0:0 offset1:8
    ds_read2st64_b32 v[66:67], v4 offset0:16 offset1:20
    ds_read2st64_b32 v[68:69], v5 offset0:0 offset1:8
    ds_read2st64_b32 v[70:71], v5 offset0:16 offset1:20
    s_waitcnt lgkmcnt(0)
    v_max3_u32 v64, v64, v65, v66
    v_max3_u32 v67, v67, v68, v69
    v_max3_u32 v64, v64, v70, v71
    v_max_u32 v64, v64, v67
    v_cmp_eq_u32 vcc, -1, v64
    s_nop 4
    s_cbranch_vccz L_x1ok
    s_cmp_lt_u32 s9, 300
    s_nop 0
    s_cbranch_scc1 L_x1redo1
    s_nop 0
    s_branch L_x1ok
    s_nop 0
L_stredo:
    s_mov_b32 s9, 0
    s_nop 0
L_stredo1:
    v_lshlrev_b32 v14, 4, v2
    v_lshl_add_u32 v14, v3, 6, v14
    buffer_load_dwordx4 v[208:211], v14, s[56:59], s20 offen offset:0 sc1
    buffer_load_dwordx4 v[216:219], v14, s[56:59], s20 offen offset:1024 sc1
    buffer_load_dwordx4 v[224:227], v14, s[56:59], s20 offen offset:2048 sc1
    buffer_load_dwordx4 v[232:235], v14, s[56:59], s20 offen offset:3072 sc1
    s_add_u32 s9, s9, 1
    s_waitcnt vmcnt(0)
    v_cndmask_b32 v210, v210, 0, s[100:101]
    v_cndmask_b32 v218, v218, 0, s[100:101]
    v_cndmask_b32 v226, v226, 0, s[100:101]
    v_cndmask_b32 v234, v234, 0, s[100:101]
    v_cndmask_b32 v211, v211, 0, s[100:101]
    v_cndmask_b32 v219, v219, 0, s[100:101]
    v_cndmask_b32 v227, v227, 0, s[100:101]
    v_cndmask_b32 v235, v235, 0, s[100:101]
    v_add_f32 v208, v208, v210
    v_add_f32 v216, v216, v218
    v_add_f32 v224, v224, v226
    v_add_f32 v232, v232, v234
    v_add_f32 v209, v209, v211
    v_add_f32 v217, v217, v219
    v_add_f32 v225, v225, v227
    v_add_f32 v233, v233, v235
    v_permlane32_swap_b32 v208, v209
    v_permlane32_swap_b32 v216, v217
    v_permlane32_swap_b32 v224, v225
    v_permlane32_swap_b32 v232, v233
    v_add_f32 v208, v208, v209
    v_add_f32 v216, v216, v217
    v_add_f32 v224, v224, v225
    v_add_f32 v232, v232, v233
    v_mov_b32 v209, v208
    v_mov_b32 v217, v216
    v_mov_b32 v225, v224
    v_mov_b32 v233, v232
    v_permlane16_swap_b32 v208, v209
    v_permlane16_swap_b32 v216, v217
    v_permlane16_swap_b32 v224, v225
    v_permlane16_swap_b32 v232, v233
    v_add_f32 v208, v208, v209
    v_add_f32 v216, v216, v217
    v_add_f32 v224, v224, v225
    v_add_f32 v232, v232, v233
    v_mov_b32 v209, v208
    v_mov_b32 v217, v216
    v_mov_b32 v225, v224
    v_mov_b32 v233, v232
    v_permlane32_swap_b32 v208, v209
    v_permlane32_swap_b32 v216, v217
    v_permlane32_swap_b32 v224, v225
    v_permlane32_swap_b32 v232, v233
    v_mul_f32 v208, 0xbb124925, v208
    v_mul_f32 v216, 0xbb124925, v216
    v_mul_f32 v224, 0xbb124925, v224
    v_mul_f32 v232, 0xbb124925, v232
    v_mul_f32 v209, 0x3b124925, v209
    v_mul_f32 v217, 0x3b124925, v217
    v_mul_f32 v225, 0x3b124925, v225
    v_mul_f32 v233, 0x3b124925, v233
    v_fma_f32 v209, -v208, v208, v209
    v_fma_f32 v217, -v216, v216, v217
    v_fma_f32 v225, -v224, v224, v225
    v_fma_f32 v233, -v232, v232, v233
    v_add_f32 v209, 0x3727c5ac, v209
    v_add_f32 v217, 0x3727c5ac, v217
    v_add_f32 v225, 0x3727c5ac, v225
    v_add_f32 v233, 0x3727c5ac, v233
    v_rsq_f32 v210, v209
    v_rsq_f32 v218, v217
    v_rsq_f32 v226, v225
    v_rsq_f32 v234, v233
    v_mul_f32 v212, 0xc0135761, v210
    v_mul_f32 v220, 0xc0135761, v218
    v_mul_f32 v228, 0xc0135761, v226
    v_mul_f32 v236, 0xc0135761, v234
    v_mul_f32 v211, v210, v210
    v_mul_f32 v219, v218, v218
    v_mul_f32 v227, v226, v226
    v_mul_f32 v235, v234, v234
    v_mul_f32 v214, v210, v209
    v_mul_f32 v222, v218, v217
    v_mul_f32 v230, v226, v225
    v_mul_f32 v238, v234, v233
    v_mul_f32 v211, 0xbdd2d3e8, v211
    v_mul_f32 v219, 0xbdd2d3e8, v219
    v_mul_f32 v227, 0xbdd2d3e8, v227
    v_mul_f32 v235, 0xbdd2d3e8, v235
    v_mul_f32 v210, v211, v210
    v_mul_f32 v218, v219, v218
    v_mul_f32 v226, v227, v226
    v_mul_f32 v234, v235, v234
    v_cmp_u_f32 vcc, v210, v218
    v_cmp_u_f32 s[10:11], v226, v234
    s_or_b64 vcc, vcc, s[10:11]
    s_nop 3
    s_cbranch_vccz L_stok
    s_cmp_lt_u32 s9, 300
    s_nop 0
    s_cbranch_scc1 L_stredo1
    s_nop 0
    s_branch L_stok
    s_nop 0
L_side:
    s_sub_u32 s93, s2, 224
    s_mov_b32 s52, s18
    s_and_b32 s53, s19, 0xffff
    s_mov_b32 s54, 0x126000
    s_mov_b32 s55, 0x00020000
    s_mov_b32 s56, s40
    s_and_b32 s57, s41, 0xffff
    s_mov_b32 s58, 0x4000000
    s_mov_b32 s59, 0x00020000
    s_lshl_b32 s5, s2, 2
    s_add_u32 s5, s5, s72
    s_lshl_b32 s91, s5, 7
    s_add_u32 s91, s91, 0x3c0000
    v_add_u32 v252, 896, v19
    v_add_u32 v253, 1792, v19
    v_lshrrev_b32 v4, 1, v3
    v_xor_b32 v4, v4, v2
    v_lshl_add_u32 v4, v4, 4, s96
    v_lshl_add_u32 v250, v3, 7, v4
    v_xor_b32 v251, 64, v250
    s_cmp_lg_u32 s72, 0
    s_nop 3
    s_cbranch_scc1 L_nz
    v_mov_b32 v240, 0
    v_mov_b32 v241, 0
    v_mov_b32 v242, 0
    v_mov_b32 v243, 0
    v_lshrrev_b32 v244, 1, v1
    v_lshlrev_b32 v244, 7, v244
    v_and_b32 v245, 1, v1
    v_lshl_add_u32 v244, v245, 4, v244
    s_lshl_b32 s5, s93, 12
    s_add_u32 s5, s5, 0x3c0000
    buffer_store_dwordx4 v[240:243], v244, s[56:59], s5 offen sc1
    s_mov_b32 s68, s38
    s_and_b32 s69, s39, 0xffff
    s_mov_b32 s70, 0x100
    s_mov_b32 s71, 0x00020000
    v_mov_b32 v245, 1
    v_mov_b32 v244, 252
    s_waitcnt vmcnt(0)
    s_mov_b64 exec, 1
    buffer_atomic_add v245, v244, s[68:71], 0 offen sc1
    s_mov_b64 exec, -1
    s_nop 0
L_nz:
    s_add_u32 m0, s96, 0
    s_nop 0
    buffer_load_dwordx4 v246, s[44:47], s84 offen offset:0 lds
    buffer_load_dwordx4 v247, s[44:47], s84 offen offset:1024 lds
    buffer_load_dwordx4 v248, s[44:47], s84 offen offset:2048 lds
    buffer_load_dwordx4 v249, s[44:47], s84 offen offset:3072 lds
    s_add_u32 m0, s96, 16384
    s_nop 0
    buffer_load_dwordx4 v246, s[44:47], s85 offen offset:0 lds
    buffer_load_dwordx4 v247, s[44:47], s85 offen offset:1024 lds
    buffer_load_dwordx4 v248, s[44:47], s85 offen offset:2048 lds
    buffer_load_dwordx4 v249, s[44:47], s85 offen offset:3072 lds
    s_add_u32 m0, s96, 32768
    s_nop 0
    buffer_load_dwordx4 v246, s[44:47], s86 offen offset:0 lds
    buffer_load_dwordx4 v247, s[44:47], s86 offen offset:1024 lds
    buffer_load_dwordx4 v248, s[44:47], s86 offen offset:2048 lds
    buffer_load_dwordx4 v249, s[44:47], s86 offen offset:3072 lds
    s_add_u32 m0, s96, 49152
    s_nop 0
    buffer_load_dwordx4 v246, s[44:47], s87 offen offset:0 lds
    buffer_load_dwordx4 v247, s[44:47], s87 offen offset:1024 lds
    buffer_load_dwordx4 v248, s[44:47], s87 offen offset:2048 lds
    buffer_load_dwordx4 v249, s[44:47], s87 offen offset:3072 lds
    s_cmp_ge_u32 s72, 2
    s_nop 0
    s_cbranch_scc1 L_ng0
    s_mov_b32 s68, s34
    s_and_b32 s69, s35, 0xffff
    s_mov_b32 s70, 0x380
    s_mov_b32 s71, 0x00020000
    s_mul_i32 s5, s72, 896
    s_add_u32 m0, s5, 161792
    s_mov_b32 exec_hi, 0x00ffffff
    buffer_load_dwordx4 v16, s[68:71], 0 offen lds
    s_mov_b64 exec, -1
    s_nop 0
L_ng0:
    v_bfe_u32 v4, v1, 2, 2
    v_and_b32 v5, 3, v1
    v_lshl_add_u32 v6, v2, 3, v4
    v_lshlrev_b32 v6, 6, v6
    v_and_b32 v7, 1, v2
    v_xor_b32 v7, v7, v5
    v_lshl_add_u32 v6, v7, 4, v6
    v_and_b32 v7, 1, v5
    v_lshl_add_u32 v20, v7, 3, v6
    v_xor_b32 v21, 8, v20
    v_add_u32 v22, 57344, v20
    v_add_u32 v24, 114688, v20
    v_add_u32 v23, 57344, v21
    v_add_u32 v25, 114688, v21
    v_cmp_eq_u32 s[100:101], 3, v2
    s_mov_b32 s80, 0x3fb8aa3b
    s_mov_b32 s81, 0x3fb8aa3b
    s_mov_b32 s82, 0xbfb8aa3b
    s_mov_b32 s83, 0xbfb8aa3b
    v_mov_b32 v63, 1
    v_lshrrev_b32 v4, 3, v1
    v_and_b32 v5, 7, v1
    v_bfe_u32 v6, v4, 1, 1
    v_lshlrev_b32 v6, 2, v6
    v_xor_b32 v5, v5, v6
    v_lshlrev_b32 v5, 4, v5
    s_movk_i32 s8, 896
    s_movk_i32 s9, 3584
    s_and_b32 s10, s72, 1
    s_lshl_b32 s10, s10, 4
    v_xor_b32 v5, s10, v5
    v_mad_u32_u24 v30, v4, s9, v5
    v_mad_u32_u24 v57, v4, s8, v5
    v_bfe_u32 v4, v1, 2, 2
    v_and_b32 v5, 3, v1
    v_and_b32 v8, 1, v2
    v_lshl_add_u32 v6, v2, 3, v4
    v_lshl_add_u32 v6, v8, 2, v6
    v_lshlrev_b32 v6, 7, v6
    v_lshrrev_b32 v7, 1, v4
    v_lshlrev_b32 v7, 2, v7
    v_or_b32 v7, v7, v8
    v_xor_b32 v7, v7, v5
    v_lshl_add_u32 v6, v7, 4, v6
    v_and_b32 v7, 1, v5
    v_lshl_add_u32 v6, v7, 3, v6
    v_mov_b32 v32, v6
    v_add_u32 v40, 65536, v32
    v_add_u32 v48, 131072, v32
    v_xor_b32 v33, 512, v6
    v_add_u32 v41, 65536, v33
    v_add_u32 v49, 131072, v33
    v_xor_b32 v34, 8, v6
    v_add_u32 v42, 65536, v34
    v_add_u32 v50, 131072, v34
    v_xor_b32 v35, 520, v6
    v_add_u32 v43, 65536, v35
    v_add_u32 v51, 131072, v35
    v_xor_b32 v36, 64, v6
    v_add_u32 v44, 65536, v36
    v_add_u32 v52, 131072, v36
    v_xor_b32 v37, 576, v6
    v_add_u32 v45, 65536, v37
    v_add_u32 v53, 131072, v37
    v_xor_b32 v38, 72, v6
    v_add_u32 v46, 65536, v38
    v_add_u32 v54, 131072, v38
    v_xor_b32 v39, 584, v6
    v_add_u32 v47, 65536, v39
    v_add_u32 v55, 131072, v39
    v_lshrrev_b32 v4, 3, v1
    s_sub_u32 s8, s77, 1
    v_add_u32 v4, s8, v4
    v_and_b32 v6, 7, v1
    v_bfe_u32 v7, v4, 2, 2
    v_lshl_add_u32 v7, v6, 2, v7
    v_lshrrev_b32 v8, 4, v4
    v_lshl_add_u32 v7, v7, 3, v8
    v_and_b32 v8, 3, v4
    v_lshl_add_u32 v7, v7, 2, v8
    v_lshlrev_b32 v7, 7, v7
    v_add_u32 v26, 0x3c0000, v7
    s_lshr_b32 s8, 0x3c78, s74
    s_and_b32 s8, s8, 1
    s_mul_i32 s8, s8, 0x7f
    s_lshr_b32 s9, 0x78f, s74
    s_and_b32 s9, s9, 1
    s_mul_i32 s9, s9, 0x7f000000
    s_or_b32 s8, s8, s9
    s_or_b32 s8, s8, 0x7f7f00
    v_cmp_gt_u32 vcc, 128, v4
    s_and_b32 s26, s8, vcc_lo
    s_mov_b32 s27, 0
    s_add_u32 s9, s74, 224
    s_lshl_b32 s9, s9, 2
    s_add_u32 s9, s9, s72
    s_lshl_b32 s9, s9, 7
    s_add_u32 s9, s9, 0x3c001c
    v_lshl_add_u32 v31, v1, 13, s9
    s_lshr_b32 s5, s93, 3
    s_lshl_b32 s5, s5, 2
    s_add_u32 s5, s5, s72
    s_lshl_b32 s6, s5, 13
    v_lshl_add_u32 v28, v1, 7, s6
    s_mul_i32 s6, s5, 21504
    v_lshrrev_b32 v4, 3, v1
    v_mul_u32_u24 v4, 2688, v4
    v_and_b32 v5, 7, v1
    v_lshl_add_u32 v4, v5, 7, v4
    v_add_u32 v29, s6, v4
    s_waitcnt vmcnt(12)
    ds_read_b128 a[0:3], v250 offset:0
    ds_read_b128 a[4:7], v250 offset:2048
    ds_read_b128 a[8:11], v251 offset:0
    ds_read_b128 a[12:15], v251 offset:2048
    s_mul_i32 s42, s84, 1344
    s_add_u32 m0, s90, 28672
    s_nop 0
    buffer_load_dwordx4 v252, s[52:55], s42 offen lds
    s_add_u32 m0, s90, 57344
    s_nop 0
    buffer_load_dwordx4 v253, s[52:55], s42 offen lds
    s_waitcnt lgkmcnt(0)
    s_add_u32 m0, s96, 0
    s_nop 0
    buffer_load_dwordx4 v246, s[44:47], s88 offen offset:0 lds
    buffer_load_dwordx4 v247, s[44:47], s88 offen offset:1024 lds
    buffer_load_dwordx4 v248, s[44:47], s88 offen offset:2048 lds
    buffer_load_dwordx4 v249, s[44:47], s88 offen offset:3072 lds
    s_waitcnt vmcnt(14)
    ds_read_b128 a[16:19], v250 offset:16384
    ds_read_b128 a[20:23], v250 offset:18432
    ds_read_b128 a[24:27], v251 offset:16384
    ds_read_b128 a[28:31], v251 offset:18432
    s_mul_i32 s42, s85, 1344
    s_add_u32 m0, s90, 32768
    s_nop 0
    buffer_load_dwordx4 v252, s[52:55], s42 offen lds
    s_add_u32 m0, s90, 61440
    s_nop 0
    buffer_load_dwordx4 v253, s[52:55], s42 offen lds
    s_waitcnt lgkmcnt(0)
    s_add_u32 m0, s96, 16384
    s_nop 0
    buffer_load_dwordx4 v246, s[44:47], s89 offen offset:0 lds
    buffer_load_dwordx4 v247, s[44:47], s89 offen offset:1024 lds
    buffer_load_dwordx4 v248, s[44:47], s89 offen offset:2048 lds
    buffer_load_dwordx4 v249, s[44:47], s89 offen offset:3072 lds
    s_waitcnt vmcnt(16)
    ds_read_b128 a[32:35], v250 offset:32768
    ds_read_b128 a[36:39], v250 offset:34816
    ds_read_b128 a[40:43], v251 offset:32768
    ds_read_b128 a[44:47], v251 offset:34816
    s_mul_i32 s42, s86, 1344
    s_add_u32 m0, s90, 36864
    s_nop 0
    buffer_load_dwordx4 v252, s[52:55], s42 offen lds
    s_add_u32 m0, s90, 65536
    s_nop 0
    buffer_load_dwordx4 v253, s[52:55], s42 offen lds
    s_waitcnt lgkmcnt(0)
    s_add_u32 m0, s96, 32768
    s_nop 0
    buffer_load_dwordx4 v246, s[44:47], s43 offen offset:0 lds
    buffer_load_dwordx4 v247, s[44:47], s43 offen offset:1024 lds
    buffer_load_dwordx4 v248, s[44:47], s43 offen offset:2048 lds
    buffer_load_dwordx4 v249, s[44:47], s43 offen offset:3072 lds
    s_waitcnt vmcnt(18)
    ds_read_b128 a[48:51], v250 offset:49152
    ds_read_b128 a[52:55], v250 offset:51200
    ds_read_b128 a[56:59], v251 offset:49152
    ds_read_b128 a[60:63], v251 offset:51200
    s_mul_i32 s42, s87, 1344
    s_add_u32 m0, s90, 40960
    s_nop 0
    buffer_load_dwordx4 v252, s[52:55], s42 offen lds
    s_add_u32 m0, s90, 69632
    s_nop 0
    buffer_load_dwordx4 v253, s[52:55], s42 offen lds
    s_waitcnt vmcnt(14)
    ds_read_b128 a[64:67], v250 offset:0
    ds_read_b128 a[68:71], v250 offset:2048
    ds_read_b128 a[72:75], v251 offset:0
    ds_read_b128 a[76:79], v251 offset:2048
    s_mul_i32 s42, s88, 1344
    s_add_u32 m0, s90, 45056
    s_nop 0
    buffer_load_dwordx4 v252, s[52:55], s42 offen lds
    s_add_u32 m0, s90, 73728
    s_nop 0
    buffer_load_dwordx4 v253, s[52:55], s42 offen lds
    s_waitcnt vmcnt(10)
    ds_read_b128 a[80:83], v250 offset:16384
    ds_read_b128 a[84:87], v250 offset:18432
    ds_read_b128 a[88:91], v251 offset:16384
    ds_read_b128 a[92:95], v251 offset:18432
    s_mul_i32 s42, s89, 1344
    s_add_u32 m0, s90, 49152
    s_nop 0
    buffer_load_dwordx4 v252, s[52:55], s42 offen lds
    s_add_u32 m0, s90, 77824
    s_nop 0
    buffer_load_dwordx4 v253, s[52:55], s42 offen lds
    s_lshl_b32 s13, s93, 2
    s_add_u32 s13, s13, s72
    s_add_u32 s8, s13, 0
    s_mov_b32 s68, s32
    s_mov_b32 s69, s33
    s_mov_b32 s70, 1605632
    s_mul_i32 s9, s8, 8192
    s_cmp_ge_u32 s8, 196
    s_cselect_b32 s70, 0, s70
    s_and_b32 s69, s69, 0xffff
    s_mov_b32 s71, 0x00020000
    v_lshlrev_b32 v5, 7, v1
    buffer_load_dword v60, v5, s[68:71], s9 offen
    s_waitcnt vmcnt(7)
    ds_read_b128 a[96:99], v250 offset:32768
    ds_read_b128 a[100:103], v250 offset:34816
    ds_read_b128 a[104:107], v251 offset:32768
    ds_read_b128 a[108:111], v251 offset:34816
    s_mul_i32 s42, s43, 1344
    s_add_u32 m0, s90, 53248
    s_nop 0
    buffer_load_dwordx4 v252, s[52:55], s42 offen lds
    s_add_u32 m0, s90, 81920
    s_nop 0
    buffer_load_dwordx4 v253, s[52:55], s42 offen lds
    s_lshl_b32 s13, s72, 5
    s_add_u32 s13, s13, s93
    s_add_u32 s8, s13, 128
    s_mov_b32 s68, s32
    s_mov_b32 s69, s33
    s_mov_b32 s70, 1605632
    s_mul_i32 s9, s8, 8192
    s_cmp_ge_u32 s8, 196
    s_cselect_b32 s70, 0, s70
    s_and_b32 s69, s69, 0xffff
    s_mov_b32 s71, 0x00020000
    v_lshlrev_b32 v5, 7, v1
    buffer_load_dword v60, v5, s[68:71], s9 offen
    s_mov_b32 s68, s20
    s_and_b32 s69, s21, 0xffff
    s_mov_b32 s70, 0x6200
    s_mov_b32 s71, 0x00020000
    v_lshrrev_b32 v4, 2, v1
    s_and_b32 s8, s72, 1
    s_lshl_b32 s9, s8, 4
    v_mov_b32 v5, v17
    v_add_u32 v4, s9, v4
    v_subrev_u32 v6, 4, v4
    v_cmp_le_u32 vcc, 28, v4
    s_nop 1
    v_cndmask_b32 v6, v4, v6, vcc
    v_mad_u32_u24 v5, v6, 56, v5
    v_subrev_u32 v4, 24, v4
    v_cmp_gt_u32 vcc, 4, v4
    v_mov_b32 v6, 0x7fffffff
    s_nop 0
    v_cndmask_b32 v5, v5, v6, vcc
    s_lshl_b32 s8, s8, 10
    s_add_u32 m0, s8, 159744
    s_mul_i32 s9, s74, 1568
    buffer_load_dwordx4 v5, s[68:71], s9 offen lds
    s_mov_b32 s68, s38
    s_and_b32 s69, s39, 0xffff
    s_mov_b32 s70, 0x100
    s_mov_b32 s71, 0x00020000
    v_mov_b32 v61, 252
    buffer_load_dword v61, v61, s[68:71], 0 offen sc1
    s_waitcnt vmcnt(28)
    s_barrier
    ds_read_b64_tr_b16 v[64:65], v20 offset:28672
    ds_read_b64_tr_b16 v[66:67], v20 offset:28928
    ds_read_b64_tr_b16 v[68:69], v21 offset:28672
    ds_read_b64_tr_b16 v[70:71], v21 offset:28928
    ds_read_b64_tr_b16 v[72:73], v22 offset:0
    ds_read_b64_tr_b16 v[74:75], v22 offset:256
    ds_read_b64_tr_b16 v[76:77], v23 offset:0
    ds_read_b64_tr_b16 v[78:79], v23 offset:256
    s_waitcnt lgkmcnt(0)
    v_mfma_f32_16x16x32_bf16 v[144:147], v[64:67], a[0:3], 0
    ds_read_b64_tr_b16 v[80:81], v20 offset:30720
    ds_read_b64_tr_b16 v[82:83], v20 offset:30976
    v_mfma_f32_16x16x32_bf16 v[152:155], v[64:67], a[4:7], 0
    ds_read_b64_tr_b16 v[84:85], v21 offset:30720
    ds_read_b64_tr_b16 v[86:87], v21 offset:30976
    v_mfma_f32_16x16x32_bf16 v[148:151], v[68:71], a[0:3], 0
    ds_read_b64_tr_b16 v[88:89], v22 offset:2048
    ds_read_b64_tr_b16 v[90:91], v22 offset:2304
    v_mfma_f32_16x16x32_bf16 v[156:159], v[68:71], a[4:7], 0
    ds_read_b64_tr_b16 v[92:93], v23 offset:2048
    ds_read_b64_tr_b16 v[94:95], v23 offset:2304
    v_mfma_f32_16x16x32_bf16 v[160:163], v[72:75], a[0:3], 0
    s_mul_i32 s42, s84, 1344
    s_add_u32 m0, s90, 0
    v_mfma_f32_16x16x32_bf16 v[168:171], v[72:75], a[4:7], 0
    buffer_load_dwordx4 v19, s[52:55], s42 offen lds
    v_mfma_f32_16x16x32_bf16 v[164:167], v[76:79], a[0:3], 0
    v_mfma_f32_16x16x32_bf16 v[172:175], v[76:79], a[4:7], 0
    s_waitcnt lgkmcnt(0)
    v_mfma_f32_16x16x32_bf16 v[144:147], v[80:83], a[8:11], v[144:147]
    s_waitcnt vmcnt(23)
    s_barrier
    ds_read_b64_tr_b16 v[64:65], v20 offset:32768
    ds_read_b64_tr_b16 v[66:67], v20 offset:33024
    v_mfma_f32_16x16x32_bf16 v[152:155], v[80:83], a[12:15], v[152:155]
    ds_read_b64_tr_b16 v[68:69], v21 offset:32768
    ds_read_b64_tr_b16 v[70:71], v21 offset:33024
    v_mfma_f32_16x16x32_bf16 v[148:151], v[84:87], a[8:11], v[148:151]
    ds_read_b64_tr_b16 v[72:73], v22 offset:4096
    ds_read_b64_tr_b16 v[74:75], v22 offset:4352
    v_mfma_f32_16x16x32_bf16 v[156:159], v[84:87], a[12:15], v[156:159]
    ds_read_b64_tr_b16 v[76:77], v23 offset:4096
    ds_read_b64_tr_b16 v[78:79], v23 offset:4352
    v_mfma_f32_16x16x32_bf16 v[160:163], v[88:91], a[8:11], v[160:163]
    s_mul_i32 s42, s85, 1344
    s_add_u32 m0, s90, 4096
    v_mfma_f32_16x16x32_bf16 v[168:171], v[88:91], a[12:15], v[168:171]
    buffer_load_dwordx4 v19, s[52:55], s42 offen lds
    v_mfma_f32_16x16x32_bf16 v[164:167], v[92:95], a[8:11], v[164:167]
    s_mul_i32 s42, s86, 1344
    s_add_u32 m0, s90, 8192
    v_mfma_f32_16x16x32_bf16 v[172:175], v[92:95], a[12:15], v[172:175]
    s_waitcnt lgkmcnt(0)
    v_mfma_f32_16x16x32_bf16 v[144:147], v[64:67], a[16:19], v[144:147]
    ds_read_b64_tr_b16 v[80:81], v20 offset:34816
    ds_read_b64_tr_b16 v[82:83], v20 offset:35072
    v_mfma_f32_16x16x32_bf16 v[152:155], v[64:67], a[20:23], v[152:155]
    ds_read_b64_tr_b16 v[84:85], v21 offset:34816
    ds_read_b64_tr_b16 v[86:87], v21 offset:35072
    v_mfma_f32_16x16x32_bf16 v[148:151], v[68:71], a[16:19], v[148:151]
    ds_read_b64_tr_b16 v[88:89], v22 offset:6144
    ds_read_b64_tr_b16 v[90:91], v22 offset:6400
    v_mfma_f32_16x16x32_bf16 v[156:159], v[68:71], a[20:23], v[156:159]
    ds_read_b64_tr_b16 v[92:93], v23 offset:6144
    ds_read_b64_tr_b16 v[94:95], v23 offset:6400
    v_mfma_f32_16x16x32_bf16 v[160:163], v[72:75], a[16:19], v[160:163]
    buffer_load_dwordx4 v19, s[52:55], s42 offen lds
    v_mfma_f32_16x16x32_bf16 v[168:171], v[72:75], a[20:23], v[168:171]
    s_mul_i32 s42, s87, 1344
    s_add_u32 m0, s90, 12288
    v_mfma_f32_16x16x32_bf16 v[164:167], v[76:79], a[16:19], v[164:167]
    buffer_load_dwordx4 v19, s[52:55], s42 offen lds
    v_mfma_f32_16x16x32_bf16 v[172:175], v[76:79], a[20:23], v[172:175]
    s_waitcnt lgkmcnt(0)
    v_mfma_f32_16x16x32_bf16 v[144:147], v[80:83], a[24:27], v[144:147]
    s_waitcnt vmcnt(20)
    s_barrier
    ds_read_b64_tr_b16 v[64:65], v20 offset:36864
    ds_read_b64_tr_b16 v[66:67], v20 offset:37120
    v_mfma_f32_16x16x32_bf16 v[152:155], v[80:83], a[28:31], v[152:155]
    ds_read_b64_tr_b16 v[68:69], v21 offset:36864
    ds_read_b64_tr_b16 v[70:71], v21 offset:37120
    v_mfma_f32_16x16x32_bf16 v[148:151], v[84:87], a[24:27], v[148:151]
    ds_read_b64_tr_b16 v[72:73], v22 offset:8192
    ds_read_b64_tr_b16 v[74:75], v22 offset:8448
    v_mfma_f32_16x16x32_bf16 v[156:159], v[84:87], a[28:31], v[156:159]
    ds_read_b64_tr_b16 v[76:77], v23 offset:8192
    ds_read_b64_tr_b16 v[78:79], v23 offset:8448
    v_mfma_f32_16x16x32_bf16 v[160:163], v[88:91], a[24:27], v[160:163]
    s_mul_i32 s42, s88, 1344
    s_add_u32 m0, s90, 16384
    v_mfma_f32_16x16x32_bf16 v[168:171], v[88:91], a[28:31], v[168:171]
    buffer_load_dwordx4 v19, s[52:55], s42 offen lds
    v_mfma_f32_16x16x32_bf16 v[164:167], v[92:95], a[24:27], v[164:167]
    s_mul_i32 s42, s89, 1344
    s_add_u32 m0, s90, 20480
    v_mfma_f32_16x16x32_bf16 v[172:175], v[92:95], a[28:31], v[172:175]
    s_waitcnt lgkmcnt(0)
    v_mfma_f32_16x16x32_bf16 v[144:147], v[64:67], a[32:35], v[144:147]
    ds_read_b64_tr_b16 v[80:81], v20 offset:38912
    ds_read_b64_tr_b16 v[82:83], v20 offset:39168
    v_mfma_f32_16x16x32_bf16 v[152:155], v[64:67], a[36:39], v[152:155]
    ds_read_b64_tr_b16 v[84:85], v21 offset:38912
    ds_read_b64_tr_b16 v[86:87], v21 offset:39168
    v_mfma_f32_16x16x32_bf16 v[148:151], v[68:71], a[32:35], v[148:151]
    ds_read_b64_tr_b16 v[88:89], v22 offset:10240
    ds_read_b64_tr_b16 v[90:91], v22 offset:10496
    v_mfma_f32_16x16x32_bf16 v[156:159], v[68:71], a[36:39], v[156:159]
    ds_read_b64_tr_b16 v[92:93], v23 offset:10240
    ds_read_b64_tr_b16 v[94:95], v23 offset:10496
    v_mfma_f32_16x16x32_bf16 v[160:163], v[72:75], a[32:35], v[160:163]
    buffer_load_dwordx4 v19, s[52:55], s42 offen lds
    v_mfma_f32_16x16x32_bf16 v[168:171], v[72:75], a[36:39], v[168:171]
    s_mul_i32 s42, s43, 1344
    s_add_u32 m0, s90, 24576
    v_mfma_f32_16x16x32_bf16 v[164:167], v[76:79], a[32:35], v[164:167]
    buffer_load_dwordx4 v19, s[52:55], s42 offen lds
    v_mfma_f32_16x16x32_bf16 v[172:175], v[76:79], a[36:39], v[172:175]
    s_waitcnt lgkmcnt(0)
    v_mfma_f32_16x16x32_bf16 v[144:147], v[80:83], a[40:43], v[144:147]
    s_waitcnt vmcnt(17)
    s_barrier
    ds_read_b64_tr_b16 v[64:65], v20 offset:40960
    ds_read_b64_tr_b16 v[66:67], v20 offset:41216
    v_mfma_f32_16x16x32_bf16 v[152:155], v[80:83], a[44:47], v[152:155]
    ds_read_b64_tr_b16 v[68:69], v21 offset:40960
    ds_read_b64_tr_b16 v[70:71], v21 offset:41216
    v_mfma_f32_16x16x32_bf16 v[148:151], v[84:87], a[40:43], v[148:151]
    ds_read_b64_tr_b16 v[72:73], v22 offset:12288
    ds_read_b64_tr_b16 v[74:75], v22 offset:12544
    v_mfma_f32_16x16x32_bf16 v[156:159], v[84:87], a[44:47], v[156:159]
    ds_read_b64_tr_b16 v[76:77], v23 offset:12288
    ds_read_b64_tr_b16 v[78:79], v23 offset:12544
    v_mfma_f32_16x16x32_bf16 v[160:163], v[88:91], a[40:43], v[160:163]
    v_mfma_f32_16x16x32_bf16 v[168:171], v[88:91], a[44:47], v[168:171]
    v_mfma_f32_16x16x32_bf16 v[164:167], v[92:95], a[40:43], v[164:167]
    v_mfma_f32_16x16x32_bf16 v[172:175], v[92:95], a[44:47], v[172:175]
    s_waitcnt lgkmcnt(0)
    v_mfma_f32_16x16x32_bf16 v[144:147], v[64:67], a[48:51], v[144:147]
    ds_read_b64_tr_b16 v[80:81], v20 offset:43008
    ds_read_b64_tr_b16 v[82:83], v20 offset:43264
    v_mfma_f32_16x16x32_bf16 v[152:155], v[64:67], a[52:55], v[152:155]
    ds_read_b64_tr_b16 v[84:85], v21 offset:43008
    ds_read_b64_tr_b16 v[86:87], v21 offset:43264
    v_mfma_f32_16x16x32_bf16 v[148:151], v[68:71], a[48:51], v[148:151]
    ds_read_b64_tr_b16 v[88:89], v22 offset:14336
    ds_read_b64_tr_b16 v[90:91], v22 offset:14592
    v_mfma_f32_16x16x32_bf16 v[156:159], v[68:71], a[52:55], v[156:159]
    ds_read_b64_tr_b16 v[92:93], v23 offset:14336
    ds_read_b64_tr_b16 v[94:95], v23 offset:14592
    v_mfma_f32_16x16x32_bf16 v[160:163], v[72:75], a[48:51], v[160:163]
    v_mfma_f32_16x16x32_bf16 v[168:171], v[72:75], a[52:55], v[168:171]
    v_mfma_f32_16x16x32_bf16 v[164:167], v[76:79], a[48:51], v[164:167]
    v_mfma_f32_16x16x32_bf16 v[172:175], v[76:79], a[52:55], v[172:175]
    s_waitcnt lgkmcnt(0)
    v_mfma_f32_16x16x32_bf16 v[144:147], v[80:83], a[56:59], v[144:147]
    s_waitcnt vmcnt(15)
    s_barrier
    ds_read_b64_tr_b16 v[64:65], v20 offset:45056
    ds_read_b64_tr_b16 v[66:67], v20 offset:45312
    v_mfma_f32_16x16x32_bf16 v[152:155], v[80:83], a[60:63], v[152:155]
    ds_read_b64_tr_b16 v[68:69], v21 offset:45056
    ds_read_b64_tr_b16 v[70:71], v21 offset:45312
    v_mfma_f32_16x16x32_bf16 v[148:151], v[84:87], a[56:59], v[148:151]
    ds_read_b64_tr_b16 v[72:73], v22 offset:16384
    ds_read_b64_tr_b16 v[74:75], v22 offset:16640
    v_mfma_f32_16x16x32_bf16 v[156:159], v[84:87], a[60:63], v[156:159]
    ds_read_b64_tr_b16 v[76:77], v23 offset:16384
    ds_read_b64_tr_b16 v[78:79], v23 offset:16640
    v_mfma_f32_16x16x32_bf16 v[160:163], v[88:91], a[56:59], v[160:163]
    v_mfma_f32_16x16x32_bf16 v[168:171], v[88:91], a[60:63], v[168:171]
    v_mfma_f32_16x16x32_bf16 v[164:167], v[92:95], a[56:59], v[164:167]
    v_mfma_f32_16x16x32_bf16 v[172:175], v[92:95], a[60:63], v[172:175]
    s_waitcnt lgkmcnt(0)
    v_mfma_f32_16x16x32_bf16 v[144:147], v[64:67], a[64:67], v[144:147]
    ds_read_b64_tr_b16 v[80:81], v20 offset:47104
    ds_read_b64_tr_b16 v[82:83], v20 offset:47360
    v_mfma_f32_16x16x32_bf16 v[152:155], v[64:67], a[68:71], v[152:155]
    ds_read_b64_tr_b16 v[84:85], v21 offset:47104
    ds_read_b64_tr_b16 v[86:87], v21 offset:47360
    v_mfma_f32_16x16x32_bf16 v[148:151], v[68:71], a[64:67], v[148:151]
    ds_read_b64_tr_b16 v[88:89], v22 offset:18432
    ds_read_b64_tr_b16 v[90:91], v22 offset:18688
    v_mfma_f32_16x16x32_bf16 v[156:159], v[68:71], a[68:71], v[156:159]
    ds_read_b64_tr_b16 v[92:93], v23 offset:18432
    ds_read_b64_tr_b16 v[94:95], v23 offset:18688
    v_mfma_f32_16x16x32_bf16 v[160:163], v[72:75], a[64:67], v[160:163]
    v_mfma_f32_16x16x32_bf16 v[168:171], v[72:75], a[68:71], v[168:171]
    v_mfma_f32_16x16x32_bf16 v[164:167], v[76:79], a[64:67], v[164:167]
    v_mfma_f32_16x16x32_bf16 v[172:175], v[76:79], a[68:71], v[172:175]
    s_waitcnt lgkmcnt(0)
    v_mfma_f32_16x16x32_bf16 v[144:147], v[80:83], a[72:75], v[144:147]
    s_waitcnt vmcnt(13)
    s_barrier
    ds_read_b64_tr_b16 v[64:65], v20 offset:49152
    ds_read_b64_tr_b16 v[66:67], v20 offset:49408
    v_mfma_f32_16x16x32_bf16 v[152:155], v[80:83], a[76:79], v[152:155]
    ds_read_b64_tr_b16 v[68:69], v21 offset:49152
    ds_read_b64_tr_b16 v[70:71], v21 offset:49408
    v_mfma_f32_16x16x32_bf16 v[148:151], v[84:87], a[72:75], v[148:151]
    ds_read_b64_tr_b16 v[72:73], v22 offset:20480
    ds_read_b64_tr_b16 v[74:75], v22 offset:20736
    v_mfma_f32_16x16x32_bf16 v[156:159], v[84:87], a[76:79], v[156:159]
    ds_read_b64_tr_b16 v[76:77], v23 offset:20480
    ds_read_b64_tr_b16 v[78:79], v23 offset:20736
    v_mfma_f32_16x16x32_bf16 v[160:163], v[88:91], a[72:75], v[160:163]
    v_mfma_f32_16x16x32_bf16 v[168:171], v[88:91], a[76:79], v[168:171]
    v_mfma_f32_16x16x32_bf16 v[164:167], v[92:95], a[72:75], v[164:167]
    v_mfma_f32_16x16x32_bf16 v[172:175], v[92:95], a[76:79], v[172:175]
    s_waitcnt lgkmcnt(0)
    v_mfma_f32_16x16x32_bf16 v[144:147], v[64:67], a[80:83], v[144:147]
    ds_read_b64_tr_b16 v[80:81], v20 offset:51200
    ds_read_b64_tr_b16 v[82:83], v20 offset:51456
    v_mfma_f32_16x16x32_bf16 v[152:155], v[64:67], a[84:87], v[152:155]
    ds_read_b64_tr_b16 v[84:85], v21 offset:51200
    ds_read_b64_tr_b16 v[86:87], v21 offset:51456
    v_mfma_f32_16x16x32_bf16 v[148:151], v[68:71], a[80:83], v[148:151]
    ds_read_b64_tr_b16 v[88:89], v22 offset:22528
    ds_read_b64_tr_b16 v[90:91], v22 offset:22784
    v_mfma_f32_16x16x32_bf16 v[156:159], v[68:71], a[84:87], v[156:159]
    ds_read_b64_tr_b16 v[92:93], v23 offset:22528
    ds_read_b64_tr_b16 v[94:95], v23 offset:22784
    v_mfma_f32_16x16x32_bf16 v[160:163], v[72:75], a[80:83], v[160:163]
    v_mfma_f32_16x16x32_bf16 v[168:171], v[72:75], a[84:87], v[168:171]
    v_mfma_f32_16x16x32_bf16 v[164:167], v[76:79], a[80:83], v[164:167]
    v_mfma_f32_16x16x32_bf16 v[172:175], v[76:79], a[84:87], v[172:175]
    s_waitcnt lgkmcnt(0)
    v_mfma_f32_16x16x32_bf16 v[144:147], v[80:83], a[88:91], v[144:147]
    s_waitcnt vmcnt(8)
    s_barrier
    ds_read_b64_tr_b16 v[64:65], v20 offset:53248
    ds_read_b64_tr_b16 v[66:67], v20 offset:53504
    v_mfma_f32_16x16x32_bf16 v[152:155], v[80:83], a[92:95], v[152:155]
    ds_read_b64_tr_b16 v[68:69], v21 offset:53248
    ds_read_b64_tr_b16 v[70:71], v21 offset:53504
    v_mfma_f32_16x16x32_bf16 v[148:151], v[84:87], a[88:91], v[148:151]
    ds_read_b64_tr_b16 v[72:73], v22 offset:24576
    ds_read_b64_tr_b16 v[74:75], v22 offset:24832
    v_mfma_f32_16x16x32_bf16 v[156:159], v[84:87], a[92:95], v[156:159]
    ds_read_b64_tr_b16 v[76:77], v23 offset:24576
    ds_read_b64_tr_b16 v[78:79], v23 offset:24832
    v_mfma_f32_16x16x32_bf16 v[160:163], v[88:91], a[88:91], v[160:163]
    v_mfma_f32_16x16x32_bf16 v[168:171], v[88:91], a[92:95], v[168:171]
    v_mfma_f32_16x16x32_bf16 v[164:167], v[92:95], a[88:91], v[164:167]
    v_mfma_f32_16x16x32_bf16 v[172:175], v[92:95], a[92:95], v[172:175]
    s_waitcnt lgkmcnt(0)
    v_mfma_f32_16x16x32_bf16 v[144:147], v[64:67], a[96:99], v[144:147]
    ds_read_b64_tr_b16 v[80:81], v20 offset:55296
    ds_read_b64_tr_b16 v[82:83], v20 offset:55552
    v_mfma_f32_16x16x32_bf16 v[152:155], v[64:67], a[100:103], v[152:155]
    ds_read_b64_tr_b16 v[84:85], v21 offset:55296
    ds_read_b64_tr_b16 v[86:87], v21 offset:55552
    v_mfma_f32_16x16x32_bf16 v[148:151], v[68:71], a[96:99], v[148:151]
    ds_read_b64_tr_b16 v[88:89], v22 offset:26624
    ds_read_b64_tr_b16 v[90:91], v22 offset:26880
    v_mfma_f32_16x16x32_bf16 v[156:159], v[68:71], a[100:103], v[156:159]
    ds_read_b64_tr_b16 v[92:93], v23 offset:26624
    ds_read_b64_tr_b16 v[94:95], v23 offset:26880
    v_mfma_f32_16x16x32_bf16 v[160:163], v[72:75], a[96:99], v[160:163]
    v_mfma_f32_16x16x32_bf16 v[168:171], v[72:75], a[100:103], v[168:171]
    v_mfma_f32_16x16x32_bf16 v[164:167], v[76:79], a[96:99], v[164:167]
    v_mfma_f32_16x16x32_bf16 v[172:175], v[76:79], a[100:103], v[172:175]
    s_waitcnt lgkmcnt(0)
    v_mfma_f32_16x16x32_bf16 v[144:147], v[80:83], a[104:107], v[144:147]
    v_mfma_f32_16x16x32_bf16 v[152:155], v[80:83], a[108:111], v[152:155]
    v_mfma_f32_16x16x32_bf16 v[148:151], v[84:87], a[104:107], v[148:151]
    v_mfma_f32_16x16x32_bf16 v[156:159], v[84:87], a[108:111], v[156:159]
    v_mfma_f32_16x16x32_bf16 v[160:163], v[88:91], a[104:107], v[160:163]
    v_mfma_f32_16x16x32_bf16 v[168:171], v[88:91], a[108:111], v[168:171]
    v_mfma_f32_16x16x32_bf16 v[164:167], v[92:95], a[104:107], v[164:167]
    v_mfma_f32_16x16x32_bf16 v[172:175], v[92:95], a[108:111], v[172:175]
    s_cmp_lg_u32 s74, 14
    s_nop 6
    s_cbranch_scc1 L_ngo
    s_add_u32 s5, s84, 161792
    v_lshl_add_u32 v4, v2, 4, s5
    ds_read_b128 v[64:67], v4 offset:0
    ds_read_b128 v[68:71], v4 offset:64
    ds_read_b128 v[72:75], v4 offset:128
    ds_read_b128 v[76:79], v4 offset:192
    ds_read_b128 v[80:83], v4 offset:256
    ds_read_b128 v[84:87], v4 offset:320
    ds_read_b128 v[88:91], v4 offset:384
    ds_read_b128 v[92:95], v4 offset:448
    ds_read_b128 v[96:99], v4 offset:512
    ds_read_b128 v[100:103], v4 offset:576
    ds_read_b128 v[104:107], v4 offset:640
    ds_read_b128 v[108:111], v4 offset:704
    ds_read_b128 v[112:115], v4 offset:768
    ds_read_b128 v[116:119], v4 offset:832
    s_waitcnt lgkmcnt(13)
    v_mfma_f32_16x16x32_bf16 v[128:131], v[64:67], a[0:3], 0
    v_mfma_f32_16x16x32_bf16 v[132:135], v[64:67], a[4:7], 0
    s_waitcnt lgkmcnt(12)
    v_mfma_f32_16x16x32_bf16 v[128:131], v[68:71], a[8:11], v[128:131]
    v_mfma_f32_16x16x32_bf16 v[132:135], v[68:71], a[12:15], v[132:135]
    s_waitcnt lgkmcnt(11)
    v_mfma_f32_16x16x32_bf16 v[128:131], v[72:75], a[16:19], v[128:131]
    v_mfma_f32_16x16x32_bf16 v[132:135], v[72:75], a[20:23], v[132:135]
    s_waitcnt lgkmcnt(10)
    v_mfma_f32_16x16x32_bf16 v[128:131], v[76:79], a[24:27], v[128:131]
    v_mfma_f32_16x16x32_bf16 v[132:135], v[76:79], a[28:31], v[132:135]
    s_waitcnt lgkmcnt(9)
    v_mfma_f32_16x16x32_bf16 v[128:131], v[80:83], a[32:35], v[128:131]
    v_mfma_f32_16x16x32_bf16 v[132:135], v[80:83], a[36:39], v[132:135]
    s_waitcnt lgkmcnt(8)
    v_mfma_f32_16x16x32_bf16 v[128:131], v[84:87], a[40:43], v[128:131]
    v_mfma_f32_16x16x32_bf16 v[132:135], v[84:87], a[44:47], v[132:135]
    s_waitcnt lgkmcnt(7)
    v_mfma_f32_16x16x32_bf16 v[128:131], v[88:91], a[48:51], v[128:131]
    v_mfma_f32_16x16x32_bf16 v[132:135], v[88:91], a[52:55], v[132:135]
    s_waitcnt lgkmcnt(6)
    v_mfma_f32_16x16x32_bf16 v[128:131], v[92:95], a[56:59], v[128:131]
    v_mfma_f32_16x16x32_bf16 v[132:135], v[92:95], a[60:63], v[132:135]
    s_waitcnt lgkmcnt(5)
    v_mfma_f32_16x16x32_bf16 v[128:131], v[96:99], a[64:67], v[128:131]
    v_mfma_f32_16x16x32_bf16 v[132:135], v[96:99], a[68:71], v[132:135]
    s_waitcnt lgkmcnt(4)
    v_mfma_f32_16x16x32_bf16 v[128:131], v[100:103], a[72:75], v[128:131]
    v_mfma_f32_16x16x32_bf16 v[132:135], v[100:103], a[76:79], v[132:135]
    s_waitcnt lgkmcnt(3)
    v_mfma_f32_16x16x32_bf16 v[128:131], v[104:107], a[80:83], v[128:131]
    v_mfma_f32_16x16x32_bf16 v[132:135], v[104:107], a[84:87], v[132:135]
    s_waitcnt lgkmcnt(2)
    v_mfma_f32_16x16x32_bf16 v[128:131], v[108:111], a[88:91], v[128:131]
    v_mfma_f32_16x16x32_bf16 v[132:135], v[108:111], a[92:95], v[132:135]
    s_waitcnt lgkmcnt(1)
    v_mfma_f32_16x16x32_bf16 v[128:131], v[112:115], a[96:99], v[128:131]
    v_mfma_f32_16x16x32_bf16 v[132:135], v[112:115], a[100:103], v[132:135]
    s_waitcnt lgkmcnt(0)
    v_mfma_f32_16x16x32_bf16 v[128:131], v[116:119], a[104:107], v[128:131]
    v_mfma_f32_16x16x32_bf16 v[132:135], v[116:119], a[108:111], v[132:135]
    s_nop 6
    v_mul_f32 v4, s82, v128
    v_exp_f32 v4, v4
    s_nop 0
    v_add_f32 v4, 1.0, v4
    v_rcp_f32 v4, v4
    v_mul_f32 v5, s82, v132
    v_exp_f32 v5, v5
    s_nop 0
    v_add_f32 v5, 1.0, v5
    v_rcp_f32 v5, v5
    v_lshlrev_b32 v8, 2, v3
    s_lshl_b32 s8, s77, 6
    s_add_u32 s8, s8, 0x1e0000
    buffer_store_dword v4, v8, s[56:59], s8 offen offset:0 sc1
    buffer_store_dword v5, v8, s[56:59], s8 offen offset:64 sc1
    s_nop 1
L_ngo:
    s_barrier
    v_and_b32 v4, 1, v2
    v_lshl_add_u32 v6, v4, 8, v24
    v_xor_b32 v7, 256, v6
    v_lshl_add_u32 v8, v4, 8, v25
    v_xor_b32 v9, 256, v8
    ds_read_b64_tr_b16 v[240:241], v6 offset:45056
    ds_read_b64_tr_b16 v[242:243], v7 offset:45056
    ds_read_b64_tr_b16 v[244:245], v8 offset:45056
    ds_read_b64_tr_b16 v[246:247], v9 offset:45056
    v_bfe_u32 v4, v3, 1, 2
    v_xor_b32 v4, v4, v2
    v_lshlrev_b32 v4, 4, v4
    v_lshl_add_u32 v4, v3, 6, v4
    s_lshl_b32 s8, s72, 11
    s_add_u32 s8, s8, 28672
    v_add_u32 v15, s8, v4
    v_cndmask_b32 v164, v164, 1.0, s[100:101]
    v_cvt_pk_bf16_f32 v248, v160, v161
    v_cvt_pk_bf16_f32 v249, v162, v163
    v_cvt_pk_bf16_f32 v250, v164, v165
    v_cvt_pk_bf16_f32 v251, v166, v167
    v_cndmask_b32 v172, v172, 1.0, s[100:101]
    v_cvt_pk_bf16_f32 v252, v168, v169
    v_cvt_pk_bf16_f32 v253, v170, v171
    v_cvt_pk_bf16_f32 v254, v172, v173
    v_cvt_pk_bf16_f32 v255, v174, v175
    ds_write_b128 v15, v[248:251] offset:16384
    ds_write_b128 v15, v[252:255] offset:17408
    v_cvt_pk_bf16_f32 v192, v144, v145
    v_cvt_pk_bf16_f32 v193, v146, v147
    v_cvt_pk_bf16_f32 v194, v148, v149
    v_cvt_pk_bf16_f32 v195, v150, v151
    v_cvt_pk_bf16_f32 v216, v152, v153
    v_cvt_pk_bf16_f32 v217, v154, v155
    v_cvt_pk_bf16_f32 v218, v156, v157
    v_cvt_pk_bf16_f32 v219, v158, v159
    s_waitcnt lgkmcnt(0)
    v_mfma_f32_16x16x32_bf16 v[196:199], v[240:243], v[192:195], 0
    v_mfma_f32_16x16x32_bf16 v[200:203], v[244:247], v[192:195], 0
    v_mfma_f32_16x16x32_bf16 v[220:223], v[240:243], v[216:219], 0
    v_mfma_f32_16x16x32_bf16 v[224:227], v[244:247], v[216:219], 0
    v_mov_b32 v14, 0xf149f2ca
    v_cndmask_b32 v14, 0, v14, s[100:101]
    s_nop 2
    v_max3_f32 v64, v196, v197, v198
    s_nop 0
    v_max3_f32 v96, v220, v221, v222
    v_max3_f32 v66, -v196, -v197, -v198
    v_max3_f32 v98, -v220, -v221, -v222
    v_max3_f32 v64, v64, v199, v200
    v_max3_f32 v96, v96, v223, v224
    v_max3_f32 v66, v66, -v199, -v200
    v_max3_f32 v98, v98, -v223, -v224
    v_max3_f32 v64, v64, v201, v202
    v_max3_f32 v96, v96, v225, v226
    v_max3_f32 v66, v66, -v201, -v202
    v_max3_f32 v98, v98, -v225, -v226
    v_max_f32 v64, v64, v203
    v_max_f32 v96, v96, v227
    v_max_f32_e64 v66, v66, -v203
    v_max_f32_e64 v98, v98, -v227
    s_nop 0
    v_permlane32_swap_b32 v64, v66
    v_permlane32_swap_b32 v96, v98
    v_max_f32 v64, v64, v66
    v_max_f32 v96, v96, v98
    v_mov_b32 v66, v64
    v_mov_b32 v98, v96
    s_nop 0
    v_permlane16_swap_b32 v64, v66
    v_permlane16_swap_b32 v96, v98
    v_max_f32 v64, v64, v66
    v_max_f32 v96, v96, v98
    v_mul_f32 v64, s82, v64
    v_mul_f32 v96, s82, v96
    v_mov_b32 v66, v64
    v_mov_b32 v98, v96
    s_nop 0
    v_permlane32_swap_b32 v64, v66
    v_permlane32_swap_b32 v96, v98
    v_add_f32 v68, v64, v14
    v_add_f32 v100, v96, v14
    v_add_f32 v70, v66, v14
    v_add_f32 v102, v98, v14
    v_pk_fma_f32 v[76:77], v[196:197], s[80:81], v[64:65] op_sel_hi:[1,1,0]
    v_pk_fma_f32 v[108:109], v[220:221], s[80:81], v[96:97] op_sel_hi:[1,1,0]
    v_pk_fma_f32 v[84:85], v[196:197], s[82:83], v[66:67] op_sel_hi:[1,1,0]
    v_pk_fma_f32 v[116:117], v[220:221], s[82:83], v[98:99] op_sel_hi:[1,1,0]
    v_pk_fma_f32 v[78:79], v[198:199], s[80:81], v[64:65] op_sel_hi:[1,1,0]
    v_pk_fma_f32 v[110:111], v[222:223], s[80:81], v[96:97] op_sel_hi:[1,1,0]
    v_pk_fma_f32 v[86:87], v[198:199], s[82:83], v[66:67] op_sel_hi:[1,1,0]
    v_pk_fma_f32 v[118:119], v[222:223], s[82:83], v[98:99] op_sel_hi:[1,1,0]
    v_pk_fma_f32 v[80:81], v[200:201], s[80:81], v[68:69] op_sel_hi:[1,1,0]
    v_pk_fma_f32 v[112:113], v[224:225], s[80:81], v[100:101] op_sel_hi:[1,1,0]
    v_pk_fma_f32 v[88:89], v[200:201], s[82:83], v[70:71] op_sel_hi:[1,1,0]
    v_pk_fma_f32 v[120:121], v[224:225], s[82:83], v[102:103] op_sel_hi:[1,1,0]
    v_pk_fma_f32 v[82:83], v[202:203], s[80:81], v[68:69] op_sel_hi:[1,1,0]
    v_pk_fma_f32 v[114:115], v[226:227], s[80:81], v[100:101] op_sel_hi:[1,1,0]
    v_pk_fma_f32 v[90:91], v[202:203], s[82:83], v[70:71] op_sel_hi:[1,1,0]
    v_pk_fma_f32 v[122:123], v[226:227], s[82:83], v[102:103] op_sel_hi:[1,1,0]
    v_exp_f32 v76, v76
    v_exp_f32 v108, v108
    v_exp_f32 v84, v84
    v_exp_f32 v116, v116
    v_exp_f32 v77, v77
    v_exp_f32 v109, v109
    v_exp_f32 v85, v85
    v_exp_f32 v117, v117
    v_exp_f32 v78, v78
    v_exp_f32 v110, v110
    v_exp_f32 v86, v86
    v_exp_f32 v118, v118
    v_exp_f32 v79, v79
    v_exp_f32 v111, v111
    v_exp_f32 v87, v87
    v_exp_f32 v119, v119
    v_exp_f32 v80, v80
    v_exp_f32 v112, v112
    v_exp_f32 v88, v88
    v_exp_f32 v120, v120
    v_exp_f32 v81, v81
    v_exp_f32 v113, v113
    v_exp_f32 v89, v89
    v_exp_f32 v121, v121
    v_exp_f32 v82, v82
    v_exp_f32 v114, v114
    v_exp_f32 v90, v90
    v_exp_f32 v122, v122
    v_exp_f32 v83, v83
    v_exp_f32 v115, v115
    v_exp_f32 v91, v91
    v_exp_f32 v123, v123
    v_pk_add_f32 v[72:73], v[76:77], v[78:79]
    v_pk_add_f32 v[104:105], v[108:109], v[110:111]
    v_pk_add_f32 v[74:75], v[84:85], v[86:87]
    v_pk_add_f32 v[106:107], v[116:117], v[118:119]
    v_pk_add_f32 v[68:69], v[80:81], v[82:83]
    v_pk_add_f32 v[100:101], v[112:113], v[114:115]
    v_pk_add_f32 v[70:71], v[88:89], v[90:91]
    v_pk_add_f32 v[102:103], v[120:121], v[122:123]
    v_pk_add_f32 v[72:73], v[72:73], v[68:69]
    v_pk_add_f32 v[104:105], v[104:105], v[100:101]
    v_pk_add_f32 v[74:75], v[74:75], v[70:71]
    v_pk_add_f32 v[106:107], v[106:107], v[102:103]
    v_add_f32 v64, v72, v73
    v_add_f32 v96, v104, v105
    v_add_f32 v66, v74, v75
    v_add_f32 v98, v106, v107
    s_nop 0
    v_permlane32_swap_b32 v64, v66
    v_permlane32_swap_b32 v96, v98
    v_add_f32 v64, v64, v66
    v_add_f32 v96, v96, v98
    v_mov_b32 v66, v64
    v_mov_b32 v98, v96
    s_nop 0
    v_permlane16_swap_b32 v64, v66
    v_permlane16_swap_b32 v96, v98
    v_add_f32 v64, v64, v66
    v_add_f32 v96, v96, v98
    v_rcp_f32 v64, v64
    v_rcp_f32 v96, v96
    v_mov_b32 v66, v64
    v_mov_b32 v98, v96
    s_nop 0
    v_permlane32_swap_b32 v64, v66
    v_permlane32_swap_b32 v96, v98
    v_pk_mul_f32 v[76:77], v[76:77], v[64:65] op_sel_hi:[1,0]
    v_pk_mul_f32 v[108:109], v[108:109], v[96:97] op_sel_hi:[1,0]
    v_pk_mul_f32 v[84:85], v[84:85], v[66:67] op_sel_hi:[1,0]
    v_pk_mul_f32 v[116:117], v[116:117], v[98:99] op_sel_hi:[1,0]
    v_pk_mul_f32 v[78:79], v[78:79], v[64:65] op_sel_hi:[1,0]
    v_pk_mul_f32 v[110:111], v[110:111], v[96:97] op_sel_hi:[1,0]
    v_pk_mul_f32 v[86:87], v[86:87], v[66:67] op_sel_hi:[1,0]
    v_pk_mul_f32 v[118:119], v[118:119], v[98:99] op_sel_hi:[1,0]
    v_pk_mul_f32 v[80:81], v[80:81], v[64:65] op_sel_hi:[1,0]
    v_pk_mul_f32 v[112:113], v[112:113], v[96:97] op_sel_hi:[1,0]
    v_pk_mul_f32 v[88:89], v[88:89], v[66:67] op_sel_hi:[1,0]
    v_pk_mul_f32 v[120:121], v[120:121], v[98:99] op_sel_hi:[1,0]
    v_pk_mul_f32 v[82:83], v[82:83], v[64:65] op_sel_hi:[1,0]
    v_pk_mul_f32 v[114:115], v[114:115], v[96:97] op_sel_hi:[1,0]
    v_pk_mul_f32 v[90:91], v[90:91], v[66:67] op_sel_hi:[1,0]
    v_pk_mul_f32 v[122:123], v[122:123], v[98:99] op_sel_hi:[1,0]
    v_cvt_pk_bf16_f32 v204, v76, v77
    v_cvt_pk_bf16_f32 v228, v108, v109
    v_cvt_pk_bf16_f32 v208, v84, v85
    v_cvt_pk_bf16_f32 v232, v116, v117
    v_cvt_pk_bf16_f32 v205, v78, v79
    v_cvt_pk_bf16_f32 v229, v110, v111
    v_cvt_pk_bf16_f32 v209, v86, v87
    v_cvt_pk_bf16_f32 v233, v118, v119
    v_cvt_pk_bf16_f32 v206, v80, v81
    v_cvt_pk_bf16_f32 v230, v112, v113
    v_cvt_pk_bf16_f32 v210, v88, v89
    v_cvt_pk_bf16_f32 v234, v120, v121
    v_cvt_pk_bf16_f32 v207, v82, v83
    v_cvt_pk_bf16_f32 v231, v114, v115
    v_cvt_pk_bf16_f32 v211, v90, v91
    v_cvt_pk_bf16_f32 v235, v122, v123
    ds_write_b128 v15, v[204:207] offset:0
    ds_write_b128 v15, v[208:211] offset:8192
    ds_write_b128 v15, v[228:231] offset:1024
    ds_write_b128 v15, v[232:235] offset:9216
    v_bfe_u32 v4, v1, 2, 2
    v_and_b32 v5, 3, v1
    v_lshl_add_u32 v6, v2, 3, v4
    v_lshlrev_b32 v6, 6, v6
    v_lshrrev_b32 v7, 1, v4
    v_xor_b32 v7, v7, v5
    v_lshl_add_u32 v6, v7, 4, v6
    v_xor_b32 v7, 32, v6
    v_add_u32 v7, 256, v7
    s_lshr_b32 s8, s72, 1
    s_lshl_b32 s8, s8, 13
    s_add_u32 s8, s8, 28672
    s_and_b32 s9, s72, 1
    s_lshl_b32 s9, s9, 3
    s_add_u32 s9, s9, 45056
    v_add_u32 v8, s8, v6
    v_add_u32 v9, s8, v7
    v_add_u32 v10, s9, v6
    v_add_u32 v11, s9, v7
    s_waitcnt lgkmcnt(0)
    s_barrier
    ds_read_b64_tr_b16 v[64:65], v8 offset:0
    ds_read_b64_tr_b16 v[66:67], v9 offset:0
    ds_read_b64_tr_b16 v[68:69], v8 offset:8
    ds_read_b64_tr_b16 v[70:71], v9 offset:8
    ds_read_b64_tr_b16 v[72:73], v10 offset:0
    ds_read_b64_tr_b16 v[74:75], v11 offset:0
    ds_read_b64_tr_b16 v[76:77], v8 offset:2048
    ds_read_b64_tr_b16 v[78:79], v9 offset:2048
    ds_read_b64_tr_b16 v[80:81], v8 offset:2056
    ds_read_b64_tr_b16 v[82:83], v9 offset:2056
    ds_read_b64_tr_b16 v[84:85], v10 offset:2048
    ds_read_b64_tr_b16 v[86:87], v11 offset:2048
    ds_read_b64_tr_b16 v[88:89], v8 offset:4096
    ds_read_b64_tr_b16 v[90:91], v9 offset:4096
    ds_read_b64_tr_b16 v[92:93], v8 offset:4104
    ds_read_b64_tr_b16 v[94:95], v9 offset:4104
    ds_read_b64_tr_b16 v[96:97], v10 offset:4096
    ds_read_b64_tr_b16 v[98:99], v11 offset:4096
    ds_read_b64_tr_b16 v[100:101], v8 offset:6144
    ds_read_b64_tr_b16 v[102:103], v9 offset:6144
    ds_read_b64_tr_b16 v[104:105], v8 offset:6152
    ds_read_b64_tr_b16 v[106:107], v9 offset:6152
    ds_read_b64_tr_b16 v[108:109], v10 offset:6144
    ds_read_b64_tr_b16 v[110:111], v11 offset:6144
    s_lshl_b32 s10, s73, 4
    s_add_u32 s10, s10, s74
    s_lshl_b32 s10, s10, 2
    s_add_u32 s10, s10, s72
    s_lshl_b32 s10, s10, 11
    s_add_u32 s10, s10, 0x480000
    s_waitcnt lgkmcnt(15)
    v_mfma_f32_16x16x32_bf16 v[192:195], v[64:67], v[72:75], 0
    v_mfma_f32_16x16x32_bf16 v[196:199], v[68:71], v[72:75], 0
    s_waitcnt lgkmcnt(12)
    v_mfma_f32_16x16x32_bf16 v[192:195], v[76:79], v[84:87], v[192:195]
    v_mfma_f32_16x16x32_bf16 v[196:199], v[80:83], v[84:87], v[196:199]
    s_waitcnt lgkmcnt(6)
    v_mfma_f32_16x16x32_bf16 v[192:195], v[88:91], v[96:99], v[192:195]
    v_mfma_f32_16x16x32_bf16 v[196:199], v[92:95], v[96:99], v[196:199]
    s_waitcnt lgkmcnt(0)
    v_mfma_f32_16x16x32_bf16 v[192:195], v[100:103], v[108:111], v[192:195]
    v_mfma_f32_16x16x32_bf16 v[196:199], v[104:107], v[108:111], v[196:199]
    s_nop 6
    buffer_store_dwordx4 v[192:195], v16, s[56:59], s10 offen offset:0 sc1
    buffer_store_dwordx4 v[196:199], v16, s[56:59], s10 offen offset:1024 sc1
    s_barrier
    s_mov_b32 s64, s30
    s_and_b32 s65, s31, 0xffff
    s_mov_b32 s66, 0x188000
    s_mov_b32 s67, 0x00020000
    s_sub_u32 s97, s93, 16
    s_cmp_lt_u32 s97, 14
    s_cselect_b32 s66, s66, 0
    s_cselect_b32 s97, s97, 0
    s_mul_i32 s8, s72, 28672
    s_lshl_b32 s9, s97, 8
    s_add_u32 s94, s8, s9
    s_waitcnt vmcnt(9)
    v_readfirstlane_b32 s8, v61
    s_cmp_ge_u32 s8, 32
    s_nop 3
    s_cbranch_scc1 L_root_ok_s
    s_mov_b32 s68, s38
    s_and_b32 s69, s39, 0xffff
    s_mov_b32 s70, 0x100
    s_mov_b32 s71, 0x00020000
    s_mov_b32 s9, 0
    v_mov_b32 v56, 252
    s_nop 4
L_root_poll_s:
    buffer_load_dword v59, v56, s[68:71], 0 offen sc1
    s_add_u32 s9, s9, 1
    s_waitcnt vmcnt(0)
    v_readfirstlane_b32 s8, v59
    s_cmp_ge_u32 s8, 32
    s_nop 3
    s_cbranch_scc1 L_root_ok_s
    s_cmp_lt_u32 s9, 20000
    s_nop 0
    s_cbranch_scc1 L_root_poll_s
    s_nop 0
L_root_ok_s:
    s_waitcnt vmcnt(0)
    s_mov_b64 exec, 0x3
    buffer_atomic_add v63, v31, s[56:59], 0 offen offset:0 sc1
    s_mov_b64 exec, -1
    s_waitcnt vmcnt(9)
    s_barrier
    ds_read_b64_tr_b16 v[64:65], v20 offset:0
    ds_read_b64_tr_b16 v[66:67], v20 offset:256
    ds_read_b64_tr_b16 v[68:69], v21 offset:0
    ds_read_b64_tr_b16 v[70:71], v21 offset:256
    s_waitcnt lgkmcnt(0)
    v_mfma_f32_16x16x32_bf16 v[176:179], v[64:67], a[0:3], 0
    ds_read_b64_tr_b16 v[80:81], v20 offset:2048
    ds_read_b64_tr_b16 v[82:83], v20 offset:2304
    v_mfma_f32_16x16x32_bf16 v[184:187], v[64:67], a[4:7], 0
    ds_read_b64_tr_b16 v[84:85], v21 offset:2048
    ds_read_b64_tr_b16 v[86:87], v21 offset:2304
    v_mfma_f32_16x16x32_bf16 v[180:183], v[68:71], a[0:3], 0
    s_add_u32 m0, s90, 28672
    s_add_u32 s42, s94, 0
    v_mfma_f32_16x16x32_bf16 v[188:191], v[68:71], a[4:7], 0
    s_waitcnt lgkmcnt(0)
    v_mfma_f32_16x16x32_bf16 v[176:179], v[80:83], a[8:11], v[176:179]
    s_waitcnt vmcnt(8)
    s_barrier
    ds_read_b64_tr_b16 v[64:65], v20 offset:4096
    ds_read_b64_tr_b16 v[66:67], v20 offset:4352
    v_mfma_f32_16x16x32_bf16 v[184:187], v[80:83], a[12:15], v[184:187]
    ds_read_b64_tr_b16 v[68:69], v21 offset:4096
    ds_read_b64_tr_b16 v[70:71], v21 offset:4352
    v_mfma_f32_16x16x32_bf16 v[180:183], v[84:87], a[8:11], v[180:183]
    buffer_load_dwordx4 v30, s[64:67], s42 offen lds
    v_mfma_f32_16x16x32_bf16 v[188:191], v[84:87], a[12:15], v[188:191]
    s_waitcnt lgkmcnt(0)
    v_mfma_f32_16x16x32_bf16 v[176:179], v[64:67], a[16:19], v[176:179]
    ds_read_b64_tr_b16 v[80:81], v20 offset:6144
    ds_read_b64_tr_b16 v[82:83], v20 offset:6400
    v_mfma_f32_16x16x32_bf16 v[184:187], v[64:67], a[20:23], v[184:187]
    ds_read_b64_tr_b16 v[84:85], v21 offset:6144
    ds_read_b64_tr_b16 v[86:87], v21 offset:6400
    v_mfma_f32_16x16x32_bf16 v[180:183], v[68:71], a[16:19], v[180:183]
    s_add_u32 m0, s90, 32768
    s_add_u32 s42, s94, 128
    v_mfma_f32_16x16x32_bf16 v[188:191], v[68:71], a[20:23], v[188:191]
    s_waitcnt lgkmcnt(0)
    v_mfma_f32_16x16x32_bf16 v[176:179], v[80:83], a[24:27], v[176:179]
    s_waitcnt vmcnt(8)
    s_barrier
    ds_read_b64_tr_b16 v[64:65], v20 offset:8192
    ds_read_b64_tr_b16 v[66:67], v20 offset:8448
    v_mfma_f32_16x16x32_bf16 v[184:187], v[80:83], a[28:31], v[184:187]
    ds_read_b64_tr_b16 v[68:69], v21 offset:8192
    ds_read_b64_tr_b16 v[70:71], v21 offset:8448
    v_mfma_f32_16x16x32_bf16 v[180:183], v[84:87], a[24:27], v[180:183]
    buffer_load_dwordx4 v30, s[64:67], s42 offen lds
    v_mfma_f32_16x16x32_bf16 v[188:191], v[84:87], a[28:31], v[188:191]
    s_waitcnt lgkmcnt(0)
    v_mfma_f32_16x16x32_bf16 v[176:179], v[64:67], a[32:35], v[176:179]
    ds_read_b64_tr_b16 v[80:81], v20 offset:10240
    ds_read_b64_tr_b16 v[82:83], v20 offset:10496
    v_mfma_f32_16x16x32_bf16 v[184:187], v[64:67], a[36:39], v[184:187]
    ds_read_b64_tr_b16 v[84:85], v21 offset:10240
    ds_read_b64_tr_b16 v[86:87], v21 offset:10496
    v_mfma_f32_16x16x32_bf16 v[180:183], v[68:71], a[32:35], v[180:183]
    s_add_u32 m0, s90, 36864
    s_add_u32 s42, s94, 114688
    v_mfma_f32_16x16x32_bf16 v[188:191], v[68:71], a[36:39], v[188:191]
    s_waitcnt lgkmcnt(0)
    v_mfma_f32_16x16x32_bf16 v[176:179], v[80:83], a[40:43], v[176:179]
    s_waitcnt vmcnt(8)
    s_barrier
    ds_read_b64_tr_b16 v[64:65], v20 offset:12288
    ds_read_b64_tr_b16 v[66:67], v20 offset:12544
    v_mfma_f32_16x16x32_bf16 v[184:187], v[80:83], a[44:47], v[184:187]
    ds_read_b64_tr_b16 v[68:69], v21 offset:12288
    ds_read_b64_tr_b16 v[70:71], v21 offset:12544
    v_mfma_f32_16x16x32_bf16 v[180:183], v[84:87], a[40:43], v[180:183]
    buffer_load_dwordx4 v30, s[64:67], s42 offen lds
    v_mfma_f32_16x16x32_bf16 v[188:191], v[84:87], a[44:47], v[188:191]
    s_waitcnt lgkmcnt(0)
    v_mfma_f32_16x16x32_bf16 v[176:179], v[64:67], a[48:51], v[176:179]
    ds_read_b64_tr_b16 v[80:81], v20 offset:14336
    ds_read_b64_tr_b16 v[82:83], v20 offset:14592
    v_mfma_f32_16x16x32_bf16 v[184:187], v[64:67], a[52:55], v[184:187]
    ds_read_b64_tr_b16 v[84:85], v21 offset:14336
    ds_read_b64_tr_b16 v[86:87], v21 offset:14592
    v_mfma_f32_16x16x32_bf16 v[180:183], v[68:71], a[48:51], v[180:183]
    s_add_u32 m0, s90, 40960
    s_add_u32 s42, s94, 114816
    v_mfma_f32_16x16x32_bf16 v[188:191], v[68:71], a[52:55], v[188:191]
    s_waitcnt lgkmcnt(0)
    v_mfma_f32_16x16x32_bf16 v[176:179], v[80:83], a[56:59], v[176:179]
    s_waitcnt vmcnt(8)
    s_barrier
    ds_read_b64_tr_b16 v[64:65], v20 offset:16384
    ds_read_b64_tr_b16 v[66:67], v20 offset:16640
    v_mfma_f32_16x16x32_bf16 v[184:187], v[80:83], a[60:63], v[184:187]
    ds_read_b64_tr_b16 v[68:69], v21 offset:16384
    ds_read_b64_tr_b16 v[70:71], v21 offset:16640
    v_mfma_f32_16x16x32_bf16 v[180:183], v[84:87], a[56:59], v[180:183]
    buffer_load_dwordx4 v30, s[64:67], s42 offen lds
    v_mfma_f32_16x16x32_bf16 v[188:191], v[84:87], a[60:63], v[188:191]
    s_waitcnt lgkmcnt(0)
    v_mfma_f32_16x16x32_bf16 v[176:179], v[64:67], a[64:67], v[176:179]
    ds_read_b64_tr_b16 v[80:81], v20 offset:18432
    ds_read_b64_tr_b16 v[82:83], v20 offset:18688
    v_mfma_f32_16x16x32_bf16 v[184:187], v[64:67], a[68:71], v[184:187]
    ds_read_b64_tr_b16 v[84:85], v21 offset:18432
    ds_read_b64_tr_b16 v[86:87], v21 offset:18688
    v_mfma_f32_16x16x32_bf16 v[180:183], v[68:71], a[64:67], v[180:183]
    s_add_u32 m0, s90, 45056
    s_add_u32 s42, s94, 229376
    v_mfma_f32_16x16x32_bf16 v[188:191], v[68:71], a[68:71], v[188:191]
    s_waitcnt lgkmcnt(0)
    v_mfma_f32_16x16x32_bf16 v[176:179], v[80:83], a[72:75], v[176:179]
    s_waitcnt vmcnt(8)
    s_barrier
    ds_read_b64_tr_b16 v[64:65], v20 offset:20480
    ds_read_b64_tr_b16 v[66:67], v20 offset:20736
    v_mfma_f32_16x16x32_bf16 v[184:187], v[80:83], a[76:79], v[184:187]
    ds_read_b64_tr_b16 v[68:69], v21 offset:20480
    ds_read_b64_tr_b16 v[70:71], v21 offset:20736
    v_mfma_f32_16x16x32_bf16 v[180:183], v[84:87], a[72:75], v[180:183]
    buffer_load_dwordx4 v30, s[64:67], s42 offen lds
    v_mfma_f32_16x16x32_bf16 v[188:191], v[84:87], a[76:79], v[188:191]
    s_waitcnt lgkmcnt(0)
    v_mfma_f32_16x16x32_bf16 v[176:179], v[64:67], a[80:83], v[176:179]
    ds_read_b64_tr_b16 v[80:81], v20 offset:22528
    ds_read_b64_tr_b16 v[82:83], v20 offset:22784
    v_mfma_f32_16x16x32_bf16 v[184:187], v[64:67], a[84:87], v[184:187]
    ds_read_b64_tr_b16 v[84:85], v21 offset:22528
    ds_read_b64_tr_b16 v[86:87], v21 offset:22784
    v_mfma_f32_16x16x32_bf16 v[180:183], v[68:71], a[80:83], v[180:183]
    s_add_u32 m0, s90, 49152
    s_add_u32 s42, s94, 229504
    v_mfma_f32_16x16x32_bf16 v[188:191], v[68:71], a[84:87], v[188:191]
    s_waitcnt lgkmcnt(0)
    v_mfma_f32_16x16x32_bf16 v[176:179], v[80:83], a[88:91], v[176:179]
    s_waitcnt vmcnt(8)
    s_barrier
    ds_read_b64_tr_b16 v[64:65], v20 offset:24576
    ds_read_b64_tr_b16 v[66:67], v20 offset:24832
    v_mfma_f32_16x16x32_bf16 v[184:187], v[80:83], a[92:95], v[184:187]
    ds_read_b64_tr_b16 v[68:69], v21 offset:24576
    ds_read_b64_tr_b16 v[70:71], v21 offset:24832
    v_mfma_f32_16x16x32_bf16 v[180:183], v[84:87], a[88:91], v[180:183]
    buffer_load_dwordx4 v30, s[64:67], s42 offen lds
    v_mfma_f32_16x16x32_bf16 v[188:191], v[84:87], a[92:95], v[188:191]
    s_waitcnt lgkmcnt(0)
    v_mfma_f32_16x16x32_bf16 v[176:179], v[64:67], a[96:99], v[176:179]
    ds_read_b64_tr_b16 v[80:81], v20 offset:26624
    ds_read_b64_tr_b16 v[82:83], v20 offset:26880
    v_mfma_f32_16x16x32_bf16 v[184:187], v[64:67], a[100:103], v[184:187]
    ds_read_b64_tr_b16 v[84:85], v21 offset:26624
    ds_read_b64_tr_b16 v[86:87], v21 offset:26880
    v_mfma_f32_16x16x32_bf16 v[180:183], v[68:71], a[96:99], v[180:183]
    s_add_u32 m0, s90, 53248
    s_add_u32 s42, s94, 344064
    v_mfma_f32_16x16x32_bf16 v[188:191], v[68:71], a[100:103], v[188:191]
    s_waitcnt lgkmcnt(0)
    v_mfma_f32_16x16x32_bf16 v[176:179], v[80:83], a[104:107], v[176:179]
    buffer_load_dwordx4 v30, s[64:67], s42 offen lds
    v_mfma_f32_16x16x32_bf16 v[184:187], v[80:83], a[108:111], v[184:187]
    s_add_u32 m0, s90, 57344
    s_add_u32 s42, s94, 344192
    v_mfma_f32_16x16x32_bf16 v[180:183], v[84:87], a[104:107], v[180:183]
    buffer_load_dwordx4 v30, s[64:67], s42 offen lds
    v_mfma_f32_16x16x32_bf16 v[188:191], v[84:87], a[108:111], v[188:191]
    s_nop 0
    v_cvt_pk_bf16_f32 v192, v176, v177
    v_cvt_pk_bf16_f32 v193, v178, v179
    s_nop 2
    v_cvt_pk_bf16_f32 v194, v180, v181
    v_cvt_pk_bf16_f32 v195, v182, v183
    v_cvt_pk_bf16_f32 v216, v184, v185
    v_cvt_pk_bf16_f32 v217, v186, v187
    v_cvt_pk_bf16_f32 v218, v188, v189
    v_cvt_pk_bf16_f32 v219, v190, v191
    s_waitcnt lgkmcnt(0)
    v_mfma_f32_16x16x32_bf16 v[196:199], v[240:243], v[192:195], 0
    v_mfma_f32_16x16x32_bf16 v[200:203], v[244:247], v[192:195], 0
    v_mfma_f32_16x16x32_bf16 v[220:223], v[240:243], v[216:219], 0
    v_mfma_f32_16x16x32_bf16 v[224:227], v[244:247], v[216:219], 0
    v_mov_b32 v14, 0xf149f2ca
    v_cndmask_b32 v14, 0, v14, s[100:101]
    s_nop 2
    v_max3_f32 v64, v196, v197, v198
    s_nop 0
    v_max3_f32 v144, v220, v221, v222
    v_max3_f32 v66, -v196, -v197, -v198
    v_max3_f32 v146, -v220, -v221, -v222
    s_add_u32 m0, s90, 61440
    s_add_u32 s42, s94, 458752
    buffer_load_dwordx4 v30, s[64:67], s42 offen lds
    v_max3_f32 v64, v64, v199, v200
    v_max3_f32 v144, v144, v223, v224
    v_max3_f32 v66, v66, -v199, -v200
    v_max3_f32 v146, v146, -v223, -v224
    s_add_u32 m0, s90, 65536
    s_add_u32 s42, s94, 458880
    buffer_load_dwordx4 v30, s[64:67], s42 offen lds
    v_max3_f32 v64, v64, v201, v202
    v_max3_f32 v144, v144, v225, v226
    v_max3_f32 v66, v66, -v201, -v202
    v_max3_f32 v146, v146, -v225, -v226
    s_add_u32 m0, s90, 69632
    s_add_u32 s42, s94, 573440
    buffer_load_dwordx4 v30, s[64:67], s42 offen lds
    v_max_f32 v64, v64, v203
    v_max_f32 v144, v144, v227
    v_max_f32_e64 v66, v66, -v203
    v_max_f32_e64 v146, v146, -v227
    s_add_u32 m0, s90, 73728
    s_add_u32 s42, s94, 573568
    buffer_load_dwordx4 v30, s[64:67], s42 offen lds
    v_permlane32_swap_b32 v64, v66
    v_permlane32_swap_b32 v144, v146
    v_max_f32 v64, v64, v66
    v_max_f32 v144, v144, v146
    s_add_u32 m0, s90, 77824
    s_add_u32 s42, s94, 688128
    buffer_load_dwordx4 v30, s[64:67], s42 offen lds
    v_mov_b32 v66, v64
    v_mov_b32 v146, v144
    s_nop 0
    v_permlane16_swap_b32 v64, v66
    v_permlane16_swap_b32 v144, v146
    s_add_u32 m0, s90, 81920
    s_add_u32 s42, s94, 688256
    buffer_load_dwordx4 v30, s[64:67], s42 offen lds
    v_max_f32 v64, v64, v66
    v_max_f32 v144, v144, v146
    v_mul_f32 v64, s82, v64
    v_mul_f32 v144, s82, v144
    s_add_u32 m0, s90, 86016
    s_add_u32 s42, s94, 802816
    buffer_load_dwordx4 v30, s[64:67], s42 offen lds
    v_mov_b32 v66, v64
    v_mov_b32 v146, v144
    s_nop 0
    v_permlane32_swap_b32 v64, v66
    v_permlane32_swap_b32 v144, v146
    s_add_u32 m0, s90, 90112
    s_add_u32 s42, s94, 802944
    buffer_load_dwordx4 v30, s[64:67], s42 offen lds
    v_add_f32 v68, v64, v14
    v_add_f32 v148, v144, v14
    v_add_f32 v70, v66, v14
    v_add_f32 v150, v146, v14
    s_add_u32 m0, s90, 94208
    s_add_u32 s42, s94, 917504
    buffer_load_dwordx4 v30, s[64:67], s42 offen lds
    v_pk_fma_f32 v[76:77], v[196:197], s[80:81], v[64:65] op_sel_hi:[1,1,0]
    v_pk_fma_f32 v[156:157], v[220:221], s[80:81], v[144:145] op_sel_hi:[1,1,0]
    v_pk_fma_f32 v[84:85], v[196:197], s[82:83], v[66:67] op_sel_hi:[1,1,0]
    v_pk_fma_f32 v[164:165], v[220:221], s[82:83], v[146:147] op_sel_hi:[1,1,0]
    s_add_u32 m0, s90, 98304
    s_add_u32 s42, s94, 917632
    buffer_load_dwordx4 v30, s[64:67], s42 offen lds
    v_pk_fma_f32 v[78:79], v[198:199], s[80:81], v[64:65] op_sel_hi:[1,1,0]
    v_pk_fma_f32 v[158:159], v[222:223], s[80:81], v[144:145] op_sel_hi:[1,1,0]
    v_pk_fma_f32 v[86:87], v[198:199], s[82:83], v[66:67] op_sel_hi:[1,1,0]
    v_pk_fma_f32 v[166:167], v[222:223], s[82:83], v[146:147] op_sel_hi:[1,1,0]
    s_add_u32 m0, s90, 102400
    s_add_u32 s42, s94, 1032192
    buffer_load_dwordx4 v30, s[64:67], s42 offen lds
    v_pk_fma_f32 v[80:81], v[200:201], s[80:81], v[68:69] op_sel_hi:[1,1,0]
    v_pk_fma_f32 v[160:161], v[224:225], s[80:81], v[148:149] op_sel_hi:[1,1,0]
    v_pk_fma_f32 v[88:89], v[200:201], s[82:83], v[70:71] op_sel_hi:[1,1,0]
    v_pk_fma_f32 v[168:169], v[224:225], s[82:83], v[150:151] op_sel_hi:[1,1,0]
    s_add_u32 m0, s90, 106496
    s_add_u32 s42, s94, 1032320
    buffer_load_dwordx4 v30, s[64:67], s42 offen lds
    v_pk_fma_f32 v[82:83], v[202:203], s[80:81], v[68:69] op_sel_hi:[1,1,0]
    v_pk_fma_f32 v[162:163], v[226:227], s[80:81], v[148:149] op_sel_hi:[1,1,0]
    v_pk_fma_f32 v[90:91], v[202:203], s[82:83], v[70:71] op_sel_hi:[1,1,0]
    v_pk_fma_f32 v[170:171], v[226:227], s[82:83], v[150:151] op_sel_hi:[1,1,0]
    s_add_u32 m0, s90, 110592
    s_add_u32 s42, s94, 1146880
    buffer_load_dwordx4 v30, s[64:67], s42 offen lds
    v_exp_f32 v76, v76
    v_exp_f32 v156, v156
    v_exp_f32 v84, v84
    v_exp_f32 v164, v164
    s_add_u32 m0, s90, 114688
    s_add_u32 s42, s94, 1147008
    buffer_load_dwordx4 v30, s[64:67], s42 offen lds
    v_exp_f32 v77, v77
    v_exp_f32 v157, v157
    v_exp_f32 v85, v85
    v_exp_f32 v165, v165
    s_add_u32 m0, s90, 118784
    s_add_u32 s42, s94, 1261568
    buffer_load_dwordx4 v30, s[64:67], s42 offen lds
    v_exp_f32 v78, v78
    v_exp_f32 v158, v158
    v_exp_f32 v86, v86
    v_exp_f32 v166, v166
    s_add_u32 m0, s90, 122880
    s_add_u32 s42, s94, 1261696
    buffer_load_dwordx4 v30, s[64:67], s42 offen lds
    v_exp_f32 v79, v79
    v_exp_f32 v159, v159
    v_exp_f32 v87, v87
    v_exp_f32 v167, v167
    s_add_u32 m0, s90, 126976
    s_add_u32 s42, s94, 1376256
    buffer_load_dwordx4 v30, s[64:67], s42 offen lds
    v_exp_f32 v80, v80
    v_exp_f32 v160, v160
    v_exp_f32 v88, v88
    v_exp_f32 v168, v168
    s_add_u32 m0, s90, 131072
    s_add_u32 s42, s94, 1376384
    buffer_load_dwordx4 v30, s[64:67], s42 offen lds
    v_exp_f32 v81, v81
    v_exp_f32 v161, v161
    v_exp_f32 v89, v89
    v_exp_f32 v169, v169
    s_add_u32 m0, s90, 135168
    s_add_u32 s42, s94, 1490944
    buffer_load_dwordx4 v30, s[64:67], s42 offen lds
    v_exp_f32 v82, v82
    v_exp_f32 v162, v162
    v_exp_f32 v90, v90
    v_exp_f32 v170, v170
    s_add_u32 m0, s90, 139264
    s_add_u32 s42, s94, 1491072
    buffer_load_dwordx4 v30, s[64:67], s42 offen lds
    v_exp_f32 v83, v83
    v_exp_f32 v163, v163
    v_exp_f32 v91, v91
    v_exp_f32 v171, v171
    v_pk_add_f32 v[72:73], v[76:77], v[78:79]
    v_pk_add_f32 v[152:153], v[156:157], v[158:159]
    v_pk_add_f32 v[74:75], v[84:85], v[86:87]
    v_pk_add_f32 v[154:155], v[164:165], v[166:167]
    v_pk_add_f32 v[68:69], v[80:81], v[82:83]
    v_pk_add_f32 v[148:149], v[160:161], v[162:163]
    v_pk_add_f32 v[70:71], v[88:89], v[90:91]
    v_pk_add_f32 v[150:151], v[168:169], v[170:171]
    v_pk_add_f32 v[72:73], v[72:73], v[68:69]
    v_pk_add_f32 v[152:153], v[152:153], v[148:149]
    v_pk_add_f32 v[74:75], v[74:75], v[70:71]
    v_pk_add_f32 v[154:155], v[154:155], v[150:151]
    v_add_f32 v64, v72, v73
    v_add_f32 v144, v152, v153
    v_add_f32 v66, v74, v75
    v_add_f32 v146, v154, v155
    s_nop 0
    v_permlane32_swap_b32 v64, v66
    v_permlane32_swap_b32 v144, v146
    v_add_f32 v64, v64, v66
    v_add_f32 v144, v144, v146
    v_mov_b32 v66, v64
    v_mov_b32 v146, v144
    s_nop 0
    v_permlane16_swap_b32 v64, v66
    v_permlane16_swap_b32 v144, v146
    v_add_f32 v64, v64, v66
    v_add_f32 v144, v144, v146
    v_rcp_f32 v64, v64
    v_rcp_f32 v144, v144
    v_mov_b32 v66, v64
    v_mov_b32 v146, v144
    s_nop 0
    v_permlane32_swap_b32 v64, v66
    v_permlane32_swap_b32 v144, v146
    v_pk_mul_f32 v[76:77], v[76:77], v[64:65] op_sel_hi:[1,0]
    v_pk_mul_f32 v[156:157], v[156:157], v[144:145] op_sel_hi:[1,0]
    v_pk_mul_f32 v[84:85], v[84:85], v[66:67] op_sel_hi:[1,0]
    v_pk_mul_f32 v[164:165], v[164:165], v[146:147] op_sel_hi:[1,0]
    v_pk_mul_f32 v[78:79], v[78:79], v[64:65] op_sel_hi:[1,0]
    v_pk_mul_f32 v[158:159], v[158:159], v[144:145] op_sel_hi:[1,0]
    v_pk_mul_f32 v[86:87], v[86:87], v[66:67] op_sel_hi:[1,0]
    v_pk_mul_f32 v[166:167], v[166:167], v[146:147] op_sel_hi:[1,0]
    v_pk_mul_f32 v[80:81], v[80:81], v[64:65] op_sel_hi:[1,0]
    v_pk_mul_f32 v[160:161], v[160:161], v[144:145] op_sel_hi:[1,0]
    v_pk_mul_f32 v[88:89], v[88:89], v[66:67] op_sel_hi:[1,0]
    v_pk_mul_f32 v[168:169], v[168:169], v[146:147] op_sel_hi:[1,0]
    v_pk_mul_f32 v[82:83], v[82:83], v[64:65] op_sel_hi:[1,0]
    v_pk_mul_f32 v[162:163], v[162:163], v[144:145] op_sel_hi:[1,0]
    v_pk_mul_f32 v[90:91], v[90:91], v[66:67] op_sel_hi:[1,0]
    v_pk_mul_f32 v[170:171], v[170:171], v[146:147] op_sel_hi:[1,0]
    v_cvt_pk_bf16_f32 v204, v76, v77
    v_cvt_pk_bf16_f32 v228, v156, v157
    v_cvt_pk_bf16_f32 v208, v84, v85
    v_cvt_pk_bf16_f32 v232, v164, v165
    v_cvt_pk_bf16_f32 v205, v78, v79
    v_cvt_pk_bf16_f32 v229, v158, v159
    v_cvt_pk_bf16_f32 v209, v86, v87
    v_cvt_pk_bf16_f32 v233, v166, v167
    v_cvt_pk_bf16_f32 v206, v80, v81
    v_cvt_pk_bf16_f32 v230, v160, v161
    v_cvt_pk_bf16_f32 v210, v88, v89
    v_cvt_pk_bf16_f32 v234, v168, v169
    v_cvt_pk_bf16_f32 v207, v82, v83
    v_cvt_pk_bf16_f32 v231, v162, v163
    v_cvt_pk_bf16_f32 v211, v90, v91
    v_cvt_pk_bf16_f32 v235, v170, v171
    v_accvgpr_write_b32 a240, v204
    v_accvgpr_write_b32 a241, v205
    v_accvgpr_write_b32 a242, v206
    v_accvgpr_write_b32 a243, v207
    v_accvgpr_write_b32 a244, v208
    v_accvgpr_write_b32 a245, v209
    v_accvgpr_write_b32 a246, v210
    v_accvgpr_write_b32 a247, v211
    v_accvgpr_write_b32 a248, v228
    v_accvgpr_write_b32 a249, v229
    v_accvgpr_write_b32 a250, v230
    v_accvgpr_write_b32 a251, v231
    v_accvgpr_write_b32 a252, v232
    v_accvgpr_write_b32 a253, v233
    v_accvgpr_write_b32 a254, v234
    v_accvgpr_write_b32 a255, v235
    s_and_b32 s10, s93, 15
    s_lshr_b32 s11, s93, 4
    s_lshl_b32 s8, s10, 13
    s_add_u32 s8, s8, 0x3c0014
    v_bfe_u32 v4, v1, 2, 1
    v_lshrrev_b32 v5, 3, v1
    v_lshl_add_u32 v4, v4, 3, v5
    v_and_b32 v5, 3, v1
    v_lshl_add_u32 v4, v4, 2, v5
    v_lshl_add_u32 v27, v4, 7, s8
    s_lshl_b32 s6, s10, 13
    s_lshl_b32 s7, s72, 11
    s_add_u32 s6, s6, s7
    s_add_u32 s6, s6, 0x480000
    s_lshl_b32 s7, s11, 10
    s_add_u32 s6, s6, s7
    s_mov_b32 s9, 0
    s_nop 0
L_pl_kvp:
    s_buffer_load_dword s79, s[56:59], s91 offset:0x1c glc
    s_add_u32 s9, s9, 1
    s_waitcnt lgkmcnt(0)
    s_cmp_ge_u32 s79, 16
    s_nop 0
    s_cbranch_scc1 L_pw_kvp
    s_cmp_lt_u32 s9, 40000
    s_nop 0
    s_cbranch_scc1 L_pl_kvp
    s_nop 0
L_pw_kvp:
    buffer_load_dwordx4 v[64:67], v16, s[56:59], s6 offen
    s_add_u32 s6, s6, 131072
    buffer_load_dwordx4 v[68:71], v16, s[56:59], s6 offen
    s_add_u32 s6, s6, 131072
    buffer_load_dwordx4 v[72:75], v16, s[56:59], s6 offen
    s_add_u32 s6, s6, 131072
    buffer_load_dwordx4 v[76:79], v16, s[56:59], s6 offen
    s_add_u32 s6, s6, 131072
    buffer_load_dwordx4 v[80:83], v16, s[56:59], s6 offen
    s_add_u32 s6, s6, 131072
    buffer_load_dwordx4 v[84:87], v16, s[56:59], s6 offen
    s_add_u32 s6, s6, 131072
    buffer_load_dwordx4 v[88:91], v16, s[56:59], s6 offen
    s_add_u32 s6, s6, 131072
    buffer_load_dwordx4 v[92:95], v16, s[56:59], s6 offen
    s_add_u32 s6, s6, 131072
    buffer_load_dwordx4 v[96:99], v16, s[56:59], s6 offen
    s_add_u32 s6, s6, 131072
    buffer_load_dwordx4 v[100:103], v16, s[56:59], s6 offen
    s_add_u32 s6, s6, 131072
    buffer_load_dwordx4 v[104:107], v16, s[56:59], s6 offen
    s_add_u32 s6, s6, 131072
    buffer_load_dwordx4 v[108:111], v16, s[56:59], s6 offen
    s_add_u32 s6, s6, 131072
    buffer_load_dwordx4 v[112:115], v16, s[56:59], s6 offen
    s_add_u32 s6, s6, 131072
    buffer_load_dwordx4 v[116:119], v16, s[56:59], s6 offen
    s_add_u32 s6, s6, 131072
    buffer_load_dwordx4 v[120:123], v16, s[56:59], s6 offen
    s_add_u32 s6, s6, 131072
    buffer_load_dwordx4 v[124:127], v16, s[56:59], s6 offen
    s_add_u32 s6, s6, 131072
    s_lshl_b32 s6, s10, 2
    s_add_u32 s6, s6, s72
    s_lshl_b32 s6, s6, 10
    s_add_u32 s6, s6, 0x1e2000
    s_lshl_b32 s7, s11, 3
    s_add_u32 s6, s6, s7
    s_waitcnt vmcnt(14)
    v_pk_add_f32 v[64:65], v[64:65], v[68:69]
    v_pk_add_f32 v[66:67], v[66:67], v[70:71]
    s_waitcnt vmcnt(13)
    v_pk_add_f32 v[64:65], v[64:65], v[72:73]
    v_pk_add_f32 v[66:67], v[66:67], v[74:75]
    s_waitcnt vmcnt(12)
    v_pk_add_f32 v[64:65], v[64:65], v[76:77]
    v_pk_add_f32 v[66:67], v[66:67], v[78:79]
    s_waitcnt vmcnt(11)
    v_pk_add_f32 v[64:65], v[64:65], v[80:81]
    v_pk_add_f32 v[66:67], v[66:67], v[82:83]
    s_waitcnt vmcnt(10)
    v_pk_add_f32 v[64:65], v[64:65], v[84:85]
    v_pk_add_f32 v[66:67], v[66:67], v[86:87]
    s_waitcnt vmcnt(9)
    v_pk_add_f32 v[64:65], v[64:65], v[88:89]
    v_pk_add_f32 v[66:67], v[66:67], v[90:91]
    s_waitcnt vmcnt(8)
    v_pk_add_f32 v[64:65], v[64:65], v[92:93]
    v_pk_add_f32 v[66:67], v[66:67], v[94:95]
    s_waitcnt vmcnt(7)
    v_pk_add_f32 v[64:65], v[64:65], v[96:97]
    v_pk_add_f32 v[66:67], v[66:67], v[98:99]
    s_waitcnt vmcnt(6)
    v_pk_add_f32 v[64:65], v[64:65], v[100:101]
    v_pk_add_f32 v[66:67], v[66:67], v[102:103]
    s_waitcnt vmcnt(5)
    v_pk_add_f32 v[64:65], v[64:65], v[104:105]
    v_pk_add_f32 v[66:67], v[66:67], v[106:107]
    s_waitcnt vmcnt(4)
    v_pk_add_f32 v[64:65], v[64:65], v[108:109]
    v_pk_add_f32 v[66:67], v[66:67], v[110:111]
    s_waitcnt vmcnt(3)
    v_pk_add_f32 v[64:65], v[64:65], v[112:113]
    v_pk_add_f32 v[66:67], v[66:67], v[114:115]
    s_waitcnt vmcnt(2)
    v_pk_add_f32 v[64:65], v[64:65], v[116:117]
    v_pk_add_f32 v[66:67], v[66:67], v[118:119]
    s_waitcnt vmcnt(1)
    v_pk_add_f32 v[64:65], v[64:65], v[120:121]
    v_pk_add_f32 v[66:67], v[66:67], v[122:123]
    s_waitcnt vmcnt(0)
    v_pk_add_f32 v[64:65], v[64:65], v[124:125]
    v_pk_add_f32 v[66:67], v[66:67], v[126:127]
    v_cvt_pk_bf16_f32 v192, v64, v65
    v_cvt_pk_bf16_f32 v193, v66, v67
    buffer_store_dwordx2 v[192:193], v16, s[56:59], s6 offen sc1
    s_waitcnt vmcnt(0)
    s_barrier
    s_cmp_lg_u32 s72, 0
    s_nop 0
    s_cbranch_scc1 L_s_k1
    buffer_atomic_add v63, v27, s[56:59], 0 offen offset:0 sc1
    s_nop 1
L_s_k1:
    s_cmp_lt_u32 s93, 16
    s_nop 0
    s_cbranch_scc1 L_s_o
    s_cmp_ge_u32 s93, 30
    s_nop 0
    s_cbranch_scc1 L_s_o
    s_lshr_b32 s8, s97, 1
    s_lshl_b32 s8, s8, 14
    s_and_b32 s9, s97, 1
    s_lshl_b32 s9, s9, 8
    s_add_u32 s8, s8, s9
    s_add_u32 s8, s8, 0x3c0010
    v_bfe_u32 v4, v1, 1, 2
    v_lshrrev_b32 v5, 3, v1
    v_lshl_add_u32 v4, v4, 3, v5
    v_and_b32 v5, 1, v1
    v_lshl_add_u32 v4, v4, 2, v5
    v_lshl_add_u32 v27, v4, 7, s8
    s_and_b32 s5, s72, 1
    s_cmp_eq_u32 s5, 1
    s_cselect_b64 s[10:11], -1, 0
    s_lshr_b32 s5, s72, 1
    s_lshl_b32 s5, s5, 12
    s_add_u32 s5, s5, 28672
    v_cndmask_b32 v128, v32, v36, s[10:11]
    v_add_u32 v128, s5, v128
    v_add_u32 v132, 57344, v128
    v_cndmask_b32 v129, v33, v37, s[10:11]
    v_add_u32 v129, s5, v129
    v_add_u32 v133, 57344, v129
    v_cndmask_b32 v130, v34, v38, s[10:11]
    v_add_u32 v130, s5, v130
    v_add_u32 v134, 57344, v130
    v_cndmask_b32 v131, v35, v39, s[10:11]
    v_add_u32 v131, s5, v131
    v_add_u32 v135, 57344, v131
    v_mov_b32 v136, 0x3f803f80
    v_mov_b32 v137, 0x3f803f80
    v_mov_b32 v138, 0x3f803f80
    v_mov_b32 v139, 0x3f803f80
    ds_read_b64_tr_b16 v[144:145], v128 offset:0
    ds_read_b64_tr_b16 v[146:147], v129 offset:0
    ds_read_b64_tr_b16 v[148:149], v130 offset:0
    ds_read_b64_tr_b16 v[150:151], v131 offset:0
    ds_read_b64_tr_b16 v[152:153], v128 offset:8192
    ds_read_b64_tr_b16 v[154:155], v129 offset:8192
    ds_read_b64_tr_b16 v[156:157], v130 offset:8192
    ds_read_b64_tr_b16 v[158:159], v131 offset:8192
    ds_read_b64_tr_b16 v[160:161], v128 offset:16384
    ds_read_b64_tr_b16 v[162:163], v129 offset:16384
    ds_read_b64_tr_b16 v[164:165], v130 offset:16384
    ds_read_b64_tr_b16 v[166:167], v131 offset:16384
    ds_read_b64_tr_b16 v[168:169], v128 offset:24576
    ds_read_b64_tr_b16 v[170:171], v129 offset:24576
    ds_read_b64_tr_b16 v[172:173], v130 offset:24576
    ds_read_b64_tr_b16 v[174:175], v131 offset:24576
    s_waitcnt lgkmcnt(12)
    v_mfma_f32_16x16x32_bf16 v[208:211], v[144:147], v[136:139], 0
    v_mfma_f32_16x16x32_bf16 v[212:215], v[148:151], v[136:139], 0
    ds_read_b64_tr_b16 v[176:177], v128 offset:32768
    ds_read_b64_tr_b16 v[178:179], v129 offset:32768
    ds_read_b64_tr_b16 v[180:181], v130 offset:32768
    ds_read_b64_tr_b16 v[182:183], v131 offset:32768
    s_waitcnt lgkmcnt(12)
    v_mfma_f32_16x16x32_bf16 v[208:211], v[152:155], v[136:139], v[208:211]
    v_mfma_f32_16x16x32_bf16 v[212:215], v[156:159], v[136:139], v[212:215]
    ds_read_b64_tr_b16 v[184:185], v128 offset:40960
    ds_read_b64_tr_b16 v[186:187], v129 offset:40960
    ds_read_b64_tr_b16 v[188:189], v130 offset:40960
    ds_read_b64_tr_b16 v[190:191], v131 offset:40960
    s_waitcnt lgkmcnt(12)
    v_mfma_f32_16x16x32_bf16 v[208:211], v[160:163], v[136:139], v[208:211]
    v_mfma_f32_16x16x32_bf16 v[212:215], v[164:167], v[136:139], v[212:215]
    ds_read_b64_tr_b16 v[192:193], v128 offset:49152
    ds_read_b64_tr_b16 v[194:195], v129 offset:49152
    ds_read_b64_tr_b16 v[196:197], v130 offset:49152
    ds_read_b64_tr_b16 v[198:199], v131 offset:49152
    s_waitcnt lgkmcnt(12)
    v_mfma_f32_16x16x32_bf16 v[208:211], v[168:171], v[136:139], v[208:211]
    v_mfma_f32_16x16x32_bf16 v[212:215], v[172:175], v[136:139], v[212:215]
    ds_read_b64_tr_b16 v[144:145], v132 offset:0
    ds_read_b64_tr_b16 v[146:147], v133 offset:0
    ds_read_b64_tr_b16 v[148:149], v134 offset:0
    ds_read_b64_tr_b16 v[150:151], v135 offset:0
    s_waitcnt lgkmcnt(12)
    v_mfma_f32_16x16x32_bf16 v[208:211], v[176:179], v[136:139], v[208:211]
    v_mfma_f32_16x16x32_bf16 v[212:215], v[180:183], v[136:139], v[212:215]
    ds_read_b64_tr_b16 v[152:153], v132 offset:8192
    ds_read_b64_tr_b16 v[154:155], v133 offset:8192
    ds_read_b64_tr_b16 v[156:157], v134 offset:8192
    ds_read_b64_tr_b16 v[158:159], v135 offset:8192
    s_waitcnt lgkmcnt(12)
    v_mfma_f32_16x16x32_bf16 v[208:211], v[184:187], v[136:139], v[208:211]
    v_mfma_f32_16x16x32_bf16 v[212:215], v[188:191], v[136:139], v[212:215]
    ds_read_b64_tr_b16 v[160:161], v132 offset:16384
    ds_read_b64_tr_b16 v[162:163], v133 offset:16384
    ds_read_b64_tr_b16 v[164:165], v134 offset:16384
    ds_read_b64_tr_b16 v[166:167], v135 offset:16384
    s_waitcnt lgkmcnt(12)
    v_mfma_f32_16x16x32_bf16 v[208:211], v[192:195], v[136:139], v[208:211]
    v_mfma_f32_16x16x32_bf16 v[212:215], v[196:199], v[136:139], v[212:215]
    ds_read_b64_tr_b16 v[168:169], v132 offset:24576
    ds_read_b64_tr_b16 v[170:171], v133 offset:24576
    ds_read_b64_tr_b16 v[172:173], v134 offset:24576
    ds_read_b64_tr_b16 v[174:175], v135 offset:24576
    s_waitcnt lgkmcnt(12)
    v_mfma_f32_16x16x32_bf16 v[208:211], v[144:147], v[136:139], v[208:211]
    v_mfma_f32_16x16x32_bf16 v[212:215], v[148:151], v[136:139], v[212:215]
    ds_read_b64_tr_b16 v[176:177], v132 offset:32768
    ds_read_b64_tr_b16 v[178:179], v133 offset:32768
    ds_read_b64_tr_b16 v[180:181], v134 offset:32768
    ds_read_b64_tr_b16 v[182:183], v135 offset:32768
    s_waitcnt lgkmcnt(12)
    v_mfma_f32_16x16x32_bf16 v[208:211], v[152:155], v[136:139], v[208:211]
    v_mfma_f32_16x16x32_bf16 v[212:215], v[156:159], v[136:139], v[212:215]
    ds_read_b64_tr_b16 v[184:185], v132 offset:40960
    ds_read_b64_tr_b16 v[186:187], v133 offset:40960
    ds_read_b64_tr_b16 v[188:189], v134 offset:40960
    ds_read_b64_tr_b16 v[190:191], v135 offset:40960
    s_waitcnt lgkmcnt(12)
    v_mfma_f32_16x16x32_bf16 v[208:211], v[160:163], v[136:139], v[208:211]
    v_mfma_f32_16x16x32_bf16 v[212:215], v[164:167], v[136:139], v[212:215]
    ds_read_b64_tr_b16 v[192:193], v132 offset:49152
    ds_read_b64_tr_b16 v[194:195], v133 offset:49152
    ds_read_b64_tr_b16 v[196:197], v134 offset:49152
    ds_read_b64_tr_b16 v[198:199], v135 offset:49152
    s_waitcnt lgkmcnt(12)
    v_mfma_f32_16x16x32_bf16 v[208:211], v[168:171], v[136:139], v[208:211]
    v_mfma_f32_16x16x32_bf16 v[212:215], v[172:175], v[136:139], v[212:215]
    s_waitcnt lgkmcnt(8)
    v_mfma_f32_16x16x32_bf16 v[208:211], v[176:179], v[136:139], v[208:211]
    v_mfma_f32_16x16x32_bf16 v[212:215], v[180:183], v[136:139], v[212:215]
    s_waitcnt lgkmcnt(4)
    v_mfma_f32_16x16x32_bf16 v[208:211], v[184:187], v[136:139], v[208:211]
    v_mfma_f32_16x16x32_bf16 v[212:215], v[188:191], v[136:139], v[212:215]
    s_waitcnt lgkmcnt(0)
    v_mfma_f32_16x16x32_bf16 v[208:211], v[192:195], v[136:139], v[208:211]
    v_mfma_f32_16x16x32_bf16 v[212:215], v[196:199], v[136:139], v[212:215]
    v_lshlrev_b32 v6, 4, v2
    s_lshl_b32 s6, s97, 9
    s_lshl_b32 s7, s72, 7
    s_add_u32 s6, s6, s7
    s_add_u32 s6, s6, 0x1f2000
    s_nop 1
    buffer_store_dwordx4 v[208:211], v6, s[56:59], s6 offen offset:0 sc1
    buffer_store_dwordx4 v[212:215], v6, s[56:59], s6 offen offset:64 sc1
    s_waitcnt vmcnt(0)
    s_barrier
    s_cmp_lg_u32 s72, 0
    s_nop 0
    s_cbranch_scc1 L_s_o
    buffer_atomic_add v63, v27, s[56:59], 0 offen offset:0 sc1
    s_nop 1
L_s_o:
    s_and_b32 s5, s93, 7
    s_lshl_b32 s5, s5, 9
    s_add_u32 s6, s5, 0x3c0014
    s_add_u32 s5, s5, 0x3c0010
    v_lshrrev_b32 v4, 2, v1
    v_lshl_add_u32 v216, v4, 13, s6
    v_lshrrev_b32 v5, 3, v1
    v_lshl_add_u32 v217, v5, 14, s5
    v_and_b32 v4, 1, v4
    v_lshl_add_u32 v217, v4, 8, v217
    s_lshl_b32 s5, s72, 8
    s_add_u32 s5, s5, 0x1e2000
    v_lshl_add_u32 v218, v1, 10, s5
    s_mov_b32 s5, 0x1f2000
    v_lshl_add_u32 v219, v1, 7, s5
    s_mov_b64 s[12:13], 0
    s_mov_b64 s[14:15], 0
    s_mov_b32 s9, 0
    s_nop 1
L_pl_sk:
    s_buffer_load_dword s28, s[56:59], s91 offset:0x14 glc
    s_add_u32 s9, s9, 1
    s_waitcnt lgkmcnt(0)
    s_cmp_ge_u32 s28, 2
    s_nop 0
    s_cbranch_scc1 L_pw_sk
    s_cmp_lt_u32 s9, 40000
    s_nop 0
    s_cbranch_scc1 L_pl_sk
    s_nop 0
L_pw_sk:
    buffer_load_dword v220, v216, s[56:59], 0 offen sc1
    buffer_load_dword v221, v217, s[56:59], 0 offen sc1
    s_lshl_b32 s8, s74, 12
    s_add_u32 s8, s8, 0x1e2000
    v_lshlrev_b32 v6, 8, v2
    buffer_load_dwordx4 a[224:227], v16, s[56:59], s8 offen offset:0
    buffer_load_dwordx4 a[228:231], v16, s[56:59], s8 offen offset:1024
    buffer_load_dwordx4 a[232:235], v16, s[56:59], s8 offen offset:2048
    buffer_load_dwordx4 a[236:239], v16, s[56:59], s8 offen offset:3072
    buffer_load_dwordx4 v[112:115], v6, s[56:59], s8 offen offset:1216
    buffer_load_dwordx4 v[116:119], v6, s[56:59], s8 offen offset:3264
    s_waitcnt vmcnt(6)
    v_cmp_le_u32 vcc, 2, v220
    v_cmp_le_u32 s[6:7], 1, v221
    s_andn2_b64 exec, vcc, s[12:13]
    s_or_b64 s[12:13], s[12:13], vcc
    buffer_load_dword v222, v218, s[56:59], 0 offen offset:0
    buffer_load_dword v222, v218, s[56:59], 0 offen offset:128
    s_andn2_b64 exec, s[6:7], s[14:15]
    s_or_b64 s[14:15], s[14:15], s[6:7]
    buffer_load_dword v222, v219, s[56:59], 0 offen
    s_mov_b64 exec, -1
    buffer_load_dword v220, v216, s[56:59], 0 offen sc1
    buffer_load_dword v221, v217, s[56:59], 0 offen sc1
    s_waitcnt vmcnt(2)
    s_lshl_b32 s10, s77, 4
    s_add_u32 s10, s10, s74
    s_lshl_b32 s10, s10, 10
    s_add_u32 s10, s10, 0x700000
    s_add_u32 s11, s10, 16384
    v_mfma_f32_16x16x32_bf16 v[136:139], v[112:115], a[240:243], 0
    v_mfma_f32_16x16x32_bf16 v[128:131], a[224:227], a[240:243], 0
    v_mfma_f32_16x16x32_bf16 v[132:135], a[228:231], a[240:243], 0
    v_mfma_f32_16x16x32_bf16 v[152:155], v[112:115], a[248:251], 0
    v_mfma_f32_16x16x32_bf16 v[144:147], a[224:227], a[248:251], 0
    v_mfma_f32_16x16x32_bf16 v[148:151], a[228:231], a[248:251], 0
    v_mfma_f32_16x16x32_bf16 v[136:139], v[116:119], a[244:247], v[136:139]
    v_mfma_f32_16x16x32_bf16 v[128:131], a[232:235], a[244:247], v[128:131]
    v_mfma_f32_16x16x32_bf16 v[132:135], a[236:239], a[244:247], v[132:135]
    v_mfma_f32_16x16x32_bf16 v[152:155], v[116:119], a[252:255], v[152:155]
    v_mfma_f32_16x16x32_bf16 v[144:147], a[232:235], a[252:255], v[144:147]
    v_mfma_f32_16x16x32_bf16 v[148:151], a[236:239], a[252:255], v[148:151]
    s_nop 2
    v_add_f32 v136, 0x358637bd, v136
    s_nop 1
    v_add_f32 v152, 0x358637bd, v152
    v_rcp_f32 v136, v136
    v_rcp_f32 v152, v152
    v_pk_mul_f32 v[128:129], v[128:129], v[136:137] op_sel_hi:[1,0]
    v_pk_mul_f32 v[144:145], v[144:145], v[152:153] op_sel_hi:[1,0]
    v_pk_mul_f32 v[130:131], v[130:131], v[136:137] op_sel_hi:[1,0]
    v_pk_mul_f32 v[146:147], v[146:147], v[152:153] op_sel_hi:[1,0]
    v_pk_mul_f32 v[132:133], v[132:133], v[136:137] op_sel_hi:[1,0]
    v_pk_mul_f32 v[148:149], v[148:149], v[152:153] op_sel_hi:[1,0]
    v_pk_mul_f32 v[134:135], v[134:135], v[136:137] op_sel_hi:[1,0]
    v_pk_mul_f32 v[150:151], v[150:151], v[152:153] op_sel_hi:[1,0]
    v_cvt_pk_bf16_f32 v140, v128, v129
    v_cvt_pk_bf16_f32 v156, v144, v145
    v_cvt_pk_bf16_f32 v141, v130, v131
    v_cvt_pk_bf16_f32 v157, v146, v147
    v_cvt_pk_bf16_f32 v142, v132, v133
    v_cvt_pk_bf16_f32 v158, v148, v149
    v_cvt_pk_bf16_f32 v143, v134, v135
    v_cvt_pk_bf16_f32 v159, v150, v151
    buffer_store_dwordx4 v[140:143], v16, s[56:59], s10 offen sc1
    buffer_store_dwordx4 v[156:159], v16, s[56:59], s11 offen sc1
    s_waitcnt vmcnt(2)
    v_cmp_le_u32 vcc, 2, v220
    v_cmp_le_u32 s[6:7], 1, v221
    s_andn2_b64 exec, vcc, s[12:13]
    s_or_b64 s[12:13], s[12:13], vcc
    buffer_load_dword v222, v218, s[56:59], 0 offen offset:0
    buffer_load_dword v222, v218, s[56:59], 0 offen offset:128
    s_andn2_b64 exec, s[6:7], s[14:15]
    s_or_b64 s[14:15], s[14:15], s[6:7]
    buffer_load_dword v222, v219, s[56:59], 0 offen
    s_mov_b64 exec, -1
    s_mov_b32 s48, s22
    s_and_b32 s49, s23, 0xffff
    s_mov_b32 s50, 0x62000
    s_mov_b32 s51, 0x00020000
    s_mov_b32 s60, 0
    buffer_load_dword v60, v28, s[48:51], s60 offen
    s_mov_b32 s60, 131072
    buffer_load_dword v60, v28, s[48:51], s60 offen
    s_mov_b32 s60, 262144
    buffer_load_dword v60, v28, s[48:51], s60 offen
    s_mov_b32 s60, 393216
    buffer_load_dword v60, v28, s[48:51], s60 offen
    s_waitcnt vmcnt(4)
    s_mov_b64 exec, 0x7f7f00
    buffer_atomic_add v63, v26, s[56:59], 0 offen offset:24 sc1
    s_mov_b64 exec, -1
    v_mov_b32 v244, -1
    v_mov_b32 v245, -1
    v_mov_b32 v246, -1
    v_mov_b32 v247, -1
    s_and_b32 s5, s93, 7
    s_lshl_b32 s5, s5, 2
    s_lshr_b32 s6, s93, 3
    s_add_u32 s5, s5, s6
    s_lshl_b32 s5, s5, 19
    s_lshl_b32 s6, s72, 14
    s_add_u32 s5, s5, s6
    s_add_u32 s5, s5, 0xa01800
    s_mov_b32 s6, 0
    s_nop 0
L_pf_a:
    buffer_store_dwordx4 v[244:247], v16, s[56:59], s5 offen offset:0 sc1
    buffer_store_dwordx4 v[244:247], v16, s[56:59], s5 offen offset:1024 sc1
    buffer_store_dwordx4 v[244:247], v16, s[56:59], s5 offen offset:2048 sc1
    buffer_store_dwordx4 v[244:247], v16, s[56:59], s5 offen offset:3072 sc1
    s_add_u32 s5, s5, 4096
    buffer_store_dwordx4 v[244:247], v16, s[56:59], s5 offen offset:0 sc1
    buffer_store_dwordx4 v[244:247], v16, s[56:59], s5 offen offset:1024 sc1
    s_add_u32 s5, s5, 61440
    s_add_u32 s6, s6, 1
    s_cmp_lt_u32 s6, 7
    s_nop 0
    s_cbranch_scc1 L_pf_a
    v_lshrrev_b32 v4, 2, v1
    v_lshlrev_b32 v4, 14, v4
    v_and_b32 v5, 3, v1
    v_lshl_add_u32 v4, v5, 7, v4
    s_lshl_b32 s5, s93, 9
    s_add_u32 s5, s5, 0x3c0008
    v_add_u32 v248, s5, v4
    s_waitcnt vmcnt(0)
    s_mov_b64 exec, 0xfffffff
    buffer_atomic_add v63, v248, s[56:59], 0 offen offset:0 sc1
    s_mov_b64 exec, -1
    s_lshl_b32 s5, s93, 9
    s_lshl_b32 s6, s72, 7
    s_add_u32 s5, s5, s6
    s_add_u32 s5, s5, 0x3c0000
    s_and_b32 s6, s93, 7
    s_lshl_b32 s6, s6, 2
    s_lshr_b32 s7, s93, 3
    s_add_u32 s6, s6, s7
    s_lshl_b32 s6, s6, 2
    s_add_u32 s6, s6, s72
    s_lshl_b32 s6, s6, 14
    s_add_u32 s6, s6, 0x700000
    v_lshlrev_b32 v4, 7, v1
    s_add_u32 s7, s6, 8192
    s_mov_b32 s9, 0
    s_nop 2
L_opf:
    s_buffer_load_dword s8, s[56:59], s5 offset:0x18 glc
    s_add_u32 s9, s9, 1
    s_waitcnt lgkmcnt(0)
    s_cmp_ge_u32 s8, 16
    s_nop 0
    s_cbranch_scc1 L_opf1
    s_cmp_lt_u32 s9, 40
    s_nop 0
    s_cbranch_scc1 L_opf
    s_nop 0
    s_branch L_opf2
    s_nop 0
L_opf1:
    buffer_load_dword v5, v4, s[56:59], s6 offen
    buffer_load_dword v5, v4, s[56:59], s7 offen
    s_waitcnt vmcnt(0)
    s_nop 0
L_opf2:
L_end:
L_exit:
    s_endpgm
L_code_end:
.section .rodata,"a"
.p2align 6
.amdhsa_kernel p1_kernel
  .amdhsa_next_free_vgpr 512
  .amdhsa_next_free_sgpr 102
  .amdhsa_accum_offset 256
  .amdhsa_group_segment_fixed_size 0
  .amdhsa_kernarg_size 104
  .amdhsa_user_sgpr_count 2
  .amdhsa_user_sgpr_kernarg_segment_ptr 1
  .amdhsa_system_sgpr_workgroup_id_x 1
.end_amdhsa_kernel
```
